```python
import torch

def _softmax(x, axis=-1):
    return torch.softmax(x, dim=axis)
def _gelu(x):
    return torch.nn.functional.gelu(x, approximate="tanh")
def _silu(x):
    return torch.nn.functional.silu(x)
def _sigmoid(x):
    return torch.sigmoid(x)
def _layernorm(x, axis=-1, eps=1e-5):
    m = x.mean(dim=axis, keepdim=True)
    v = x.var(dim=axis, keepdim=True, unbiased=False)
    return (x - m) / torch.sqrt(v + eps)
def _scatter_add(tgt, idx, src, axis=0):
    return tgt.clone().index_add_(axis, idx, src)
def _segment_sum(src, seg, n):
    out = torch.zeros((n,) + src.shape[1:], dtype=src.dtype)
    return out.index_add_(0, seg, src)
def _pad(x, pw):
    flat = tuple(v for pair in reversed(pw) for v in pair)
    return torch.nn.functional.pad(x, flat)

kernel_name = 'recurrent_scan__softmax_full_mha__swiglu_ffn__prompt'

def setup_inputs():

    _w = (lambda a: (lambda t: t.to(torch.bfloat16) if t.is_floating_point() else t)(torch.as_tensor(a)))
    def _A_setup():
        B, S, D = 1, 2048, 640
        return {
            "x": _w((lambda *s: torch.randn(*s, dtype=torch.bfloat16) * 0.05)(B, S, D)),
            "wqkv": _w((lambda *s: torch.randn(*s, dtype=torch.bfloat16) * 0.05)(D, 3 * D)),
            "wo": _w((lambda *s: torch.randn(*s, dtype=torch.bfloat16) * 0.05)(D, D)),
        }
    _A_in = _A_setup()

    def _B_setup():
        B, S, D, F = 1, 2048, 640, 1536
        return {
            "x": _w((lambda *s: torch.randn(*s, dtype=torch.bfloat16) * 0.05)(B, S, D)),
            "w_gate": _w((lambda *s: torch.randn(*s, dtype=torch.bfloat16) * 0.05)(D, F)),
            "w_up": _w((lambda *s: torch.randn(*s, dtype=torch.bfloat16) * 0.05)(D, F)),
            "w_down": _w((lambda *s: torch.randn(*s, dtype=torch.bfloat16) * 0.05)(F, D)),
        }
    _B_in = _B_setup()

    return {
        "A_x": _A_in["x"],
        "A_wqkv": _A_in["wqkv"],
        "A_wo": _A_in["wo"],
        "B_x": _B_in["x"],
        "B_w_gate": _B_in["w_gate"],
        "B_w_up": _B_in["w_up"],
        "B_w_down": _B_in["w_down"],
    }

def reference(A_x, A_wqkv, A_wo, B_x, B_w_gate, B_w_up, B_w_down):
    def _A_ref(x, wqkv, wo):
        B, S, D = x.shape
        H = 32; Dh = D // H
        qkv = (lambda x, *d: x.permute(*d))((x @ wqkv).reshape(B, S, 3, H, Dh), 2, 0, 3, 1, 4)
        q, k, v = qkv[0], qkv[1], qkv[2]
        scale = Dh ** -0.5
        scores = torch.einsum("bhqd,bhkd->bhqk", q, k) * scale
        p = _softmax(scores, axis=-1)
        o = torch.einsum("bhqk,bhkd->bhqd", p, v)
        return (lambda x, *d: x.permute(*d))(o, 0, 2, 1, 3).reshape(B, S, D) @ wo

    def _B_ref(x, w_gate, w_up, w_down):
        g = _silu(x @ w_gate)
        u = x @ w_up
        return (g * u) @ w_down

    x = A_x
    xn = _layernorm(x, axis=-1)
    s = _A_ref(xn, A_wqkv, A_wo)
    g = _silu(_B_ref(xn, B_w_gate, B_w_up, B_w_down))
    return x + s * g
```

```asm
; @launch grid=(256,1,1) block=(256,1,1) lds=163840
.amdgcn_target "amdgcn-amd-amdhsa--gfx950"
.text
.globl recurrent_scan__softmax_full_mha__swiglu_ffn__prompt_kernel
.p2align 8
.type recurrent_scan__softmax_full_mha__swiglu_ffn__prompt_kernel,@function
recurrent_scan__softmax_full_mha__swiglu_ffn__prompt_kernel:
    s_cmp_ge_u32 s2, 256
    s_cbranch_scc1 L_exit
    s_load_dwordx2 s[8:9], s[0:1], 0
    s_load_dwordx4 s[64:67], s[0:1], 8
    s_load_dwordx4 s[68:71], s[0:1], 32
    s_load_dwordx2 s[72:73], s[0:1], 48
    s_load_dwordx2 s[44:45], s[0:1], 56
    s_load_dwordx2 s[40:41], s[0:1], 64
    s_load_dwordx2 s[12:13], s[0:1], 72
    v_lshrrev_b32 v1, 6, v0
    v_and_b32 v0, 63, v0
    v_readfirstlane_b32 s3, v1
    v_lshlrev_b32 v1, 4, v0
    s_getpc_b64 s[98:99]
L_pc:
    s_lshr_b32 s4, s2, 3
    s_lshl_b32 s4, s4, 2
    s_add_u32 s4, s4, s3
    s_lshl_b32 s4, s4, 10
    s_min_u32 s4, s4, L_end-L_pc-1024
    s_add_u32 s98, s98, s4
    s_addc_u32 s99, s99, 0
    global_load_dword v62, v1, s[98:99] offset:0
    v_lshrrev_b32 v56, 3, v0
    v_and_b32 v57, 7, v0
    v_lshrrev_b32 v58, 4, v0
    v_xor_b32 v59, v57, v58
    v_mul_u32_u24 v60, 1280, v56
    v_lshl_add_u32 v36, v59, 4, v60
    v_xor_b32 v37, 64, v36
    v_add_u32 v38, 18432, v36
    v_add_u32 v39, 27648, v37
    v_add_u32 v37, 9216, v37
    s_lshr_b32 s5, s2, 3
    s_and_b32 s6, s5, 3
    s_lshr_b32 s62, s5, 2
    s_and_b32 s4, s2, 7
    s_lshl_b32 s4, s4, 2
    s_add_u32 s61, s4, s6
    s_and_b32 s6, s5, 3
    s_lshr_b32 s60, s5, 2
    s_and_b32 s4, s2, 3
    s_lshl_b32 s4, s4, 2
    s_add_u32 s4, s4, s6
    s_lshl_b32 s4, s4, 2
    s_add_u32 s7, s4, s3
    s_mul_i32 s63, s7, 40960
    s_mul_i32 s48, s3, 40960
    s_mov_b32 s10, 2621440
    s_mov_b32 s11, 0x00020000
    s_mul_i32 s4, s60, 5
    s_lshr_b32 s4, s4, 2
    s_mul_i32 s5, s6, 10
    s_lshr_b32 s5, s5, 2
    s_add_u32 s4, s4, s5
    s_cmp_ge_u32 s4, 10
    s_cselect_b32 s5, 10, 0
    s_sub_u32 s6, s4, s5
    s_lshl_b32 s6, s6, 2
    s_mov_b32 s92, 0x76543210
    s_mov_b32 s93, 0x98
    s_sub_u32 s94, 40, s6
    s_lshl_b64 s[4:5], s[92:93], s94
    s_lshr_b64 s[92:93], s[92:93], s6
    s_or_b64 s[92:93], s[92:93], s[4:5]
    s_add_u32 m0, s48, 12288
    s_bfe_u32 s94, s92, 0x40000
    s_lshl_b32 s94, s94, 7
    s_add_u32 s94, s94, s63
    s_waitcnt lgkmcnt(0)
    buffer_load_dwordx4 v36, s[8:11], s94 offen offset:0 lds
    buffer_load_dwordx4 v37, s[8:11], s94 offen offset:1024 lds
    buffer_load_dwordx4 v38, s[8:11], s94 offen offset:2048 lds
    buffer_load_dwordx4 v39, s[8:11], s94 offen offset:3072 lds
    s_cmp_eq_u32 s3, 1
    s_cselect_b64 s[4:5], s[68:69], s[64:65]
    s_cmp_eq_u32 s3, 2
    s_cselect_b64 s[4:5], s[70:71], s[4:5]
    s_cmp_eq_u32 s3, 3
    s_cselect_b32 s91, 0x200000, 0
    s_load_dword s90, s[4:5], s91
    s_and_b32 s4, s61, 3
    s_lshl_b32 s4, s4, 2
    s_add_u32 s4, s4, s3
    s_mov_b32 s91, 1981440
    s_cmp_eq_u32 s4, 1
    s_cselect_b32 s91, 4087808, s91
    s_cmp_eq_u32 s4, 2
    s_cselect_b32 s91, 6194176, s91
    s_cmp_eq_u32 s4, 3
    s_cselect_b32 s91, 8326144, s91
    s_cmp_eq_u32 s4, 4
    s_cselect_b32 s91, 10412032, s91
    s_cmp_eq_u32 s4, 5
    s_cselect_b32 s91, 12497920, s91
    s_cmp_eq_u32 s4, 6
    s_cselect_b32 s91, 14285824, s91
    s_cmp_eq_u32 s4, 7
    s_cselect_b32 s91, 19775488, s91
    s_cmp_eq_u32 s4, 8
    s_cselect_b32 s91, 16384512, s91
    s_cmp_eq_u32 s4, 9
    s_cselect_b32 s91, 16909824, s91
    s_load_dword s90, s[12:13], s91
    s_cmp_eq_u32 s3, 0
    s_cselect_b64 s[4:5], s[72:73], s[66:67]
    s_cmp_eq_u32 s3, 2
    s_cselect_b64 s[4:5], s[40:41], s[4:5]
    s_load_dword s90, s[4:5], 0
    s_add_u32 m0, s48, 16384
    s_bfe_u32 s94, s92, 0x40004
    s_lshl_b32 s94, s94, 7
    s_add_u32 s94, s94, s63
    buffer_load_dwordx4 v36, s[8:11], s94 offen offset:0 lds
    buffer_load_dwordx4 v37, s[8:11], s94 offen offset:1024 lds
    buffer_load_dwordx4 v38, s[8:11], s94 offen offset:2048 lds
    buffer_load_dwordx4 v39, s[8:11], s94 offen offset:3072 lds
    s_and_b32 s6, s2, 7
    s_lshr_b32 s6, s6, 2
    s_lshl_b32 s6, s6, 3
    s_add_u32 s6, s6, s60
    s_and_b32 s60, s6, 1
    s_lshr_b32 s5, s6, 1
    s_mov_b32 s14, 19818496
    s_mov_b32 s15, 0x00020000
    s_mov_b32 s42, 256
    s_mov_b32 s43, 0x00020000
    s_mov_b32 s46, 2621440
    s_mov_b32 s47, 0x00020000
    s_mov_b32 s49, 0xffff0000
    s_mov_b32 s50, 0x3f803f80
    s_min_u32 s4, s6, 13
    s_lshl_b32 s51, s4, 7
    s_mul_i32 s52, s3, 61440
    s_add_u32 s51, s51, s52
    s_add_u32 s16, s64, s51
    s_addc_u32 s17, s65, 0
    s_sub_u32 s18, 2457600, s51
    s_mov_b32 s19, 0x00020000
    s_mul_i32 s56, s7, 123904
    s_lshl_b32 s4, s4, 12
    s_add_u32 s55, s56, s4
    s_cmp_ge_u32 s6, 14
    s_cselect_b32 s55, 2130706432, s55
    s_cselect_b32 s18, 0, s18
    s_cmp_lt_u32 s6, 10
    s_cselect_b32 s58, 0x3ea52b5c, 1.0
    s_mul_i32 s57, s7, 99328
    s_add_u32 s57, s57, 7929856
    s_mul_i32 s54, s3, 49152
    s_lshl_b32 s4, s5, 1
    s_add_u32 s4, s4, 14
    s_xor_b32 s51, s5, 20
    s_cmp_eq_u32 s6, 14
    s_cselect_b32 s51, 15, s51
    s_mov_b32 s53, 245760
    s_mov_b32 s59, 2457600
    s_cmp_eq_u32 s60, 0
    s_cselect_b32 s4, s51, s4
    s_cselect_b32 s52, s54, s52
    s_cselect_b32 s56, s57, s56
    s_cselect_b32 s53, 196608, s53
    s_cselect_b32 s59, 1966080, s59
    s_cselect_b32 s20, s68, s64
    s_cselect_b32 s21, s69, s65
    s_cselect_b32 s24, s70, s64
    s_cselect_b32 s25, s71, s65
    s_cselect_b64 vcc, -1, 0
    s_lshl_b32 s51, s4, 7
    s_add_u32 s51, s51, s52
    s_lshl_b32 s4, s4, 12
    s_add_u32 s56, s56, s4
    s_add_u32 s20, s20, s51
    s_addc_u32 s21, s21, 0
    s_sub_u32 s20, s20, 2048
    s_subb_u32 s21, s21, 0
    s_sub_u32 s22, s59, s51
    s_add_u32 s22, s22, 2048
    s_mov_b32 s23, 0x00020000
    s_lshl_b32 s4, s60, 7
    s_add_u32 s51, s51, s4
    s_add_u32 s24, s24, s51
    s_addc_u32 s25, s25, 0
    s_sub_u32 s26, s59, s51
    s_mov_b32 s27, 0x00020000
    s_xor_b32 s4, s6, 1
    s_cmp_eq_u32 s6, 14
    s_cselect_b32 s4, 19, s4
    s_lshl_b32 s51, s4, 7
    s_add_u32 s51, s51, s54
    s_add_u32 s28, s68, s51
    s_addc_u32 s29, s69, 0
    s_sub_u32 s30, 1966080, s51
    s_mov_b32 s31, 0x00020000
    s_add_u32 s32, s70, s51
    s_addc_u32 s33, s71, 0
    s_sub_u32 s32, s32, 2048
    s_subb_u32 s33, s33, 0
    s_sub_u32 s34, 1966080, s51
    s_add_u32 s34, s34, 2048
    s_mov_b32 s35, 0x00020000
    s_lshl_b32 s4, s4, 12
    s_add_u32 s57, s57, s4
    v_bfe_u32 v64, v0, 4, 1
    v_lshlrev_b32 v59, 2, v64
    v_xor_b32 v59, v59, v57
    v_lshlrev_b32 v59, 4, v59
    v_mul_u32_u24 v32, 3840, v56
    v_add_u32 v32, v32, v59
    v_xor_b32 v33, 16, v32
    v_add_u32 v33, 29696, v33
    v_mul_u32_u24 v10, 3072, v56
    v_add_u32 v10, v10, v59
    v_xor_b32 v11, 16, v10
    v_add_u32 v11, 23552, v11
    v_cndmask_b32 v34, v32, v10, vcc
    v_cndmask_b32 v35, v33, v11, vcc
    s_add_u32 m0, s48, 20480
    s_bfe_u32 s94, s92, 0x40008
    s_lshl_b32 s94, s94, 7
    s_add_u32 s94, s94, s63
    buffer_load_dwordx4 v36, s[8:11], s94 offen offset:0 lds
    buffer_load_dwordx4 v37, s[8:11], s94 offen offset:1024 lds
    buffer_load_dwordx4 v38, s[8:11], s94 offen offset:2048 lds
    buffer_load_dwordx4 v39, s[8:11], s94 offen offset:3072 lds
    v_and_b32 v59, 31, v0
    v_lshrrev_b32 v60, 5, v0
    v_bfe_u32 v61, v0, 1, 3
    v_xor_b32 v61, v61, v60
    v_lshlrev_b32 v61, 4, v61
    v_lshl_add_u32 v61, v59, 7, v61
    v_add_u32 v40, s48, v61
    v_and_b32 v59, 15, v0
    v_bfe_u32 v61, v0, 1, 3
    v_xor_b32 v61, v61, v58
    v_lshlrev_b32 v61, 4, v61
    v_lshl_add_u32 v61, v59, 7, v61
    v_add_u32 v40, s48, v61
    v_add_u32 v41, 2048, v40
    v_xor_b32 v42, 64, v40
    v_xor_b32 v43, 64, v41
    v_mov_b32 v50, 0
    v_mov_b32 v51, 0
    v_mov_b32 v74, 0
    v_mov_b32 v75, 0
    v_min_u32 v49, 29, v0
    s_lshl_b32 s4, s2, 1
    s_and_b32 s95, s3, 1
    s_add_u32 s4, s4, s95
    s_mul_i32 s4, s4, 30
    v_add_u32 v49, s4, v49
    s_cmp_lt_u32 s3, 2
    s_cselect_b64 s[96:97], s[68:69], s[70:71]
    v_lshlrev_b32 v49, 7, v49
    v_mov_b32 v14, 0
    v_mov_b32 v66, 2130706432
    s_lshl_b32 s4, s5, 1
    s_add_u32 s4, s4, 13
    v_add_u32 v67, s4, v0
    v_cmp_eq_u32 vcc, 0, v0
    v_mov_b32 v68, s6
    s_lshr_b32 s51, s7, 2
    s_lshl_b32 s51, s51, 7
    s_lshl_b32 s4, s3, 2
    s_add_u32 s51, s51, s4
    s_add_u32 s51, s51, 19712000
    v_cndmask_b32 v67, v67, v68, vcc
    v_cndmask_b32 v15, v66, v14, vcc
    v_lshl_add_u32 v67, v67, 11, s51
    s_cmp_eq_u32 s60, 0
    s_cselect_b32 s4, 0, 6
    s_cmp_lt_u32 s6, 14
    s_addc_u32 vcc_lo, s4, 0
    s_mov_b32 vcc_hi, 0
    v_cndmask_b32 v67, v66, v67, vcc
    s_lshl_b32 s4, s62, 2
    s_add_u32 s4, s4, s3
    s_lshl_b32 s4, s4, 9
    s_and_b32 s54, s61, 3
    s_lshl_b32 s54, s54, 5
    s_add_u32 s4, s4, s54
    s_and_b32 s54, s61, 28
    s_add_u32 s4, s4, s54
    s_add_u32 s54, s4, 19695616
    v_mov_b32 v71, 0
    v_accvgpr_write_b32 a240, v67
    s_and_b32 s4, s2, 63
    s_lshl_b32 s4, s4, 2
    s_cmp_eq_u32 s3, 0
    s_cselect_b32 s4, s4, 2130706432
    v_or_b32 v13, s4, v15
    v_mov_b32 v68, s54
    v_add_u32 v15, v15, v68
    v_bfe_u32 v63, v0, 2, 2
    v_lshl_add_u32 v61, v60, 3, v63
    v_lshlrev_b32 v61, 7, v61
    v_bfe_u32 v59, v0, 3, 1
    v_lshl_add_u32 v61, v59, 6, v61
    v_lshl_add_u32 v61, v64, 5, v61
    v_and_b32 v65, 3, v0
    v_lshl_add_u32 v2, v65, 3, v61
    v_xor_b32 v3, 64, v2
    v_lshl_add_u32 v61, v64, 3, v63
    v_lshlrev_b32 v61, 7, v61
    v_lshl_add_u32 v61, v59, 6, v61
    v_lshl_add_u32 v61, v64, 4, v61
    v_bfe_u32 v59, v0, 1, 1
    v_lshl_add_u32 v61, v59, 5, v61
    v_and_b32 v59, 1, v0
    v_lshl_add_u32 v61, v59, 3, v61
    v_mul_u32_u24 v59, 40960, v60
    v_add_u32 v2, v59, v61
    v_xor_b32 v3, 64, v2
    v_xor_b32 v4, 16, v2
    v_xor_b32 v5, 80, v2
    v_add_u32 v6, 81920, v2
    v_add_u32 v7, 81920, v3
    v_add_u32 v8, 81920, v4
    v_add_u32 v9, 81920, v5
    v_lshlrev_b32 v61, 4, v60
    v_lshl_add_u32 v61, v64, 2, v61
    v_add_u32 v61, v61, v63
    v_mul_u32_u24 v12, 160, v61
    v_mad_u32_u24 v12, v65, 40, v12
    s_add_u32 s4, s48, 30720
    v_add_u32 v12, s4, v12
    s_lshr_b32 s4, s3, 1
    s_lshl_b32 s4, s4, 8
    s_add_u32 s4, s4, s2
    s_lshl_b32 s4, s4, 1
    s_and_b32 s5, s3, 1
    s_add_u32 s4, s4, s5
    s_and_b32 s5, s4, 7
    s_lshr_b32 s4, s4, 3
    s_mul_i32 s59, s5, 68
    s_add_u32 s59, s59, s4
    s_mul_i32 s59, s59, 5120
    s_add_u32 s59, s59, 16910336
    s_mov_b32 s38, 819200
    s_mov_b32 s39, 0x00020000
    s_cmp_lt_u32 s4, 48
    s_cselect_b32 s36, s72, s66
    s_cselect_b32 s37, s73, s67
    s_cselect_b32 s38, 1966080, s38
    s_cselect_b32 s64, 16, 20
    s_cselect_b32 s67, 32, 40
    s_cselect_b32 s68, 0, 48
    s_cmp_lt_u32 s4, 64
    s_cselect_b32 s64, s64, 80
    s_cselect_b32 s65, 8, 20
    s_cselect_b32 s66, 4, 40
    s_cselect_b32 s67, s67, 160
    s_cselect_b32 s68, s68, 64
    s_cselect_b32 s69, 0, 16
    s_sub_u32 s68, s4, s68
    s_mul_i32 s67, s67, s68
    s_add_u32 s67, s67, s69
    s_mul_i32 s67, s67, 1280
    s_mov_b32 s70, s5
    s_mul_i32 s5, s5, 160
    s_add_u32 s67, s67, s5
    s_cmp_ge_u32 s4, 68
    s_cselect_b32 s67, 2130706432, s67
    s_cselect_b32 s59, 2130706432, s59
    v_add_u32 v56, 0, v0
    v_mul_u32_u24 v57, 0x199a, v56
    v_lshrrev_b32 v57, 16, v57
    v_mul_u32_u24 v58, 10, v57
    v_sub_u32 v58, v56, v58
    v_and_b32 v56, 3, v57
    v_bfe_u32 v61, v57, 2, 1
    v_mad_u32_u24 v56, v61, s66, v56
    v_bfe_u32 v61, v57, 3, 1
    v_mad_u32_u24 v56, v61, s65, v56
    v_lshrrev_b32 v61, 4, v57
    v_mad_u32_u24 v56, v61, s64, v56
    v_mul_u32_u24 v56, 1280, v56
    v_lshl_add_u32 v44, v58, 4, v56
    v_add_u32 v56, 64, v0
    v_mul_u32_u24 v57, 0x199a, v56
    v_lshrrev_b32 v57, 16, v57
    v_mul_u32_u24 v58, 10, v57
    v_sub_u32 v58, v56, v58
    v_and_b32 v56, 3, v57
    v_bfe_u32 v61, v57, 2, 1
    v_mad_u32_u24 v56, v61, s66, v56
    v_bfe_u32 v61, v57, 3, 1
    v_mad_u32_u24 v56, v61, s65, v56
    v_lshrrev_b32 v61, 4, v57
    v_mad_u32_u24 v56, v61, s64, v56
    v_mul_u32_u24 v56, 1280, v56
    v_lshl_add_u32 v45, v58, 4, v56
    v_subrev_u32 v45, 1024, v45
    v_add_u32 v56, 128, v0
    v_mul_u32_u24 v57, 0x199a, v56
    v_lshrrev_b32 v57, 16, v57
    v_mul_u32_u24 v58, 10, v57
    v_sub_u32 v58, v56, v58
    v_and_b32 v56, 3, v57
    v_bfe_u32 v61, v57, 2, 1
    v_mad_u32_u24 v56, v61, s66, v56
    v_bfe_u32 v61, v57, 3, 1
    v_mad_u32_u24 v56, v61, s65, v56
    v_lshrrev_b32 v61, 4, v57
    v_mad_u32_u24 v56, v61, s64, v56
    v_mul_u32_u24 v56, 1280, v56
    v_lshl_add_u32 v46, v58, 4, v56
    v_subrev_u32 v46, 2048, v46
    v_add_u32 v56, 192, v0
    v_mul_u32_u24 v57, 0x199a, v56
    v_lshrrev_b32 v57, 16, v57
    v_mul_u32_u24 v58, 10, v57
    v_sub_u32 v58, v56, v58
    v_and_b32 v56, 3, v57
    v_bfe_u32 v61, v57, 2, 1
    v_mad_u32_u24 v56, v61, s66, v56
    v_bfe_u32 v61, v57, 3, 1
    v_mad_u32_u24 v56, v61, s65, v56
    v_lshrrev_b32 v61, 4, v57
    v_mad_u32_u24 v56, v61, s64, v56
    v_mul_u32_u24 v56, 1280, v56
    v_lshl_add_u32 v47, v58, 4, v56
    v_subrev_u32 v47, 3072, v47
    v_add_u32 v56, 256, v0
    v_mul_u32_u24 v57, 0x199a, v56
    v_lshrrev_b32 v57, 16, v57
    v_mul_u32_u24 v58, 10, v57
    v_sub_u32 v58, v56, v58
    v_and_b32 v56, 3, v57
    v_bfe_u32 v61, v57, 2, 1
    v_mad_u32_u24 v56, v61, s66, v56
    v_bfe_u32 v61, v57, 3, 1
    v_mad_u32_u24 v56, v61, s65, v56
    v_lshrrev_b32 v61, 4, v57
    v_mad_u32_u24 v56, v61, s64, v56
    v_mul_u32_u24 v56, 1280, v56
    v_lshl_add_u32 v48, v58, 4, v56
    v_mov_b32 v14, 1
    s_waitcnt vmcnt(8)
    ds_read_b128 v[96:99], v40 offset:12288
    ds_read_b128 v[100:103], v41 offset:12288
    ds_read_b128 v[104:107], v42 offset:12288
    ds_read_b128 v[108:111], v43 offset:12288
    s_waitcnt vmcnt(4)
    ds_read_b128 v[112:115], v40 offset:16384
    ds_read_b128 v[116:119], v41 offset:16384
    ds_read_b128 v[120:123], v42 offset:16384
    ds_read_b128 v[124:127], v43 offset:16384
    s_add_u32 m0, s48, 24576
    s_bfe_u32 s94, s92, 0x4000c
    s_lshl_b32 s94, s94, 7
    s_add_u32 s94, s94, s63
    buffer_load_dwordx4 v36, s[8:11], s94 offen offset:0 lds
    s_waitcnt lgkmcnt(4)
    v_dot2c_f32_bf16 v50, s50, v96
    v_dot2c_f32_bf16 v51, v96, v96
    v_dot2c_f32_bf16 v50, s50, v97
    v_dot2c_f32_bf16 v51, v97, v97
    v_dot2c_f32_bf16 v50, s50, v98
    v_dot2c_f32_bf16 v51, v98, v98
    v_dot2c_f32_bf16 v50, s50, v99
    v_dot2c_f32_bf16 v51, v99, v99
    buffer_load_dwordx4 v37, s[8:11], s94 offen offset:1024 lds
    v_dot2c_f32_bf16 v74, s50, v100
    v_dot2c_f32_bf16 v75, v100, v100
    v_dot2c_f32_bf16 v74, s50, v101
    v_dot2c_f32_bf16 v75, v101, v101
    v_dot2c_f32_bf16 v74, s50, v102
    v_dot2c_f32_bf16 v75, v102, v102
    v_dot2c_f32_bf16 v74, s50, v103
    v_dot2c_f32_bf16 v75, v103, v103
    buffer_load_dwordx4 v38, s[8:11], s94 offen offset:2048 lds
    v_dot2c_f32_bf16 v50, s50, v104
    v_dot2c_f32_bf16 v51, v104, v104
    v_dot2c_f32_bf16 v50, s50, v105
    v_dot2c_f32_bf16 v51, v105, v105
    v_dot2c_f32_bf16 v50, s50, v106
    v_dot2c_f32_bf16 v51, v106, v106
    v_dot2c_f32_bf16 v50, s50, v107
    v_dot2c_f32_bf16 v51, v107, v107
    buffer_load_dwordx4 v39, s[8:11], s94 offen offset:3072 lds
    v_dot2c_f32_bf16 v74, s50, v108
    v_dot2c_f32_bf16 v75, v108, v108
    v_dot2c_f32_bf16 v74, s50, v109
    v_dot2c_f32_bf16 v75, v109, v109
    v_dot2c_f32_bf16 v74, s50, v110
    v_dot2c_f32_bf16 v75, v110, v110
    v_dot2c_f32_bf16 v74, s50, v111
    v_dot2c_f32_bf16 v75, v111, v111
    s_waitcnt vmcnt(4)
    ds_read_b128 v[128:131], v40 offset:20480
    ds_read_b128 v[132:135], v41 offset:20480
    ds_read_b128 v[136:139], v42 offset:20480
    ds_read_b128 v[140:143], v43 offset:20480
    s_add_u32 m0, s48, 28672
    s_bfe_u32 s94, s92, 0x40010
    s_lshl_b32 s94, s94, 7
    s_add_u32 s94, s94, s63
    buffer_load_dwordx4 v36, s[8:11], s94 offen offset:0 lds
    s_waitcnt lgkmcnt(4)
    v_dot2c_f32_bf16 v50, s50, v112
    v_dot2c_f32_bf16 v51, v112, v112
    v_dot2c_f32_bf16 v50, s50, v113
    v_dot2c_f32_bf16 v51, v113, v113
    v_dot2c_f32_bf16 v50, s50, v114
    v_dot2c_f32_bf16 v51, v114, v114
    v_dot2c_f32_bf16 v50, s50, v115
    v_dot2c_f32_bf16 v51, v115, v115
    buffer_load_dwordx4 v37, s[8:11], s94 offen offset:1024 lds
    v_dot2c_f32_bf16 v74, s50, v116
    v_dot2c_f32_bf16 v75, v116, v116
    v_dot2c_f32_bf16 v74, s50, v117
    v_dot2c_f32_bf16 v75, v117, v117
    v_dot2c_f32_bf16 v74, s50, v118
    v_dot2c_f32_bf16 v75, v118, v118
    v_dot2c_f32_bf16 v74, s50, v119
    v_dot2c_f32_bf16 v75, v119, v119
    buffer_load_dwordx4 v38, s[8:11], s94 offen offset:2048 lds
    v_dot2c_f32_bf16 v50, s50, v120
    v_dot2c_f32_bf16 v51, v120, v120
    v_dot2c_f32_bf16 v50, s50, v121
    v_dot2c_f32_bf16 v51, v121, v121
    v_dot2c_f32_bf16 v50, s50, v122
    v_dot2c_f32_bf16 v51, v122, v122
    v_dot2c_f32_bf16 v50, s50, v123
    v_dot2c_f32_bf16 v51, v123, v123
    buffer_load_dwordx4 v39, s[8:11], s94 offen offset:3072 lds
    v_dot2c_f32_bf16 v74, s50, v124
    v_dot2c_f32_bf16 v75, v124, v124
    v_dot2c_f32_bf16 v74, s50, v125
    v_dot2c_f32_bf16 v75, v125, v125
    v_dot2c_f32_bf16 v74, s50, v126
    v_dot2c_f32_bf16 v75, v126, v126
    v_dot2c_f32_bf16 v74, s50, v127
    v_dot2c_f32_bf16 v75, v127, v127
    s_waitcnt vmcnt(4)
    ds_read_b128 v[144:147], v40 offset:24576
    ds_read_b128 v[148:151], v41 offset:24576
    ds_read_b128 v[152:155], v42 offset:24576
    ds_read_b128 v[156:159], v43 offset:24576
    s_add_u32 m0, s48, 32768
    s_bfe_u32 s94, s92, 0x40014
    s_lshl_b32 s94, s94, 7
    s_add_u32 s94, s94, s63
    buffer_load_dwordx4 v36, s[8:11], s94 offen offset:0 lds
    s_waitcnt lgkmcnt(4)
    v_dot2c_f32_bf16 v50, s50, v128
    v_dot2c_f32_bf16 v51, v128, v128
    v_dot2c_f32_bf16 v50, s50, v129
    v_dot2c_f32_bf16 v51, v129, v129
    v_dot2c_f32_bf16 v50, s50, v130
    v_dot2c_f32_bf16 v51, v130, v130
    v_dot2c_f32_bf16 v50, s50, v131
    v_dot2c_f32_bf16 v51, v131, v131
    buffer_load_dwordx4 v37, s[8:11], s94 offen offset:1024 lds
    v_dot2c_f32_bf16 v74, s50, v132
    v_dot2c_f32_bf16 v75, v132, v132
    v_dot2c_f32_bf16 v74, s50, v133
    v_dot2c_f32_bf16 v75, v133, v133
    v_dot2c_f32_bf16 v74, s50, v134
    v_dot2c_f32_bf16 v75, v134, v134
    v_dot2c_f32_bf16 v74, s50, v135
    v_dot2c_f32_bf16 v75, v135, v135
    buffer_load_dwordx4 v38, s[8:11], s94 offen offset:2048 lds
    v_dot2c_f32_bf16 v50, s50, v136
    v_dot2c_f32_bf16 v51, v136, v136
    v_dot2c_f32_bf16 v50, s50, v137
    v_dot2c_f32_bf16 v51, v137, v137
    v_dot2c_f32_bf16 v50, s50, v138
    v_dot2c_f32_bf16 v51, v138, v138
    v_dot2c_f32_bf16 v50, s50, v139
    v_dot2c_f32_bf16 v51, v139, v139
    buffer_load_dwordx4 v39, s[8:11], s94 offen offset:3072 lds
    v_dot2c_f32_bf16 v74, s50, v140
    v_dot2c_f32_bf16 v75, v140, v140
    v_dot2c_f32_bf16 v74, s50, v141
    v_dot2c_f32_bf16 v75, v141, v141
    v_dot2c_f32_bf16 v74, s50, v142
    v_dot2c_f32_bf16 v75, v142, v142
    v_dot2c_f32_bf16 v74, s50, v143
    v_dot2c_f32_bf16 v75, v143, v143
    s_waitcnt vmcnt(4)
    ds_read_b128 v[160:163], v40 offset:28672
    ds_read_b128 v[164:167], v41 offset:28672
    ds_read_b128 v[168:171], v42 offset:28672
    ds_read_b128 v[172:175], v43 offset:28672
    s_add_u32 m0, s48, 36864
    s_bfe_u32 s94, s92, 0x40018
    s_lshl_b32 s94, s94, 7
    s_add_u32 s94, s94, s63
    buffer_load_dwordx4 v36, s[8:11], s94 offen offset:0 lds
    s_waitcnt lgkmcnt(4)
    v_dot2c_f32_bf16 v50, s50, v144
    v_dot2c_f32_bf16 v51, v144, v144
    v_dot2c_f32_bf16 v50, s50, v145
    v_dot2c_f32_bf16 v51, v145, v145
    v_dot2c_f32_bf16 v50, s50, v146
    v_dot2c_f32_bf16 v51, v146, v146
    v_dot2c_f32_bf16 v50, s50, v147
    v_dot2c_f32_bf16 v51, v147, v147
    buffer_load_dwordx4 v37, s[8:11], s94 offen offset:1024 lds
    v_dot2c_f32_bf16 v74, s50, v148
    v_dot2c_f32_bf16 v75, v148, v148
    v_dot2c_f32_bf16 v74, s50, v149
    v_dot2c_f32_bf16 v75, v149, v149
    v_dot2c_f32_bf16 v74, s50, v150
    v_dot2c_f32_bf16 v75, v150, v150
    v_dot2c_f32_bf16 v74, s50, v151
    v_dot2c_f32_bf16 v75, v151, v151
    buffer_load_dwordx4 v38, s[8:11], s94 offen offset:2048 lds
    v_dot2c_f32_bf16 v50, s50, v152
    v_dot2c_f32_bf16 v51, v152, v152
    v_dot2c_f32_bf16 v50, s50, v153
    v_dot2c_f32_bf16 v51, v153, v153
    v_dot2c_f32_bf16 v50, s50, v154
    v_dot2c_f32_bf16 v51, v154, v154
    v_dot2c_f32_bf16 v50, s50, v155
    v_dot2c_f32_bf16 v51, v155, v155
    buffer_load_dwordx4 v39, s[8:11], s94 offen offset:3072 lds
    v_dot2c_f32_bf16 v74, s50, v156
    v_dot2c_f32_bf16 v75, v156, v156
    v_dot2c_f32_bf16 v74, s50, v157
    v_dot2c_f32_bf16 v75, v157, v157
    v_dot2c_f32_bf16 v74, s50, v158
    v_dot2c_f32_bf16 v75, v158, v158
    v_dot2c_f32_bf16 v74, s50, v159
    v_dot2c_f32_bf16 v75, v159, v159
    s_waitcnt vmcnt(4)
    ds_read_b128 v[176:179], v40 offset:32768
    ds_read_b128 v[180:183], v41 offset:32768
    ds_read_b128 v[184:187], v42 offset:32768
    ds_read_b128 v[188:191], v43 offset:32768
    s_add_u32 m0, s48, 12288
    s_bfe_u32 s94, s92, 0x4001c
    s_lshl_b32 s94, s94, 7
    s_add_u32 s94, s94, s63
    buffer_load_dwordx4 v36, s[8:11], s94 offen offset:0 lds
    s_waitcnt lgkmcnt(4)
    v_dot2c_f32_bf16 v50, s50, v160
    v_dot2c_f32_bf16 v51, v160, v160
    v_dot2c_f32_bf16 v50, s50, v161
    v_dot2c_f32_bf16 v51, v161, v161
    v_dot2c_f32_bf16 v50, s50, v162
    v_dot2c_f32_bf16 v51, v162, v162
    v_dot2c_f32_bf16 v50, s50, v163
    v_dot2c_f32_bf16 v51, v163, v163
    buffer_load_dwordx4 v37, s[8:11], s94 offen offset:1024 lds
    v_dot2c_f32_bf16 v74, s50, v164
    v_dot2c_f32_bf16 v75, v164, v164
    v_dot2c_f32_bf16 v74, s50, v165
    v_dot2c_f32_bf16 v75, v165, v165
    v_dot2c_f32_bf16 v74, s50, v166
    v_dot2c_f32_bf16 v75, v166, v166
    v_dot2c_f32_bf16 v74, s50, v167
    v_dot2c_f32_bf16 v75, v167, v167
    buffer_load_dwordx4 v38, s[8:11], s94 offen offset:2048 lds
    v_dot2c_f32_bf16 v50, s50, v168
    v_dot2c_f32_bf16 v51, v168, v168
    v_dot2c_f32_bf16 v50, s50, v169
    v_dot2c_f32_bf16 v51, v169, v169
    v_dot2c_f32_bf16 v50, s50, v170
    v_dot2c_f32_bf16 v51, v170, v170
    v_dot2c_f32_bf16 v50, s50, v171
    v_dot2c_f32_bf16 v51, v171, v171
    buffer_load_dwordx4 v39, s[8:11], s94 offen offset:3072 lds
    v_dot2c_f32_bf16 v74, s50, v172
    v_dot2c_f32_bf16 v75, v172, v172
    v_dot2c_f32_bf16 v74, s50, v173
    v_dot2c_f32_bf16 v75, v173, v173
    v_dot2c_f32_bf16 v74, s50, v174
    v_dot2c_f32_bf16 v75, v174, v174
    v_dot2c_f32_bf16 v74, s50, v175
    v_dot2c_f32_bf16 v75, v175, v175
    s_waitcnt vmcnt(4)
    ds_read_b128 v[192:195], v40 offset:36864
    ds_read_b128 v[196:199], v41 offset:36864
    ds_read_b128 v[200:203], v42 offset:36864
    ds_read_b128 v[204:207], v43 offset:36864
    s_add_u32 m0, s48, 16384
    s_bfe_u32 s94, s93, 0x40000
    s_lshl_b32 s94, s94, 7
    s_add_u32 s94, s94, s63
    buffer_load_dwordx4 v36, s[8:11], s94 offen offset:0 lds
    s_waitcnt lgkmcnt(4)
    v_dot2c_f32_bf16 v50, s50, v176
    v_dot2c_f32_bf16 v51, v176, v176
    v_dot2c_f32_bf16 v50, s50, v177
    v_dot2c_f32_bf16 v51, v177, v177
    v_dot2c_f32_bf16 v50, s50, v178
    v_dot2c_f32_bf16 v51, v178, v178
    v_dot2c_f32_bf16 v50, s50, v179
    v_dot2c_f32_bf16 v51, v179, v179
    buffer_load_dwordx4 v37, s[8:11], s94 offen offset:1024 lds
    v_dot2c_f32_bf16 v74, s50, v180
    v_dot2c_f32_bf16 v75, v180, v180
    v_dot2c_f32_bf16 v74, s50, v181
    v_dot2c_f32_bf16 v75, v181, v181
    v_dot2c_f32_bf16 v74, s50, v182
    v_dot2c_f32_bf16 v75, v182, v182
    v_dot2c_f32_bf16 v74, s50, v183
    v_dot2c_f32_bf16 v75, v183, v183
    buffer_load_dwordx4 v38, s[8:11], s94 offen offset:2048 lds
    v_dot2c_f32_bf16 v50, s50, v184
    v_dot2c_f32_bf16 v51, v184, v184
    v_dot2c_f32_bf16 v50, s50, v185
    v_dot2c_f32_bf16 v51, v185, v185
    v_dot2c_f32_bf16 v50, s50, v186
    v_dot2c_f32_bf16 v51, v186, v186
    v_dot2c_f32_bf16 v50, s50, v187
    v_dot2c_f32_bf16 v51, v187, v187
    buffer_load_dwordx4 v39, s[8:11], s94 offen offset:3072 lds
    v_dot2c_f32_bf16 v74, s50, v188
    v_dot2c_f32_bf16 v75, v188, v188
    v_dot2c_f32_bf16 v74, s50, v189
    v_dot2c_f32_bf16 v75, v189, v189
    v_dot2c_f32_bf16 v74, s50, v190
    v_dot2c_f32_bf16 v75, v190, v190
    v_dot2c_f32_bf16 v74, s50, v191
    v_dot2c_f32_bf16 v75, v191, v191
    s_waitcnt vmcnt(4)
    ds_read_b128 v[208:211], v40 offset:12288
    ds_read_b128 v[212:215], v41 offset:12288
    ds_read_b128 v[216:219], v42 offset:12288
    ds_read_b128 v[220:223], v43 offset:12288
    s_add_u32 m0, s48, 20480
    s_bfe_u32 s94, s93, 0x40004
    s_lshl_b32 s94, s94, 7
    s_add_u32 s94, s94, s63
    buffer_load_dwordx4 v36, s[8:11], s94 offen offset:0 lds
    s_waitcnt lgkmcnt(4)
    v_dot2c_f32_bf16 v50, s50, v192
    v_dot2c_f32_bf16 v51, v192, v192
    v_dot2c_f32_bf16 v50, s50, v193
    v_dot2c_f32_bf16 v51, v193, v193
    v_dot2c_f32_bf16 v50, s50, v194
    v_dot2c_f32_bf16 v51, v194, v194
    v_dot2c_f32_bf16 v50, s50, v195
    v_dot2c_f32_bf16 v51, v195, v195
    buffer_load_dwordx4 v37, s[8:11], s94 offen offset:1024 lds
    v_dot2c_f32_bf16 v74, s50, v196
    v_dot2c_f32_bf16 v75, v196, v196
    v_dot2c_f32_bf16 v74, s50, v197
    v_dot2c_f32_bf16 v75, v197, v197
    v_dot2c_f32_bf16 v74, s50, v198
    v_dot2c_f32_bf16 v75, v198, v198
    v_dot2c_f32_bf16 v74, s50, v199
    v_dot2c_f32_bf16 v75, v199, v199
    buffer_load_dwordx4 v38, s[8:11], s94 offen offset:2048 lds
    v_dot2c_f32_bf16 v50, s50, v200
    v_dot2c_f32_bf16 v51, v200, v200
    v_dot2c_f32_bf16 v50, s50, v201
    v_dot2c_f32_bf16 v51, v201, v201
    v_dot2c_f32_bf16 v50, s50, v202
    v_dot2c_f32_bf16 v51, v202, v202
    v_dot2c_f32_bf16 v50, s50, v203
    v_dot2c_f32_bf16 v51, v203, v203
    buffer_load_dwordx4 v39, s[8:11], s94 offen offset:3072 lds
    v_dot2c_f32_bf16 v74, s50, v204
    v_dot2c_f32_bf16 v75, v204, v204
    v_dot2c_f32_bf16 v74, s50, v205
    v_dot2c_f32_bf16 v75, v205, v205
    v_dot2c_f32_bf16 v74, s50, v206
    v_dot2c_f32_bf16 v75, v206, v206
    v_dot2c_f32_bf16 v74, s50, v207
    v_dot2c_f32_bf16 v75, v207, v207
    s_waitcnt vmcnt(4)
    ds_read_b128 v[224:227], v40 offset:16384
    ds_read_b128 v[228:231], v41 offset:16384
    ds_read_b128 v[232:235], v42 offset:16384
    ds_read_b128 v[236:239], v43 offset:16384
    s_barrier
    s_add_u32 m0, s48, 0
    s_bfe_u32 s94, s92, 0x40000
    s_mul_i32 s51, s94, 245760
    buffer_load_dwordx4 v32, s[16:19], s51 offen offset:0 lds
    s_waitcnt lgkmcnt(4)
    v_dot2c_f32_bf16 v50, s50, v208
    v_dot2c_f32_bf16 v51, v208, v208
    v_dot2c_f32_bf16 v50, s50, v209
    v_dot2c_f32_bf16 v51, v209, v209
    v_dot2c_f32_bf16 v50, s50, v210
    v_dot2c_f32_bf16 v51, v210, v210
    v_dot2c_f32_bf16 v50, s50, v211
    v_dot2c_f32_bf16 v51, v211, v211
    buffer_load_dwordx4 v33, s[16:19], s51 offen offset:1024 lds
    v_dot2c_f32_bf16 v74, s50, v212
    v_dot2c_f32_bf16 v75, v212, v212
    v_dot2c_f32_bf16 v74, s50, v213
    v_dot2c_f32_bf16 v75, v213, v213
    v_dot2c_f32_bf16 v74, s50, v214
    v_dot2c_f32_bf16 v75, v214, v214
    v_dot2c_f32_bf16 v74, s50, v215
    v_dot2c_f32_bf16 v75, v215, v215
    s_mul_i32 s52, s94, s53
    s_add_u32 s70, s20, s52
    s_addc_u32 s71, s21, 0
    global_load_lds_dwordx4 v34, s[70:71] offset:2048
    v_dot2c_f32_bf16 v50, s50, v216
    v_dot2c_f32_bf16 v51, v216, v216
    v_dot2c_f32_bf16 v50, s50, v217
    v_dot2c_f32_bf16 v51, v217, v217
    v_dot2c_f32_bf16 v50, s50, v218
    v_dot2c_f32_bf16 v51, v218, v218
    v_dot2c_f32_bf16 v50, s50, v219
    v_dot2c_f32_bf16 v51, v219, v219
    global_load_lds_dwordx4 v35, s[70:71] offset:3072
    v_dot2c_f32_bf16 v74, s50, v220
    v_dot2c_f32_bf16 v75, v220, v220
    v_dot2c_f32_bf16 v74, s50, v221
    v_dot2c_f32_bf16 v75, v221, v221
    v_dot2c_f32_bf16 v74, s50, v222
    v_dot2c_f32_bf16 v75, v222, v222
    v_dot2c_f32_bf16 v74, s50, v223
    v_dot2c_f32_bf16 v75, v223, v223
    s_waitcnt vmcnt(4)
    ds_read_b128 v[240:243], v40 offset:20480
    ds_read_b128 v[244:247], v41 offset:20480
    ds_read_b128 v[248:251], v42 offset:20480
    ds_read_b128 v[252:255], v43 offset:20480
    s_add_u32 m0, s48, 4096
    s_add_u32 s70, s24, s52
    s_addc_u32 s71, s25, 0
    global_load_lds_dwordx4 v34, s[70:71] offset:0
    s_waitcnt lgkmcnt(4)
    v_dot2c_f32_bf16 v50, s50, v224
    v_dot2c_f32_bf16 v51, v224, v224
    v_dot2c_f32_bf16 v50, s50, v225
    v_dot2c_f32_bf16 v51, v225, v225
    v_dot2c_f32_bf16 v50, s50, v226
    v_dot2c_f32_bf16 v51, v226, v226
    v_dot2c_f32_bf16 v50, s50, v227
    v_dot2c_f32_bf16 v51, v227, v227
    global_load_lds_dwordx4 v35, s[70:71] offset:1024
    v_dot2c_f32_bf16 v74, s50, v228
    v_dot2c_f32_bf16 v75, v228, v228
    v_dot2c_f32_bf16 v74, s50, v229
    v_dot2c_f32_bf16 v75, v229, v229
    v_dot2c_f32_bf16 v74, s50, v230
    v_dot2c_f32_bf16 v75, v230, v230
    v_dot2c_f32_bf16 v74, s50, v231
    v_dot2c_f32_bf16 v75, v231, v231
    s_add_u32 m0, s48, 6144
    s_bfe_u32 s94, s92, 0x40004
    s_mul_i32 s51, s94, 245760
    buffer_load_dwordx4 v32, s[16:19], s51 offen offset:0 lds
    v_dot2c_f32_bf16 v50, s50, v232
    v_dot2c_f32_bf16 v51, v232, v232
    v_dot2c_f32_bf16 v50, s50, v233
    v_dot2c_f32_bf16 v51, v233, v233
    v_dot2c_f32_bf16 v50, s50, v234
    v_dot2c_f32_bf16 v51, v234, v234
    v_dot2c_f32_bf16 v50, s50, v235
    v_dot2c_f32_bf16 v51, v235, v235
    buffer_load_dwordx4 v33, s[16:19], s51 offen offset:1024 lds
    v_dot2c_f32_bf16 v74, s50, v236
    v_dot2c_f32_bf16 v75, v236, v236
    v_dot2c_f32_bf16 v74, s50, v237
    v_dot2c_f32_bf16 v75, v237, v237
    v_dot2c_f32_bf16 v74, s50, v238
    v_dot2c_f32_bf16 v75, v238, v238
    v_dot2c_f32_bf16 v74, s50, v239
    v_dot2c_f32_bf16 v75, v239, v239
    s_waitcnt lgkmcnt(0)
    s_mul_i32 s52, s94, s53
    s_add_u32 s70, s20, s52
    s_addc_u32 s71, s21, 0
    global_load_lds_dwordx4 v34, s[70:71] offset:2048
    v_dot2c_f32_bf16 v50, s50, v240
    v_dot2c_f32_bf16 v51, v240, v240
    v_dot2c_f32_bf16 v50, s50, v241
    v_dot2c_f32_bf16 v51, v241, v241
    v_dot2c_f32_bf16 v50, s50, v242
    v_dot2c_f32_bf16 v51, v242, v242
    v_dot2c_f32_bf16 v50, s50, v243
    v_dot2c_f32_bf16 v51, v243, v243
    global_load_lds_dwordx4 v35, s[70:71] offset:3072
    v_dot2c_f32_bf16 v74, s50, v244
    v_dot2c_f32_bf16 v75, v244, v244
    v_dot2c_f32_bf16 v74, s50, v245
    v_dot2c_f32_bf16 v75, v245, v245
    v_dot2c_f32_bf16 v74, s50, v246
    v_dot2c_f32_bf16 v75, v246, v246
    v_dot2c_f32_bf16 v74, s50, v247
    v_dot2c_f32_bf16 v75, v247, v247
    s_add_u32 m0, s48, 10240
    s_add_u32 s70, s24, s52
    s_addc_u32 s71, s25, 0
    global_load_lds_dwordx4 v34, s[70:71] offset:0
    v_dot2c_f32_bf16 v50, s50, v248
    v_dot2c_f32_bf16 v51, v248, v248
    v_dot2c_f32_bf16 v50, s50, v249
    v_dot2c_f32_bf16 v51, v249, v249
    v_dot2c_f32_bf16 v50, s50, v250
    v_dot2c_f32_bf16 v51, v250, v250
    v_dot2c_f32_bf16 v50, s50, v251
    v_dot2c_f32_bf16 v51, v251, v251
    global_load_lds_dwordx4 v35, s[70:71] offset:1024
    v_dot2c_f32_bf16 v74, s50, v252
    v_dot2c_f32_bf16 v75, v252, v252
    v_dot2c_f32_bf16 v74, s50, v253
    v_dot2c_f32_bf16 v75, v253, v253
    v_dot2c_f32_bf16 v74, s50, v254
    v_dot2c_f32_bf16 v75, v254, v254
    v_dot2c_f32_bf16 v74, s50, v255
    v_dot2c_f32_bf16 v75, v255, v255
    s_nop 2
    v_permlane16_swap_b32 v50, v74
    v_permlane16_swap_b32 v51, v75
    v_add_f32 v50, v50, v74
    v_add_f32 v51, v51, v75
    v_mov_b32 v52, v50
    v_mov_b32 v53, v51
    s_nop 0
    v_permlane32_swap_b32 v50, v52
    v_permlane32_swap_b32 v51, v53
    v_add_f32 v50, v50, v52
    v_add_f32 v51, v51, v53
    v_mul_f32 v52, 0x3acccccd, v50
    v_mul_f32 v51, 0x3acccccd, v51
    v_fma_f32 v51, -v52, v52, v51
    v_max_f32 v51, 0, v51
    v_cvt_pk_bf16_f32 v52, v52, v52
    v_and_b32 v52, s49, v52
    v_cvt_pk_bf16_f32 v51, v51, v51
    v_and_b32 v51, s49, v51
    v_add_f32 v51, 0x3727c5ac, v51
    v_cvt_pk_bf16_f32 v51, v51, v51
    v_and_b32 v51, s49, v51
    v_sqrt_f32 v51, v51
    s_nop 0
    v_cvt_pk_bf16_f32 v51, v51, v51
    v_and_b32 v51, s49, v51
    v_rcp_f32 v50, v51
    s_nop 0
    v_mul_f32_e64 v51, -v52, v50
    v_mov_b32 v74, v50
    v_mov_b32 v75, v51
    s_nop 0
    v_permlane16_swap_b32 v50, v74
    v_permlane16_swap_b32 v51, v75
    v_lshlrev_b32 v52, 16, v96
    v_lshlrev_b32 v54, 16, v97
    v_and_b32 v53, s49, v96
    v_and_b32 v55, s49, v97
    v_pk_fma_f32 v[52:53], v[52:53], v[50:51], v[50:51] op_sel:[0,0,1] op_sel_hi:[1,0,1]
    v_pk_fma_f32 v[54:55], v[54:55], v[50:51], v[50:51] op_sel:[0,0,1] op_sel_hi:[1,0,1]
    v_cvt_pk_bf16_f32 v96, v52, v53
    v_cvt_pk_bf16_f32 v97, v54, v55
    v_lshlrev_b32 v52, 16, v98
    v_lshlrev_b32 v54, 16, v99
    v_and_b32 v53, s49, v98
    v_and_b32 v55, s49, v99
    v_pk_fma_f32 v[52:53], v[52:53], v[50:51], v[50:51] op_sel:[0,0,1] op_sel_hi:[1,0,1]
    v_pk_fma_f32 v[54:55], v[54:55], v[50:51], v[50:51] op_sel:[0,0,1] op_sel_hi:[1,0,1]
    v_cvt_pk_bf16_f32 v98, v52, v53
    v_cvt_pk_bf16_f32 v99, v54, v55
    v_lshlrev_b32 v52, 16, v100
    v_lshlrev_b32 v54, 16, v101
    v_and_b32 v53, s49, v100
    v_and_b32 v55, s49, v101
    v_pk_fma_f32 v[52:53], v[52:53], v[74:75], v[74:75] op_sel:[0,0,1] op_sel_hi:[1,0,1]
    v_pk_fma_f32 v[54:55], v[54:55], v[74:75], v[74:75] op_sel:[0,0,1] op_sel_hi:[1,0,1]
    v_cvt_pk_bf16_f32 v100, v52, v53
    v_cvt_pk_bf16_f32 v101, v54, v55
    v_lshlrev_b32 v52, 16, v102
    v_lshlrev_b32 v54, 16, v103
    v_and_b32 v53, s49, v102
    v_and_b32 v55, s49, v103
    v_pk_fma_f32 v[52:53], v[52:53], v[74:75], v[74:75] op_sel:[0,0,1] op_sel_hi:[1,0,1]
    v_pk_fma_f32 v[54:55], v[54:55], v[74:75], v[74:75] op_sel:[0,0,1] op_sel_hi:[1,0,1]
    v_cvt_pk_bf16_f32 v102, v52, v53
    v_cvt_pk_bf16_f32 v103, v54, v55
    v_lshlrev_b32 v52, 16, v104
    v_lshlrev_b32 v54, 16, v105
    v_and_b32 v53, s49, v104
    v_and_b32 v55, s49, v105
    v_pk_fma_f32 v[52:53], v[52:53], v[50:51], v[50:51] op_sel:[0,0,1] op_sel_hi:[1,0,1]
    v_pk_fma_f32 v[54:55], v[54:55], v[50:51], v[50:51] op_sel:[0,0,1] op_sel_hi:[1,0,1]
    v_cvt_pk_bf16_f32 v104, v52, v53
    v_cvt_pk_bf16_f32 v105, v54, v55
    v_lshlrev_b32 v52, 16, v106
    v_lshlrev_b32 v54, 16, v107
    v_and_b32 v53, s49, v106
    v_and_b32 v55, s49, v107
    v_pk_fma_f32 v[52:53], v[52:53], v[50:51], v[50:51] op_sel:[0,0,1] op_sel_hi:[1,0,1]
    v_pk_fma_f32 v[54:55], v[54:55], v[50:51], v[50:51] op_sel:[0,0,1] op_sel_hi:[1,0,1]
    v_cvt_pk_bf16_f32 v106, v52, v53
    v_cvt_pk_bf16_f32 v107, v54, v55
    v_lshlrev_b32 v52, 16, v108
    v_lshlrev_b32 v54, 16, v109
    v_and_b32 v53, s49, v108
    v_and_b32 v55, s49, v109
    v_pk_fma_f32 v[52:53], v[52:53], v[74:75], v[74:75] op_sel:[0,0,1] op_sel_hi:[1,0,1]
    v_pk_fma_f32 v[54:55], v[54:55], v[74:75], v[74:75] op_sel:[0,0,1] op_sel_hi:[1,0,1]
    v_cvt_pk_bf16_f32 v108, v52, v53
    v_cvt_pk_bf16_f32 v109, v54, v55
    v_lshlrev_b32 v52, 16, v110
    v_lshlrev_b32 v54, 16, v111
    v_and_b32 v53, s49, v110
    v_and_b32 v55, s49, v111
    v_pk_fma_f32 v[52:53], v[52:53], v[74:75], v[74:75] op_sel:[0,0,1] op_sel_hi:[1,0,1]
    v_pk_fma_f32 v[54:55], v[54:55], v[74:75], v[74:75] op_sel:[0,0,1] op_sel_hi:[1,0,1]
    v_cvt_pk_bf16_f32 v110, v52, v53
    v_cvt_pk_bf16_f32 v111, v54, v55
    v_lshlrev_b32 v52, 16, v112
    v_lshlrev_b32 v54, 16, v113
    v_and_b32 v53, s49, v112
    v_and_b32 v55, s49, v113
    v_pk_fma_f32 v[52:53], v[52:53], v[50:51], v[50:51] op_sel:[0,0,1] op_sel_hi:[1,0,1]
    v_pk_fma_f32 v[54:55], v[54:55], v[50:51], v[50:51] op_sel:[0,0,1] op_sel_hi:[1,0,1]
    v_cvt_pk_bf16_f32 v112, v52, v53
    v_cvt_pk_bf16_f32 v113, v54, v55
    v_lshlrev_b32 v52, 16, v114
    v_lshlrev_b32 v54, 16, v115
    v_and_b32 v53, s49, v114
    v_and_b32 v55, s49, v115
    v_pk_fma_f32 v[52:53], v[52:53], v[50:51], v[50:51] op_sel:[0,0,1] op_sel_hi:[1,0,1]
    v_pk_fma_f32 v[54:55], v[54:55], v[50:51], v[50:51] op_sel:[0,0,1] op_sel_hi:[1,0,1]
    v_cvt_pk_bf16_f32 v114, v52, v53
    v_cvt_pk_bf16_f32 v115, v54, v55
    v_lshlrev_b32 v52, 16, v116
    v_lshlrev_b32 v54, 16, v117
    v_and_b32 v53, s49, v116
    v_and_b32 v55, s49, v117
    v_pk_fma_f32 v[52:53], v[52:53], v[74:75], v[74:75] op_sel:[0,0,1] op_sel_hi:[1,0,1]
    v_pk_fma_f32 v[54:55], v[54:55], v[74:75], v[74:75] op_sel:[0,0,1] op_sel_hi:[1,0,1]
    v_cvt_pk_bf16_f32 v116, v52, v53
    v_cvt_pk_bf16_f32 v117, v54, v55
    v_lshlrev_b32 v52, 16, v118
    v_lshlrev_b32 v54, 16, v119
    v_and_b32 v53, s49, v118
    v_and_b32 v55, s49, v119
    v_pk_fma_f32 v[52:53], v[52:53], v[74:75], v[74:75] op_sel:[0,0,1] op_sel_hi:[1,0,1]
    v_pk_fma_f32 v[54:55], v[54:55], v[74:75], v[74:75] op_sel:[0,0,1] op_sel_hi:[1,0,1]
    v_cvt_pk_bf16_f32 v118, v52, v53
    v_cvt_pk_bf16_f32 v119, v54, v55
    v_lshlrev_b32 v52, 16, v120
    v_lshlrev_b32 v54, 16, v121
    v_and_b32 v53, s49, v120
    v_and_b32 v55, s49, v121
    v_pk_fma_f32 v[52:53], v[52:53], v[50:51], v[50:51] op_sel:[0,0,1] op_sel_hi:[1,0,1]
    v_pk_fma_f32 v[54:55], v[54:55], v[50:51], v[50:51] op_sel:[0,0,1] op_sel_hi:[1,0,1]
    v_cvt_pk_bf16_f32 v120, v52, v53
    v_cvt_pk_bf16_f32 v121, v54, v55
    v_lshlrev_b32 v52, 16, v122
    v_lshlrev_b32 v54, 16, v123
    v_and_b32 v53, s49, v122
    v_and_b32 v55, s49, v123
    v_pk_fma_f32 v[52:53], v[52:53], v[50:51], v[50:51] op_sel:[0,0,1] op_sel_hi:[1,0,1]
    v_pk_fma_f32 v[54:55], v[54:55], v[50:51], v[50:51] op_sel:[0,0,1] op_sel_hi:[1,0,1]
    v_cvt_pk_bf16_f32 v122, v52, v53
    v_cvt_pk_bf16_f32 v123, v54, v55
    v_lshlrev_b32 v52, 16, v124
    v_lshlrev_b32 v54, 16, v125
    v_and_b32 v53, s49, v124
    v_and_b32 v55, s49, v125
    v_pk_fma_f32 v[52:53], v[52:53], v[74:75], v[74:75] op_sel:[0,0,1] op_sel_hi:[1,0,1]
    v_pk_fma_f32 v[54:55], v[54:55], v[74:75], v[74:75] op_sel:[0,0,1] op_sel_hi:[1,0,1]
    v_cvt_pk_bf16_f32 v124, v52, v53
    v_cvt_pk_bf16_f32 v125, v54, v55
    v_lshlrev_b32 v52, 16, v126
    v_lshlrev_b32 v54, 16, v127
    v_and_b32 v53, s49, v126
    v_and_b32 v55, s49, v127
    v_pk_fma_f32 v[52:53], v[52:53], v[74:75], v[74:75] op_sel:[0,0,1] op_sel_hi:[1,0,1]
    v_pk_fma_f32 v[54:55], v[54:55], v[74:75], v[74:75] op_sel:[0,0,1] op_sel_hi:[1,0,1]
    v_cvt_pk_bf16_f32 v126, v52, v53
    v_cvt_pk_bf16_f32 v127, v54, v55
    v_lshlrev_b32 v52, 16, v128
    v_lshlrev_b32 v54, 16, v129
    v_and_b32 v53, s49, v128
    v_and_b32 v55, s49, v129
    v_pk_fma_f32 v[52:53], v[52:53], v[50:51], v[50:51] op_sel:[0,0,1] op_sel_hi:[1,0,1]
    v_pk_fma_f32 v[54:55], v[54:55], v[50:51], v[50:51] op_sel:[0,0,1] op_sel_hi:[1,0,1]
    v_cvt_pk_bf16_f32 v128, v52, v53
    v_cvt_pk_bf16_f32 v129, v54, v55
    v_lshlrev_b32 v52, 16, v130
    v_lshlrev_b32 v54, 16, v131
    v_and_b32 v53, s49, v130
    v_and_b32 v55, s49, v131
    v_pk_fma_f32 v[52:53], v[52:53], v[50:51], v[50:51] op_sel:[0,0,1] op_sel_hi:[1,0,1]
    v_pk_fma_f32 v[54:55], v[54:55], v[50:51], v[50:51] op_sel:[0,0,1] op_sel_hi:[1,0,1]
    v_cvt_pk_bf16_f32 v130, v52, v53
    v_cvt_pk_bf16_f32 v131, v54, v55
    v_lshlrev_b32 v52, 16, v132
    v_lshlrev_b32 v54, 16, v133
    v_and_b32 v53, s49, v132
    v_and_b32 v55, s49, v133
    v_pk_fma_f32 v[52:53], v[52:53], v[74:75], v[74:75] op_sel:[0,0,1] op_sel_hi:[1,0,1]
    v_pk_fma_f32 v[54:55], v[54:55], v[74:75], v[74:75] op_sel:[0,0,1] op_sel_hi:[1,0,1]
    v_cvt_pk_bf16_f32 v132, v52, v53
    v_cvt_pk_bf16_f32 v133, v54, v55
    v_lshlrev_b32 v52, 16, v134
    v_lshlrev_b32 v54, 16, v135
    v_and_b32 v53, s49, v134
    v_and_b32 v55, s49, v135
    v_pk_fma_f32 v[52:53], v[52:53], v[74:75], v[74:75] op_sel:[0,0,1] op_sel_hi:[1,0,1]
    v_pk_fma_f32 v[54:55], v[54:55], v[74:75], v[74:75] op_sel:[0,0,1] op_sel_hi:[1,0,1]
    v_cvt_pk_bf16_f32 v134, v52, v53
    v_cvt_pk_bf16_f32 v135, v54, v55
    v_lshlrev_b32 v52, 16, v136
    v_lshlrev_b32 v54, 16, v137
    v_and_b32 v53, s49, v136
    v_and_b32 v55, s49, v137
    v_pk_fma_f32 v[52:53], v[52:53], v[50:51], v[50:51] op_sel:[0,0,1] op_sel_hi:[1,0,1]
    v_pk_fma_f32 v[54:55], v[54:55], v[50:51], v[50:51] op_sel:[0,0,1] op_sel_hi:[1,0,1]
    v_cvt_pk_bf16_f32 v136, v52, v53
    v_cvt_pk_bf16_f32 v137, v54, v55
    v_lshlrev_b32 v52, 16, v138
    v_lshlrev_b32 v54, 16, v139
    v_and_b32 v53, s49, v138
    v_and_b32 v55, s49, v139
    v_pk_fma_f32 v[52:53], v[52:53], v[50:51], v[50:51] op_sel:[0,0,1] op_sel_hi:[1,0,1]
    v_pk_fma_f32 v[54:55], v[54:55], v[50:51], v[50:51] op_sel:[0,0,1] op_sel_hi:[1,0,1]
    v_cvt_pk_bf16_f32 v138, v52, v53
    v_cvt_pk_bf16_f32 v139, v54, v55
    v_lshlrev_b32 v52, 16, v140
    v_lshlrev_b32 v54, 16, v141
    v_and_b32 v53, s49, v140
    v_and_b32 v55, s49, v141
    v_pk_fma_f32 v[52:53], v[52:53], v[74:75], v[74:75] op_sel:[0,0,1] op_sel_hi:[1,0,1]
    v_pk_fma_f32 v[54:55], v[54:55], v[74:75], v[74:75] op_sel:[0,0,1] op_sel_hi:[1,0,1]
    v_cvt_pk_bf16_f32 v140, v52, v53
    v_cvt_pk_bf16_f32 v141, v54, v55
    v_lshlrev_b32 v52, 16, v142
    v_lshlrev_b32 v54, 16, v143
    v_and_b32 v53, s49, v142
    v_and_b32 v55, s49, v143
    v_pk_fma_f32 v[52:53], v[52:53], v[74:75], v[74:75] op_sel:[0,0,1] op_sel_hi:[1,0,1]
    v_pk_fma_f32 v[54:55], v[54:55], v[74:75], v[74:75] op_sel:[0,0,1] op_sel_hi:[1,0,1]
    v_cvt_pk_bf16_f32 v142, v52, v53
    v_cvt_pk_bf16_f32 v143, v54, v55
    v_lshlrev_b32 v52, 16, v144
    v_lshlrev_b32 v54, 16, v145
    v_and_b32 v53, s49, v144
    v_and_b32 v55, s49, v145
    v_pk_fma_f32 v[52:53], v[52:53], v[50:51], v[50:51] op_sel:[0,0,1] op_sel_hi:[1,0,1]
    v_pk_fma_f32 v[54:55], v[54:55], v[50:51], v[50:51] op_sel:[0,0,1] op_sel_hi:[1,0,1]
    v_cvt_pk_bf16_f32 v144, v52, v53
    v_cvt_pk_bf16_f32 v145, v54, v55
    v_lshlrev_b32 v52, 16, v146
    v_lshlrev_b32 v54, 16, v147
    v_and_b32 v53, s49, v146
    v_and_b32 v55, s49, v147
    v_pk_fma_f32 v[52:53], v[52:53], v[50:51], v[50:51] op_sel:[0,0,1] op_sel_hi:[1,0,1]
    v_pk_fma_f32 v[54:55], v[54:55], v[50:51], v[50:51] op_sel:[0,0,1] op_sel_hi:[1,0,1]
    v_cvt_pk_bf16_f32 v146, v52, v53
    v_cvt_pk_bf16_f32 v147, v54, v55
    v_lshlrev_b32 v52, 16, v148
    v_lshlrev_b32 v54, 16, v149
    v_and_b32 v53, s49, v148
    v_and_b32 v55, s49, v149
    v_pk_fma_f32 v[52:53], v[52:53], v[74:75], v[74:75] op_sel:[0,0,1] op_sel_hi:[1,0,1]
    v_pk_fma_f32 v[54:55], v[54:55], v[74:75], v[74:75] op_sel:[0,0,1] op_sel_hi:[1,0,1]
    v_cvt_pk_bf16_f32 v148, v52, v53
    v_cvt_pk_bf16_f32 v149, v54, v55
    v_lshlrev_b32 v52, 16, v150
    v_lshlrev_b32 v54, 16, v151
    v_and_b32 v53, s49, v150
    v_and_b32 v55, s49, v151
    v_pk_fma_f32 v[52:53], v[52:53], v[74:75], v[74:75] op_sel:[0,0,1] op_sel_hi:[1,0,1]
    v_pk_fma_f32 v[54:55], v[54:55], v[74:75], v[74:75] op_sel:[0,0,1] op_sel_hi:[1,0,1]
    v_cvt_pk_bf16_f32 v150, v52, v53
    v_cvt_pk_bf16_f32 v151, v54, v55
    v_lshlrev_b32 v52, 16, v152
    v_lshlrev_b32 v54, 16, v153
    v_and_b32 v53, s49, v152
    v_and_b32 v55, s49, v153
    v_pk_fma_f32 v[52:53], v[52:53], v[50:51], v[50:51] op_sel:[0,0,1] op_sel_hi:[1,0,1]
    v_pk_fma_f32 v[54:55], v[54:55], v[50:51], v[50:51] op_sel:[0,0,1] op_sel_hi:[1,0,1]
    v_cvt_pk_bf16_f32 v152, v52, v53
    v_cvt_pk_bf16_f32 v153, v54, v55
    v_lshlrev_b32 v52, 16, v154
    v_lshlrev_b32 v54, 16, v155
    v_and_b32 v53, s49, v154
    v_and_b32 v55, s49, v155
    v_pk_fma_f32 v[52:53], v[52:53], v[50:51], v[50:51] op_sel:[0,0,1] op_sel_hi:[1,0,1]
    v_pk_fma_f32 v[54:55], v[54:55], v[50:51], v[50:51] op_sel:[0,0,1] op_sel_hi:[1,0,1]
    v_cvt_pk_bf16_f32 v154, v52, v53
    v_cvt_pk_bf16_f32 v155, v54, v55
    v_lshlrev_b32 v52, 16, v156
    v_lshlrev_b32 v54, 16, v157
    v_and_b32 v53, s49, v156
    v_and_b32 v55, s49, v157
    v_pk_fma_f32 v[52:53], v[52:53], v[74:75], v[74:75] op_sel:[0,0,1] op_sel_hi:[1,0,1]
    v_pk_fma_f32 v[54:55], v[54:55], v[74:75], v[74:75] op_sel:[0,0,1] op_sel_hi:[1,0,1]
    v_cvt_pk_bf16_f32 v156, v52, v53
    v_cvt_pk_bf16_f32 v157, v54, v55
    v_lshlrev_b32 v52, 16, v158
    v_lshlrev_b32 v54, 16, v159
    v_and_b32 v53, s49, v158
    v_and_b32 v55, s49, v159
    v_pk_fma_f32 v[52:53], v[52:53], v[74:75], v[74:75] op_sel:[0,0,1] op_sel_hi:[1,0,1]
    v_pk_fma_f32 v[54:55], v[54:55], v[74:75], v[74:75] op_sel:[0,0,1] op_sel_hi:[1,0,1]
    v_cvt_pk_bf16_f32 v158, v52, v53
    v_cvt_pk_bf16_f32 v159, v54, v55
    v_lshlrev_b32 v52, 16, v160
    v_lshlrev_b32 v54, 16, v161
    v_and_b32 v53, s49, v160
    v_and_b32 v55, s49, v161
    v_pk_fma_f32 v[52:53], v[52:53], v[50:51], v[50:51] op_sel:[0,0,1] op_sel_hi:[1,0,1]
    v_pk_fma_f32 v[54:55], v[54:55], v[50:51], v[50:51] op_sel:[0,0,1] op_sel_hi:[1,0,1]
    v_cvt_pk_bf16_f32 v160, v52, v53
    v_cvt_pk_bf16_f32 v161, v54, v55
    v_lshlrev_b32 v52, 16, v162
    v_lshlrev_b32 v54, 16, v163
    v_and_b32 v53, s49, v162
    v_and_b32 v55, s49, v163
    v_pk_fma_f32 v[52:53], v[52:53], v[50:51], v[50:51] op_sel:[0,0,1] op_sel_hi:[1,0,1]
    v_pk_fma_f32 v[54:55], v[54:55], v[50:51], v[50:51] op_sel:[0,0,1] op_sel_hi:[1,0,1]
    v_cvt_pk_bf16_f32 v162, v52, v53
    v_cvt_pk_bf16_f32 v163, v54, v55
    v_lshlrev_b32 v52, 16, v164
    v_lshlrev_b32 v54, 16, v165
    v_and_b32 v53, s49, v164
    v_and_b32 v55, s49, v165
    v_pk_fma_f32 v[52:53], v[52:53], v[74:75], v[74:75] op_sel:[0,0,1] op_sel_hi:[1,0,1]
    v_pk_fma_f32 v[54:55], v[54:55], v[74:75], v[74:75] op_sel:[0,0,1] op_sel_hi:[1,0,1]
    v_cvt_pk_bf16_f32 v164, v52, v53
    v_cvt_pk_bf16_f32 v165, v54, v55
    v_lshlrev_b32 v52, 16, v166
    v_lshlrev_b32 v54, 16, v167
    v_and_b32 v53, s49, v166
    v_and_b32 v55, s49, v167
    v_pk_fma_f32 v[52:53], v[52:53], v[74:75], v[74:75] op_sel:[0,0,1] op_sel_hi:[1,0,1]
    v_pk_fma_f32 v[54:55], v[54:55], v[74:75], v[74:75] op_sel:[0,0,1] op_sel_hi:[1,0,1]
    v_cvt_pk_bf16_f32 v166, v52, v53
    v_cvt_pk_bf16_f32 v167, v54, v55
    v_lshlrev_b32 v52, 16, v168
    v_lshlrev_b32 v54, 16, v169
    v_and_b32 v53, s49, v168
    v_and_b32 v55, s49, v169
    v_pk_fma_f32 v[52:53], v[52:53], v[50:51], v[50:51] op_sel:[0,0,1] op_sel_hi:[1,0,1]
    v_pk_fma_f32 v[54:55], v[54:55], v[50:51], v[50:51] op_sel:[0,0,1] op_sel_hi:[1,0,1]
    v_cvt_pk_bf16_f32 v168, v52, v53
    v_cvt_pk_bf16_f32 v169, v54, v55
    v_lshlrev_b32 v52, 16, v170
    v_lshlrev_b32 v54, 16, v171
    v_and_b32 v53, s49, v170
    v_and_b32 v55, s49, v171
    v_pk_fma_f32 v[52:53], v[52:53], v[50:51], v[50:51] op_sel:[0,0,1] op_sel_hi:[1,0,1]
    v_pk_fma_f32 v[54:55], v[54:55], v[50:51], v[50:51] op_sel:[0,0,1] op_sel_hi:[1,0,1]
    v_cvt_pk_bf16_f32 v170, v52, v53
    v_cvt_pk_bf16_f32 v171, v54, v55
    v_lshlrev_b32 v52, 16, v172
    v_lshlrev_b32 v54, 16, v173
    v_and_b32 v53, s49, v172
    v_and_b32 v55, s49, v173
    v_pk_fma_f32 v[52:53], v[52:53], v[74:75], v[74:75] op_sel:[0,0,1] op_sel_hi:[1,0,1]
    v_pk_fma_f32 v[54:55], v[54:55], v[74:75], v[74:75] op_sel:[0,0,1] op_sel_hi:[1,0,1]
    v_cvt_pk_bf16_f32 v172, v52, v53
    v_cvt_pk_bf16_f32 v173, v54, v55
    v_lshlrev_b32 v52, 16, v174
    v_lshlrev_b32 v54, 16, v175
    v_and_b32 v53, s49, v174
    v_and_b32 v55, s49, v175
    v_pk_fma_f32 v[52:53], v[52:53], v[74:75], v[74:75] op_sel:[0,0,1] op_sel_hi:[1,0,1]
    v_pk_fma_f32 v[54:55], v[54:55], v[74:75], v[74:75] op_sel:[0,0,1] op_sel_hi:[1,0,1]
    v_cvt_pk_bf16_f32 v174, v52, v53
    v_cvt_pk_bf16_f32 v175, v54, v55
    v_lshlrev_b32 v52, 16, v176
    v_lshlrev_b32 v54, 16, v177
    v_and_b32 v53, s49, v176
    v_and_b32 v55, s49, v177
    v_pk_fma_f32 v[52:53], v[52:53], v[50:51], v[50:51] op_sel:[0,0,1] op_sel_hi:[1,0,1]
    v_pk_fma_f32 v[54:55], v[54:55], v[50:51], v[50:51] op_sel:[0,0,1] op_sel_hi:[1,0,1]
    v_cvt_pk_bf16_f32 v176, v52, v53
    v_cvt_pk_bf16_f32 v177, v54, v55
    v_lshlrev_b32 v52, 16, v178
    v_lshlrev_b32 v54, 16, v179
    v_and_b32 v53, s49, v178
    v_and_b32 v55, s49, v179
    v_pk_fma_f32 v[52:53], v[52:53], v[50:51], v[50:51] op_sel:[0,0,1] op_sel_hi:[1,0,1]
    v_pk_fma_f32 v[54:55], v[54:55], v[50:51], v[50:51] op_sel:[0,0,1] op_sel_hi:[1,0,1]
    v_cvt_pk_bf16_f32 v178, v52, v53
    v_cvt_pk_bf16_f32 v179, v54, v55
    v_lshlrev_b32 v52, 16, v180
    v_lshlrev_b32 v54, 16, v181
    v_and_b32 v53, s49, v180
    v_and_b32 v55, s49, v181
    v_pk_fma_f32 v[52:53], v[52:53], v[74:75], v[74:75] op_sel:[0,0,1] op_sel_hi:[1,0,1]
    v_pk_fma_f32 v[54:55], v[54:55], v[74:75], v[74:75] op_sel:[0,0,1] op_sel_hi:[1,0,1]
    v_cvt_pk_bf16_f32 v180, v52, v53
    v_cvt_pk_bf16_f32 v181, v54, v55
    v_lshlrev_b32 v52, 16, v182
    v_lshlrev_b32 v54, 16, v183
    v_and_b32 v53, s49, v182
    v_and_b32 v55, s49, v183
    v_pk_fma_f32 v[52:53], v[52:53], v[74:75], v[74:75] op_sel:[0,0,1] op_sel_hi:[1,0,1]
    v_pk_fma_f32 v[54:55], v[54:55], v[74:75], v[74:75] op_sel:[0,0,1] op_sel_hi:[1,0,1]
    v_cvt_pk_bf16_f32 v182, v52, v53
    v_cvt_pk_bf16_f32 v183, v54, v55
    v_lshlrev_b32 v52, 16, v184
    v_lshlrev_b32 v54, 16, v185
    v_and_b32 v53, s49, v184
    v_and_b32 v55, s49, v185
    v_pk_fma_f32 v[52:53], v[52:53], v[50:51], v[50:51] op_sel:[0,0,1] op_sel_hi:[1,0,1]
    v_pk_fma_f32 v[54:55], v[54:55], v[50:51], v[50:51] op_sel:[0,0,1] op_sel_hi:[1,0,1]
    v_cvt_pk_bf16_f32 v184, v52, v53
    v_cvt_pk_bf16_f32 v185, v54, v55
    v_lshlrev_b32 v52, 16, v186
    v_lshlrev_b32 v54, 16, v187
    v_and_b32 v53, s49, v186
    v_and_b32 v55, s49, v187
    v_pk_fma_f32 v[52:53], v[52:53], v[50:51], v[50:51] op_sel:[0,0,1] op_sel_hi:[1,0,1]
    v_pk_fma_f32 v[54:55], v[54:55], v[50:51], v[50:51] op_sel:[0,0,1] op_sel_hi:[1,0,1]
    v_cvt_pk_bf16_f32 v186, v52, v53
    v_cvt_pk_bf16_f32 v187, v54, v55
    s_mov_b64 exec, 0
    s_cmp_eq_u32 s3, 0
    s_cbranch_scc1 L_pad0
    s_cmp_eq_u32 s3, 1
    s_cbranch_scc1 L_pad1
    s_cmp_eq_u32 s3, 2
    s_cbranch_scc1 L_pad2
    s_branch L_pad3
.p2align 12
L_body:
L_back:
    s_mov_b64 exec, -1
    s_waitcnt vmcnt(6)
    s_barrier
    ds_read_b64_tr_b16 a[96:97], v2 offset:0
    ds_read_b64_tr_b16 a[98:99], v2 offset:512
    ds_read_b64_tr_b16 a[100:101], v3 offset:0
    ds_read_b64_tr_b16 a[102:103], v3 offset:512
    ds_read_b64_tr_b16 a[104:105], v2 offset:2048
    ds_read_b64_tr_b16 a[106:107], v2 offset:2560
    ds_read_b64_tr_b16 a[108:109], v3 offset:2048
    ds_read_b64_tr_b16 a[110:111], v3 offset:2560
    ds_read_b64_tr_b16 a[112:113], v2 offset:4096
    ds_read_b64_tr_b16 a[114:115], v2 offset:4608
    ds_read_b64_tr_b16 a[116:117], v3 offset:4096
    ds_read_b64_tr_b16 a[118:119], v3 offset:4608
    ds_read_b64_tr_b16 a[120:121], v4 offset:0
    ds_read_b64_tr_b16 a[122:123], v4 offset:512
    ds_read_b64_tr_b16 a[124:125], v5 offset:0
    ds_read_b64_tr_b16 a[126:127], v5 offset:512
    ds_read_b64_tr_b16 a[128:129], v4 offset:2048
    ds_read_b64_tr_b16 a[130:131], v4 offset:2560
    ds_read_b64_tr_b16 a[132:133], v5 offset:2048
    ds_read_b64_tr_b16 a[134:135], v5 offset:2560
    v_lshlrev_b32 v52, 16, v188
    v_lshlrev_b32 v54, 16, v189
    v_and_b32 v53, s49, v188
    v_and_b32 v55, s49, v189
    v_pk_fma_f32 v[52:53], v[52:53], v[74:75], v[74:75] op_sel:[0,0,1] op_sel_hi:[1,0,1]
    v_pk_fma_f32 v[54:55], v[54:55], v[74:75], v[74:75] op_sel:[0,0,1] op_sel_hi:[1,0,1]
    v_cvt_pk_bf16_f32 v188, v52, v53
    v_cvt_pk_bf16_f32 v189, v54, v55
    v_lshlrev_b32 v52, 16, v190
    v_lshlrev_b32 v54, 16, v191
    v_and_b32 v53, s49, v190
    v_and_b32 v55, s49, v191
    v_pk_fma_f32 v[52:53], v[52:53], v[74:75], v[74:75] op_sel:[0,0,1] op_sel_hi:[1,0,1]
    v_pk_fma_f32 v[54:55], v[54:55], v[74:75], v[74:75] op_sel:[0,0,1] op_sel_hi:[1,0,1]
    v_cvt_pk_bf16_f32 v190, v52, v53
    v_cvt_pk_bf16_f32 v191, v54, v55
    s_nop 0
    s_waitcnt lgkmcnt(8)
    v_mfma_f32_16x16x32_bf16 a[0:3], a[96:99], v[96:99], 0
    s_add_u32 m0, s48, 12288
    ds_read_b64_tr_b16 a[136:137], v4 offset:4096
    v_lshlrev_b32 v52, 16, v192
    v_and_b32 v53, s49, v192
    v_mfma_f32_16x16x32_bf16 a[8:11], a[96:99], v[100:103], 0
    ds_read_b64_tr_b16 a[138:139], v4 offset:4608
    v_fma_f32 v52, v52, v50, v51
    v_fma_f32 v53, v53, v50, v51
    v_mfma_f32_16x16x32_bf16 a[16:19], a[100:103], v[96:99], 0
    s_bfe_u32 s94, s92, 0x40008
    ds_read_b64_tr_b16 a[140:141], v5 offset:4096
    v_cvt_pk_bf16_f32 v192, v52, v53
    v_lshlrev_b32 v54, 16, v193
    v_mfma_f32_16x16x32_bf16 a[24:27], a[100:103], v[100:103], 0
    ds_read_b64_tr_b16 a[142:143], v5 offset:4608
    v_and_b32 v55, s49, v193
    v_fma_f32 v54, v54, v50, v51
    v_mfma_f32_16x16x32_bf16 a[32:35], a[104:107], v[96:99], 0
    s_mul_i32 s51, s94, 245760
    ds_read_b64_tr_b16 a[96:97], v6 offset:0
    ds_read_b64_tr_b16 a[98:99], v6 offset:512
    v_fma_f32 v55, v55, v50, v51
    v_mfma_f32_16x16x32_bf16 a[40:43], a[104:107], v[100:103], 0
    buffer_load_dwordx4 v32, s[16:19], s51 offen offset:0 lds
    v_cvt_pk_bf16_f32 v193, v54, v55
    v_mfma_f32_16x16x32_bf16 a[48:51], a[108:111], v[96:99], 0
    ds_read_b64_tr_b16 a[100:101], v7 offset:0
    v_lshlrev_b32 v52, 16, v194
    v_and_b32 v53, s49, v194
    v_mfma_f32_16x16x32_bf16 a[56:59], a[108:111], v[100:103], 0
    ds_read_b64_tr_b16 a[102:103], v7 offset:512
    v_fma_f32 v52, v52, v50, v51
    v_fma_f32 v53, v53, v50, v51
    v_mfma_f32_16x16x32_bf16 a[64:67], a[112:115], v[96:99], 0
    ds_read_b64_tr_b16 a[104:105], v6 offset:2048
    ds_read_b64_tr_b16 a[106:107], v6 offset:2560
    v_cvt_pk_bf16_f32 v194, v52, v53
    v_mfma_f32_16x16x32_bf16 a[72:75], a[112:115], v[100:103], 0
    buffer_load_dwordx4 v33, s[16:19], s51 offen offset:1024 lds
    v_lshlrev_b32 v54, 16, v195
    v_mfma_f32_16x16x32_bf16 a[80:83], a[116:119], v[96:99], 0
    s_waitcnt lgkmcnt(6)
    ds_read_b64_tr_b16 a[108:109], v7 offset:2048
    v_and_b32 v55, s49, v195
    v_fma_f32 v54, v54, v50, v51
    v_mfma_f32_16x16x32_bf16 a[88:91], a[116:119], v[100:103], 0
    ds_read_b64_tr_b16 a[110:111], v7 offset:2560
    v_fma_f32 v55, v55, v50, v51
    v_cvt_pk_bf16_f32 v195, v54, v55
    v_mfma_f32_16x16x32_bf16 a[4:7], a[120:123], v[96:99], 0
    s_mul_i32 s52, s94, s53
    ds_read_b64_tr_b16 a[112:113], v6 offset:4096
    v_lshlrev_b32 v52, 16, v196
    v_and_b32 v53, s49, v196
    v_mfma_f32_16x16x32_bf16 a[12:15], a[120:123], v[100:103], 0
    ds_read_b64_tr_b16 a[114:115], v6 offset:4608
    v_fma_f32 v52, v52, v74, v75
    v_fma_f32 v53, v53, v74, v75
    v_mfma_f32_16x16x32_bf16 a[20:23], a[124:127], v[96:99], 0
    s_add_u32 s70, s20, s52
    ds_read_b64_tr_b16 a[116:117], v7 offset:4096
    ds_read_b64_tr_b16 a[118:119], v7 offset:4608
    v_mfma_f32_16x16x32_bf16 a[28:31], a[124:127], v[100:103], 0
    s_addc_u32 s71, s21, 0
    global_load_lds_dwordx4 v34, s[70:71] offset:2048
    v_cvt_pk_bf16_f32 v196, v52, v53
    v_lshlrev_b32 v54, 16, v197
    v_mfma_f32_16x16x32_bf16 a[36:39], a[128:131], v[96:99], 0
    ds_read_b64_tr_b16 a[120:121], v8 offset:0
    v_and_b32 v55, s49, v197
    v_fma_f32 v54, v54, v74, v75
    v_mfma_f32_16x16x32_bf16 a[44:47], a[128:131], v[100:103], 0
    ds_read_b64_tr_b16 a[122:123], v8 offset:512
    v_fma_f32 v55, v55, v74, v75
    v_cvt_pk_bf16_f32 v197, v54, v55
    v_mfma_f32_16x16x32_bf16 a[52:55], a[132:135], v[96:99], 0
    ds_read_b64_tr_b16 a[124:125], v9 offset:0
    ds_read_b64_tr_b16 a[126:127], v9 offset:512
    v_lshlrev_b32 v52, 16, v198
    v_mfma_f32_16x16x32_bf16 a[60:63], a[132:135], v[100:103], 0
    global_load_lds_dwordx4 v35, s[70:71] offset:3072
    buffer_store_dword v71, v15, s[12:15], 0 offen offset:128 sc1
    v_mfma_f32_16x16x32_bf16 a[68:71], a[136:139], v[96:99], 0
    s_add_u32 m0, s48, 16384
    ds_read_b64_tr_b16 a[128:129], v8 offset:2048
    v_and_b32 v53, s49, v198
    v_fma_f32 v52, v52, v74, v75
    v_mfma_f32_16x16x32_bf16 a[76:79], a[136:139], v[100:103], 0
    ds_read_b64_tr_b16 a[130:131], v8 offset:2560
    v_fma_f32 v53, v53, v74, v75
    v_cvt_pk_bf16_f32 v198, v52, v53
    v_mfma_f32_16x16x32_bf16 a[84:87], a[140:143], v[96:99], 0
    s_waitcnt lgkmcnt(6)
    ds_read_b64_tr_b16 a[132:133], v9 offset:2048
    ds_read_b64_tr_b16 a[134:135], v9 offset:2560
    v_lshlrev_b32 v54, 16, v199
    v_mfma_f32_16x16x32_bf16 a[92:95], a[140:143], v[100:103], 0
    buffer_store_dword v71, v67, s[12:15], 0 offen offset:0 sc1
    v_and_b32 v55, s49, v199
    v_mfma_f32_16x16x32_bf16 a[0:3], a[96:99], v[104:107], a[0:3]
    s_add_u32 s70, s24, s52
    ds_read_b64_tr_b16 a[136:137], v8 offset:4096
    ds_read_b64_tr_b16 a[138:139], v8 offset:4608
    v_mfma_f32_16x16x32_bf16 a[8:11], a[96:99], v[108:111], a[8:11]
    s_addc_u32 s71, s25, 0
    global_load_lds_dwordx4 v34, s[70:71] offset:0
    v_fma_f32 v54, v54, v74, v75
    v_fma_f32 v55, v55, v74, v75
    v_mfma_f32_16x16x32_bf16 a[16:19], a[100:103], v[104:107], a[16:19]
    ds_read_b64_tr_b16 a[140:141], v9 offset:4096
    ds_read_b64_tr_b16 a[142:143], v9 offset:4608
    v_cvt_pk_bf16_f32 v199, v54, v55
    v_mfma_f32_16x16x32_bf16 a[24:27], a[100:103], v[108:111], a[24:27]
    buffer_store_dword v71, v15, s[12:15], 0 offen offset:0 sc1
    v_lshlrev_b32 v52, 16, v200
    v_mfma_f32_16x16x32_bf16 a[32:35], a[104:107], v[104:107], a[32:35]
    s_waitcnt vmcnt(8)
    s_barrier
    v_mfma_f32_16x16x32_bf16 a[40:43], a[104:107], v[108:111], a[40:43]
    ds_read_b64_tr_b16 a[96:97], v2 offset:6144
    ds_read_b64_tr_b16 a[98:99], v2 offset:6656
    v_and_b32 v53, s49, v200
    v_mfma_f32_16x16x32_bf16 a[48:51], a[108:111], v[104:107], a[48:51]
    ds_read_b64_tr_b16 a[100:101], v3 offset:6144
    v_fma_f32 v52, v52, v50, v51
    v_fma_f32 v53, v53, v50, v51
    v_mfma_f32_16x16x32_bf16 a[56:59], a[108:111], v[108:111], a[56:59]
    ds_read_b64_tr_b16 a[102:103], v3 offset:6656
    global_load_lds_dwordx4 v35, s[70:71] offset:1024
    v_cvt_pk_bf16_f32 v200, v52, v53
    v_mfma_f32_16x16x32_bf16 a[64:67], a[112:115], v[104:107], a[64:67]
    s_add_u32 m0, s48, 18432
    ds_read_b64_tr_b16 a[104:105], v2 offset:8192
    v_lshlrev_b32 v54, 16, v201
    v_and_b32 v55, s49, v201
    v_mfma_f32_16x16x32_bf16 a[72:75], a[112:115], v[108:111], a[72:75]
    ds_read_b64_tr_b16 a[106:107], v2 offset:8704
    v_fma_f32 v54, v54, v50, v51
    v_fma_f32 v55, v55, v50, v51
    v_mfma_f32_16x16x32_bf16 a[80:83], a[116:119], v[104:107], a[80:83]
    s_waitcnt lgkmcnt(6)
    ds_read_b64_tr_b16 a[108:109], v3 offset:8192
    v_cvt_pk_bf16_f32 v201, v54, v55
    v_lshlrev_b32 v52, 16, v202
    v_mfma_f32_16x16x32_bf16 a[88:91], a[116:119], v[108:111], a[88:91]
    ds_read_b64_tr_b16 a[110:111], v3 offset:8704
    v_and_b32 v53, s49, v202
    v_fma_f32 v52, v52, v50, v51
    v_mfma_f32_16x16x32_bf16 a[4:7], a[120:123], v[104:107], a[4:7]
    s_bfe_u32 s94, s92, 0x4000c
    ds_read_b64_tr_b16 a[112:113], v2 offset:10240
    v_fma_f32 v53, v53, v50, v51
    v_cvt_pk_bf16_f32 v202, v52, v53
    v_mfma_f32_16x16x32_bf16 a[12:15], a[120:123], v[108:111], a[12:15]
    ds_read_b64_tr_b16 a[114:115], v2 offset:10752
    v_lshlrev_b32 v54, 16, v203
    v_and_b32 v55, s49, v203
    v_mfma_f32_16x16x32_bf16 a[20:23], a[124:127], v[104:107], a[20:23]
    s_mul_i32 s51, s94, 245760
    ds_read_b64_tr_b16 a[116:117], v3 offset:10240
    ds_read_b64_tr_b16 a[118:119], v3 offset:10752
    v_fma_f32 v54, v54, v50, v51
    v_mfma_f32_16x16x32_bf16 a[28:31], a[124:127], v[108:111], a[28:31]
    buffer_load_dwordx4 v32, s[16:19], s51 offen offset:0 lds
    v_fma_f32 v55, v55, v50, v51
    v_mfma_f32_16x16x32_bf16 a[36:39], a[128:131], v[104:107], a[36:39]
    ds_read_b64_tr_b16 a[120:121], v4 offset:6144
    v_cvt_pk_bf16_f32 v203, v54, v55
    v_lshlrev_b32 v52, 16, v204
    v_mfma_f32_16x16x32_bf16 a[44:47], a[128:131], v[108:111], a[44:47]
    ds_read_b64_tr_b16 a[122:123], v4 offset:6656
    v_and_b32 v53, s49, v204
    v_fma_f32 v52, v52, v74, v75
    v_mfma_f32_16x16x32_bf16 a[52:55], a[132:135], v[104:107], a[52:55]
    ds_read_b64_tr_b16 a[124:125], v5 offset:6144
    ds_read_b64_tr_b16 a[126:127], v5 offset:6656
    v_fma_f32 v53, v53, v74, v75
    v_mfma_f32_16x16x32_bf16 a[60:63], a[132:135], v[108:111], a[60:63]
    buffer_load_dwordx4 v33, s[16:19], s51 offen offset:1024 lds
    v_cvt_pk_bf16_f32 v204, v52, v53
    v_mfma_f32_16x16x32_bf16 a[68:71], a[136:139], v[104:107], a[68:71]
    s_mul_i32 s52, s94, s53
    ds_read_b64_tr_b16 a[128:129], v4 offset:8192
    v_lshlrev_b32 v54, 16, v205
    v_and_b32 v55, s49, v205
    v_mfma_f32_16x16x32_bf16 a[76:79], a[136:139], v[108:111], a[76:79]
    ds_read_b64_tr_b16 a[130:131], v4 offset:8704
    v_fma_f32 v54, v54, v74, v75
    v_fma_f32 v55, v55, v74, v75
    v_mfma_f32_16x16x32_bf16 a[84:87], a[140:143], v[104:107], a[84:87]
    s_waitcnt lgkmcnt(6)
    ds_read_b64_tr_b16 a[132:133], v5 offset:8192
    v_cvt_pk_bf16_f32 v205, v54, v55
    v_lshlrev_b32 v52, 16, v206
    v_mfma_f32_16x16x32_bf16 a[92:95], a[140:143], v[108:111], a[92:95]
    ds_read_b64_tr_b16 a[134:135], v5 offset:8704
    v_and_b32 v53, s49, v206
    v_fma_f32 v52, v52, v74, v75
    v_mfma_f32_16x16x32_bf16 a[0:3], a[96:99], v[112:115], a[0:3]
    s_add_u32 s70, s20, s52
    ds_read_b64_tr_b16 a[136:137], v4 offset:10240
    ds_read_b64_tr_b16 a[138:139], v4 offset:10752
    v_mfma_f32_16x16x32_bf16 a[8:11], a[96:99], v[116:119], a[8:11]
    s_addc_u32 s71, s21, 0
    global_load_lds_dwordx4 v34, s[70:71] offset:2048
    v_fma_f32 v53, v53, v74, v75
    v_cvt_pk_bf16_f32 v206, v52, v53
    v_mfma_f32_16x16x32_bf16 a[16:19], a[100:103], v[112:115], a[16:19]
    ds_read_b64_tr_b16 a[140:141], v5 offset:10240
    v_lshlrev_b32 v54, 16, v207
    v_and_b32 v55, s49, v207
    v_mfma_f32_16x16x32_bf16 a[24:27], a[100:103], v[116:119], a[24:27]
    ds_read_b64_tr_b16 a[142:143], v5 offset:10752
    v_fma_f32 v54, v54, v74, v75
    v_fma_f32 v55, v55, v74, v75
    v_mfma_f32_16x16x32_bf16 a[32:35], a[104:107], v[112:115], a[32:35]
    ds_read_b64_tr_b16 a[96:97], v6 offset:6144
    v_cvt_pk_bf16_f32 v207, v54, v55
    v_lshlrev_b32 v52, 16, v208
    v_mfma_f32_16x16x32_bf16 a[40:43], a[104:107], v[116:119], a[40:43]
    ds_read_b64_tr_b16 a[98:99], v6 offset:6656
    global_load_lds_dwordx4 v35, s[70:71] offset:3072
    v_and_b32 v53, s49, v208
    v_mfma_f32_16x16x32_bf16 a[48:51], a[108:111], v[112:115], a[48:51]
    s_add_u32 m0, s48, 22528
    ds_read_b64_tr_b16 a[100:101], v7 offset:6144
    v_fma_f32 v52, v52, v50, v51
    v_fma_f32 v53, v53, v50, v51
    v_mfma_f32_16x16x32_bf16 a[56:59], a[108:111], v[116:119], a[56:59]
    ds_read_b64_tr_b16 a[102:103], v7 offset:6656
    v_cvt_pk_bf16_f32 v208, v52, v53
    v_lshlrev_b32 v54, 16, v209
    v_mfma_f32_16x16x32_bf16 a[64:67], a[112:115], v[112:115], a[64:67]
    s_add_u32 s70, s24, s52
    ds_read_b64_tr_b16 a[104:105], v6 offset:8192
    ds_read_b64_tr_b16 a[106:107], v6 offset:8704
    v_mfma_f32_16x16x32_bf16 a[72:75], a[112:115], v[116:119], a[72:75]
    s_addc_u32 s71, s25, 0
    global_load_lds_dwordx4 v34, s[70:71] offset:0
    v_and_b32 v55, s49, v209
    v_fma_f32 v54, v54, v50, v51
    v_mfma_f32_16x16x32_bf16 a[80:83], a[116:119], v[112:115], a[80:83]
    s_waitcnt lgkmcnt(6)
    ds_read_b64_tr_b16 a[108:109], v7 offset:8192
    v_fma_f32 v55, v55, v50, v51
    v_cvt_pk_bf16_f32 v209, v54, v55
    v_mfma_f32_16x16x32_bf16 a[88:91], a[116:119], v[116:119], a[88:91]
    ds_read_b64_tr_b16 a[110:111], v7 offset:8704
    v_lshlrev_b32 v52, 16, v210
    v_and_b32 v53, s49, v210
    v_mfma_f32_16x16x32_bf16 a[4:7], a[120:123], v[112:115], a[4:7]
    ds_read_b64_tr_b16 a[112:113], v6 offset:10240
    v_fma_f32 v52, v52, v50, v51
    v_fma_f32 v53, v53, v50, v51
    v_mfma_f32_16x16x32_bf16 a[12:15], a[120:123], v[116:119], a[12:15]
    ds_read_b64_tr_b16 a[114:115], v6 offset:10752
    global_load_lds_dwordx4 v35, s[70:71] offset:1024
    v_cvt_pk_bf16_f32 v210, v52, v53
    v_mfma_f32_16x16x32_bf16 a[20:23], a[124:127], v[112:115], a[20:23]
    s_add_u32 m0, s48, 24576
    ds_read_b64_tr_b16 a[116:117], v7 offset:10240
    v_lshlrev_b32 v54, 16, v211
    v_and_b32 v55, s49, v211
    v_mfma_f32_16x16x32_bf16 a[28:31], a[124:127], v[116:119], a[28:31]
    ds_read_b64_tr_b16 a[118:119], v7 offset:10752
    v_fma_f32 v54, v54, v50, v51
    v_fma_f32 v55, v55, v50, v51
    v_mfma_f32_16x16x32_bf16 a[36:39], a[128:131], v[112:115], a[36:39]
    s_bfe_u32 s94, s92, 0x40010
    ds_read_b64_tr_b16 a[120:121], v8 offset:6144
    v_cvt_pk_bf16_f32 v211, v54, v55
    v_lshlrev_b32 v52, 16, v212
    v_mfma_f32_16x16x32_bf16 a[44:47], a[128:131], v[116:119], a[44:47]
    ds_read_b64_tr_b16 a[122:123], v8 offset:6656
    v_and_b32 v53, s49, v212
    v_fma_f32 v52, v52, v74, v75
    v_mfma_f32_16x16x32_bf16 a[52:55], a[132:135], v[112:115], a[52:55]
    s_mul_i32 s51, s94, 245760
    ds_read_b64_tr_b16 a[124:125], v9 offset:6144
    ds_read_b64_tr_b16 a[126:127], v9 offset:6656
    v_fma_f32 v53, v53, v74, v75
    v_mfma_f32_16x16x32_bf16 a[60:63], a[132:135], v[116:119], a[60:63]
    buffer_load_dwordx4 v32, s[16:19], s51 offen offset:0 lds
    v_cvt_pk_bf16_f32 v212, v52, v53
    v_mfma_f32_16x16x32_bf16 a[68:71], a[136:139], v[112:115], a[68:71]
    ds_read_b64_tr_b16 a[128:129], v8 offset:8192
    v_lshlrev_b32 v54, 16, v213
    v_and_b32 v55, s49, v213
    v_mfma_f32_16x16x32_bf16 a[76:79], a[136:139], v[116:119], a[76:79]
    ds_read_b64_tr_b16 a[130:131], v8 offset:8704
    v_fma_f32 v54, v54, v74, v75
    v_fma_f32 v55, v55, v74, v75
    v_mfma_f32_16x16x32_bf16 a[84:87], a[140:143], v[112:115], a[84:87]
    s_waitcnt lgkmcnt(6)
    ds_read_b64_tr_b16 a[132:133], v9 offset:8192
    ds_read_b64_tr_b16 a[134:135], v9 offset:8704
    v_cvt_pk_bf16_f32 v213, v54, v55
    v_mfma_f32_16x16x32_bf16 a[92:95], a[140:143], v[116:119], a[92:95]
    buffer_load_dwordx4 v33, s[16:19], s51 offen offset:1024 lds
    v_lshlrev_b32 v52, 16, v214
    v_mfma_f32_16x16x32_bf16 a[0:3], a[96:99], v[120:123], a[0:3]
    s_mul_i32 s52, s94, s53
    ds_read_b64_tr_b16 a[136:137], v8 offset:10240
    v_and_b32 v53, s49, v214
    v_mfma_f32_16x16x32_bf16 a[8:11], a[96:99], v[124:127], a[8:11]
    ds_read_b64_tr_b16 a[138:139], v8 offset:10752
    v_fma_f32 v52, v52, v74, v75
    v_mfma_f32_16x16x32_bf16 a[16:19], a[100:103], v[120:123], a[16:19]
    s_add_u32 s70, s20, s52
    ds_read_b64_tr_b16 a[140:141], v9 offset:10240
    ds_read_b64_tr_b16 a[142:143], v9 offset:10752
    v_mfma_f32_16x16x32_bf16 a[24:27], a[100:103], v[124:127], a[24:27]
    s_addc_u32 s71, s21, 0
    global_load_lds_dwordx4 v34, s[70:71] offset:2048
    v_fma_f32 v53, v53, v74, v75
    v_mfma_f32_16x16x32_bf16 a[32:35], a[104:107], v[120:123], a[32:35]
    s_waitcnt vmcnt(9)
    s_barrier
    v_mfma_f32_16x16x32_bf16 a[40:43], a[104:107], v[124:127], a[40:43]
    ds_read_b64_tr_b16 a[96:97], v2 offset:12288
    ds_read_b64_tr_b16 a[98:99], v2 offset:12800
    v_mfma_f32_16x16x32_bf16 a[48:51], a[108:111], v[120:123], a[48:51]
    ds_read_b64_tr_b16 a[100:101], v3 offset:12288
    v_cvt_pk_bf16_f32 v214, v52, v53
    v_mfma_f32_16x16x32_bf16 a[56:59], a[108:111], v[124:127], a[56:59]
    ds_read_b64_tr_b16 a[102:103], v3 offset:12800
    global_load_lds_dwordx4 v35, s[70:71] offset:3072
    v_mfma_f32_16x16x32_bf16 a[64:67], a[112:115], v[120:123], a[64:67]
    s_add_u32 m0, s48, 28672
    ds_read_b64_tr_b16 a[104:105], v2 offset:14336
    v_lshlrev_b32 v54, 16, v215
    v_mfma_f32_16x16x32_bf16 a[72:75], a[112:115], v[124:127], a[72:75]
    ds_read_b64_tr_b16 a[106:107], v2 offset:14848
    v_and_b32 v55, s49, v215
    v_mfma_f32_16x16x32_bf16 a[80:83], a[116:119], v[120:123], a[80:83]
    s_waitcnt lgkmcnt(6)
    ds_read_b64_tr_b16 a[108:109], v3 offset:14336
    v_fma_f32 v54, v54, v74, v75
    v_mfma_f32_16x16x32_bf16 a[88:91], a[116:119], v[124:127], a[88:91]
    ds_read_b64_tr_b16 a[110:111], v3 offset:14848
    v_fma_f32 v55, v55, v74, v75
    v_mfma_f32_16x16x32_bf16 a[4:7], a[120:123], v[120:123], a[4:7]
    s_add_u32 s70, s24, s52
    ds_read_b64_tr_b16 a[112:113], v2 offset:16384
    ds_read_b64_tr_b16 a[114:115], v2 offset:16896
    v_mfma_f32_16x16x32_bf16 a[12:15], a[120:123], v[124:127], a[12:15]
    s_addc_u32 s71, s25, 0
    global_load_lds_dwordx4 v34, s[70:71] offset:0
    v_cvt_pk_bf16_f32 v215, v54, v55
    v_mfma_f32_16x16x32_bf16 a[20:23], a[124:127], v[120:123], a[20:23]
    ds_read_b64_tr_b16 a[116:117], v3 offset:16384
    v_lshlrev_b32 v52, 16, v216
    v_mfma_f32_16x16x32_bf16 a[28:31], a[124:127], v[124:127], a[28:31]
    ds_read_b64_tr_b16 a[118:119], v3 offset:16896
    v_and_b32 v53, s49, v216
    v_mfma_f32_16x16x32_bf16 a[36:39], a[128:131], v[120:123], a[36:39]
    ds_read_b64_tr_b16 a[120:121], v4 offset:12288
    v_fma_f32 v52, v52, v50, v51
    v_mfma_f32_16x16x32_bf16 a[44:47], a[128:131], v[124:127], a[44:47]
    ds_read_b64_tr_b16 a[122:123], v4 offset:12800
    global_load_lds_dwordx4 v35, s[70:71] offset:1024
    v_mfma_f32_16x16x32_bf16 a[52:55], a[132:135], v[120:123], a[52:55]
    s_add_u32 m0, s48, 0
    ds_read_b64_tr_b16 a[124:125], v5 offset:12288
    v_fma_f32 v53, v53, v50, v51
    v_mfma_f32_16x16x32_bf16 a[60:63], a[132:135], v[124:127], a[60:63]
    ds_read_b64_tr_b16 a[126:127], v5 offset:12800
    v_cvt_pk_bf16_f32 v216, v52, v53
    v_mfma_f32_16x16x32_bf16 a[68:71], a[136:139], v[120:123], a[68:71]
    s_bfe_u32 s94, s92, 0x40014
    ds_read_b64_tr_b16 a[128:129], v4 offset:14336
    v_lshlrev_b32 v54, 16, v217
    v_mfma_f32_16x16x32_bf16 a[76:79], a[136:139], v[124:127], a[76:79]
    ds_read_b64_tr_b16 a[130:131], v4 offset:14848
    v_and_b32 v55, s49, v217
    v_mfma_f32_16x16x32_bf16 a[84:87], a[140:143], v[120:123], a[84:87]
    s_waitcnt lgkmcnt(6)
    ds_read_b64_tr_b16 a[132:133], v5 offset:14336
    v_fma_f32 v54, v54, v50, v51
    v_mfma_f32_16x16x32_bf16 a[92:95], a[140:143], v[124:127], a[92:95]
    ds_read_b64_tr_b16 a[134:135], v5 offset:14848
    v_fma_f32 v55, v55, v50, v51
    v_mfma_f32_16x16x32_bf16 a[0:3], a[96:99], v[128:131], a[0:3]
    s_mul_i32 s51, s94, 245760
    ds_read_b64_tr_b16 a[136:137], v4 offset:16384
    ds_read_b64_tr_b16 a[138:139], v4 offset:16896
    v_mfma_f32_16x16x32_bf16 a[8:11], a[96:99], v[132:135], a[8:11]
    buffer_load_dwordx4 v32, s[16:19], s51 offen offset:0 lds
    v_mfma_f32_16x16x32_bf16 a[16:19], a[100:103], v[128:131], a[16:19]
    ds_read_b64_tr_b16 a[140:141], v5 offset:16384
    v_cvt_pk_bf16_f32 v217, v54, v55
    v_mfma_f32_16x16x32_bf16 a[24:27], a[100:103], v[132:135], a[24:27]
    ds_read_b64_tr_b16 a[142:143], v5 offset:16896
    v_lshlrev_b32 v52, 16, v218
    v_mfma_f32_16x16x32_bf16 a[32:35], a[104:107], v[128:131], a[32:35]
    ds_read_b64_tr_b16 a[96:97], v6 offset:12288
    ds_read_b64_tr_b16 a[98:99], v6 offset:12800
    v_mfma_f32_16x16x32_bf16 a[40:43], a[104:107], v[132:135], a[40:43]
    buffer_load_dwordx4 v33, s[16:19], s51 offen offset:1024 lds
    v_mfma_f32_16x16x32_bf16 a[48:51], a[108:111], v[128:131], a[48:51]
    s_mul_i32 s52, s94, s53
    ds_read_b64_tr_b16 a[100:101], v7 offset:12288
    v_and_b32 v53, s49, v218
    v_mfma_f32_16x16x32_bf16 a[56:59], a[108:111], v[132:135], a[56:59]
    ds_read_b64_tr_b16 a[102:103], v7 offset:12800
    v_fma_f32 v52, v52, v50, v51
    v_mfma_f32_16x16x32_bf16 a[64:67], a[112:115], v[128:131], a[64:67]
    s_add_u32 s70, s20, s52
    ds_read_b64_tr_b16 a[104:105], v6 offset:14336
    ds_read_b64_tr_b16 a[106:107], v6 offset:14848
    v_mfma_f32_16x16x32_bf16 a[72:75], a[112:115], v[132:135], a[72:75]
    s_addc_u32 s71, s21, 0
    global_load_lds_dwordx4 v34, s[70:71] offset:2048
    v_fma_f32 v53, v53, v50, v51
    v_mfma_f32_16x16x32_bf16 a[80:83], a[116:119], v[128:131], a[80:83]
    s_waitcnt lgkmcnt(6)
    ds_read_b64_tr_b16 a[108:109], v7 offset:14336
    v_cvt_pk_bf16_f32 v218, v52, v53
    v_mfma_f32_16x16x32_bf16 a[88:91], a[116:119], v[132:135], a[88:91]
    ds_read_b64_tr_b16 a[110:111], v7 offset:14848
    v_lshlrev_b32 v54, 16, v219
    v_mfma_f32_16x16x32_bf16 a[4:7], a[120:123], v[128:131], a[4:7]
    ds_read_b64_tr_b16 a[112:113], v6 offset:16384
    v_and_b32 v55, s49, v219
    v_mfma_f32_16x16x32_bf16 a[12:15], a[120:123], v[132:135], a[12:15]
    ds_read_b64_tr_b16 a[114:115], v6 offset:16896
    global_load_lds_dwordx4 v35, s[70:71] offset:3072
    v_mfma_f32_16x16x32_bf16 a[20:23], a[124:127], v[128:131], a[20:23]
    s_add_u32 m0, s48, 4096
    ds_read_b64_tr_b16 a[116:117], v7 offset:16384
    v_fma_f32 v54, v54, v50, v51
    v_mfma_f32_16x16x32_bf16 a[28:31], a[124:127], v[132:135], a[28:31]
    ds_read_b64_tr_b16 a[118:119], v7 offset:16896
    v_fma_f32 v55, v55, v50, v51
    v_mfma_f32_16x16x32_bf16 a[36:39], a[128:131], v[128:131], a[36:39]
    s_add_u32 s70, s24, s52
    ds_read_b64_tr_b16 a[120:121], v8 offset:12288
    ds_read_b64_tr_b16 a[122:123], v8 offset:12800
    v_mfma_f32_16x16x32_bf16 a[44:47], a[128:131], v[132:135], a[44:47]
    s_addc_u32 s71, s25, 0
    global_load_lds_dwordx4 v34, s[70:71] offset:0
    v_cvt_pk_bf16_f32 v219, v54, v55
    v_mfma_f32_16x16x32_bf16 a[52:55], a[132:135], v[128:131], a[52:55]
    ds_read_b64_tr_b16 a[124:125], v9 offset:12288
    v_lshlrev_b32 v52, 16, v220
    v_mfma_f32_16x16x32_bf16 a[60:63], a[132:135], v[132:135], a[60:63]
    ds_read_b64_tr_b16 a[126:127], v9 offset:12800
    v_and_b32 v53, s49, v220
    v_mfma_f32_16x16x32_bf16 a[68:71], a[136:139], v[128:131], a[68:71]
    ds_read_b64_tr_b16 a[128:129], v8 offset:14336
    v_fma_f32 v52, v52, v74, v75
    v_mfma_f32_16x16x32_bf16 a[76:79], a[136:139], v[132:135], a[76:79]
    ds_read_b64_tr_b16 a[130:131], v8 offset:14848
    global_load_lds_dwordx4 v35, s[70:71] offset:1024
    v_mfma_f32_16x16x32_bf16 a[84:87], a[140:143], v[128:131], a[84:87]
    s_waitcnt lgkmcnt(6)
    ds_read_b64_tr_b16 a[132:133], v9 offset:14336
    v_fma_f32 v53, v53, v74, v75
    v_mfma_f32_16x16x32_bf16 a[92:95], a[140:143], v[132:135], a[92:95]
    ds_read_b64_tr_b16 a[134:135], v9 offset:14848
    v_cvt_pk_bf16_f32 v220, v52, v53
    v_mfma_f32_16x16x32_bf16 a[0:3], a[96:99], v[136:139], a[0:3]
    ds_read_b64_tr_b16 a[136:137], v8 offset:16384
    v_lshlrev_b32 v54, 16, v221
    v_mfma_f32_16x16x32_bf16 a[8:11], a[96:99], v[140:143], a[8:11]
    ds_read_b64_tr_b16 a[138:139], v8 offset:16896
    v_and_b32 v55, s49, v221
    v_mfma_f32_16x16x32_bf16 a[16:19], a[100:103], v[136:139], a[16:19]
    ds_read_b64_tr_b16 a[140:141], v9 offset:16384
    v_fma_f32 v54, v54, v74, v75
    v_mfma_f32_16x16x32_bf16 a[24:27], a[100:103], v[140:143], a[24:27]
    ds_read_b64_tr_b16 a[142:143], v9 offset:16896
    v_fma_f32 v55, v55, v74, v75
    v_mfma_f32_16x16x32_bf16 a[32:35], a[104:107], v[136:139], a[32:35]
    s_waitcnt vmcnt(12)
    s_barrier
    v_mfma_f32_16x16x32_bf16 a[40:43], a[104:107], v[140:143], a[40:43]
    ds_read_b64_tr_b16 a[96:97], v2 offset:18432
    ds_read_b64_tr_b16 a[98:99], v2 offset:18944
    v_mfma_f32_16x16x32_bf16 a[48:51], a[108:111], v[136:139], a[48:51]
    s_add_u32 m0, s48, 6144
    ds_read_b64_tr_b16 a[100:101], v3 offset:18432
    v_cvt_pk_bf16_f32 v221, v54, v55
    v_mfma_f32_16x16x32_bf16 a[56:59], a[108:111], v[140:143], a[56:59]
    ds_read_b64_tr_b16 a[102:103], v3 offset:18944
    v_lshlrev_b32 v52, 16, v222
    v_mfma_f32_16x16x32_bf16 a[64:67], a[112:115], v[136:139], a[64:67]
    s_bfe_u32 s94, s92, 0x40018
    ds_read_b64_tr_b16 a[104:105], v2 offset:20480
    v_and_b32 v53, s49, v222
    v_mfma_f32_16x16x32_bf16 a[72:75], a[112:115], v[140:143], a[72:75]
    ds_read_b64_tr_b16 a[106:107], v2 offset:20992
    v_fma_f32 v52, v52, v74, v75
    v_mfma_f32_16x16x32_bf16 a[80:83], a[116:119], v[136:139], a[80:83]
    s_waitcnt lgkmcnt(6)
    ds_read_b64_tr_b16 a[108:109], v3 offset:20480
    v_fma_f32 v53, v53, v74, v75
    v_mfma_f32_16x16x32_bf16 a[88:91], a[116:119], v[140:143], a[88:91]
    ds_read_b64_tr_b16 a[110:111], v3 offset:20992
    v_cvt_pk_bf16_f32 v222, v52, v53
    v_mfma_f32_16x16x32_bf16 a[4:7], a[120:123], v[136:139], a[4:7]
    s_mul_i32 s51, s94, 245760
    ds_read_b64_tr_b16 a[112:113], v2 offset:22528
    ds_read_b64_tr_b16 a[114:115], v2 offset:23040
    v_mfma_f32_16x16x32_bf16 a[12:15], a[120:123], v[140:143], a[12:15]
    buffer_load_dwordx4 v32, s[16:19], s51 offen offset:0 lds
    v_mfma_f32_16x16x32_bf16 a[20:23], a[124:127], v[136:139], a[20:23]
    ds_read_b64_tr_b16 a[116:117], v3 offset:22528
    v_lshlrev_b32 v54, 16, v223
    v_mfma_f32_16x16x32_bf16 a[28:31], a[124:127], v[140:143], a[28:31]
    ds_read_b64_tr_b16 a[118:119], v3 offset:23040
    v_and_b32 v55, s49, v223
    v_mfma_f32_16x16x32_bf16 a[36:39], a[128:131], v[136:139], a[36:39]
    ds_read_b64_tr_b16 a[120:121], v4 offset:18432
    ds_read_b64_tr_b16 a[122:123], v4 offset:18944
    v_mfma_f32_16x16x32_bf16 a[44:47], a[128:131], v[140:143], a[44:47]
    buffer_load_dwordx4 v33, s[16:19], s51 offen offset:1024 lds
    v_mfma_f32_16x16x32_bf16 a[52:55], a[132:135], v[136:139], a[52:55]
    s_mul_i32 s52, s94, s53
    ds_read_b64_tr_b16 a[124:125], v5 offset:18432
    v_fma_f32 v54, v54, v74, v75
    v_mfma_f32_16x16x32_bf16 a[60:63], a[132:135], v[140:143], a[60:63]
    ds_read_b64_tr_b16 a[126:127], v5 offset:18944
    v_fma_f32 v55, v55, v74, v75
    v_mfma_f32_16x16x32_bf16 a[68:71], a[136:139], v[136:139], a[68:71]
    s_add_u32 s70, s20, s52
    ds_read_b64_tr_b16 a[128:129], v4 offset:20480
    ds_read_b64_tr_b16 a[130:131], v4 offset:20992
    v_mfma_f32_16x16x32_bf16 a[76:79], a[136:139], v[140:143], a[76:79]
L_pad0:
    s_cbranch_execz L_pad4
    s_addc_u32 s71, s21, 0
    global_load_lds_dwordx4 v34, s[70:71] offset:2048
    v_cvt_pk_bf16_f32 v223, v54, v55
    v_mfma_f32_16x16x32_bf16 a[84:87], a[140:143], v[136:139], a[84:87]
    s_waitcnt lgkmcnt(6)
    ds_read_b64_tr_b16 a[132:133], v5 offset:20480
    v_lshlrev_b32 v52, 16, v224
    v_mfma_f32_16x16x32_bf16 a[92:95], a[140:143], v[140:143], a[92:95]
    ds_read_b64_tr_b16 a[134:135], v5 offset:20992
    v_and_b32 v53, s49, v224
    v_mfma_f32_16x16x32_bf16 a[0:3], a[96:99], v[144:147], a[0:3]
    ds_read_b64_tr_b16 a[136:137], v4 offset:22528
    v_fma_f32 v52, v52, v50, v51
    v_mfma_f32_16x16x32_bf16 a[8:11], a[96:99], v[148:151], a[8:11]
    ds_read_b64_tr_b16 a[138:139], v4 offset:23040
    global_load_lds_dwordx4 v35, s[70:71] offset:3072
    v_mfma_f32_16x16x32_bf16 a[16:19], a[100:103], v[144:147], a[16:19]
    s_add_u32 m0, s48, 10240
    ds_read_b64_tr_b16 a[140:141], v5 offset:22528
    v_fma_f32 v53, v53, v50, v51
    v_mfma_f32_16x16x32_bf16 a[24:27], a[100:103], v[148:151], a[24:27]
    ds_read_b64_tr_b16 a[142:143], v5 offset:23040
    v_cvt_pk_bf16_f32 v224, v52, v53
    v_mfma_f32_16x16x32_bf16 a[32:35], a[104:107], v[144:147], a[32:35]
    s_add_u32 s70, s24, s52
    ds_read_b64_tr_b16 a[96:97], v6 offset:18432
    ds_read_b64_tr_b16 a[98:99], v6 offset:18944
    v_mfma_f32_16x16x32_bf16 a[40:43], a[104:107], v[148:151], a[40:43]
    s_addc_u32 s71, s25, 0
    global_load_lds_dwordx4 v34, s[70:71] offset:0
    v_lshlrev_b32 v54, 16, v225
    v_mfma_f32_16x16x32_bf16 a[48:51], a[108:111], v[144:147], a[48:51]
    ds_read_b64_tr_b16 a[100:101], v7 offset:18432
    v_and_b32 v55, s49, v225
    v_mfma_f32_16x16x32_bf16 a[56:59], a[108:111], v[148:151], a[56:59]
    ds_read_b64_tr_b16 a[102:103], v7 offset:18944
    v_fma_f32 v54, v54, v50, v51
    v_mfma_f32_16x16x32_bf16 a[64:67], a[112:115], v[144:147], a[64:67]
    ds_read_b64_tr_b16 a[104:105], v6 offset:20480
    v_fma_f32 v55, v55, v50, v51
    v_mfma_f32_16x16x32_bf16 a[72:75], a[112:115], v[148:151], a[72:75]
    ds_read_b64_tr_b16 a[106:107], v6 offset:20992
    global_load_lds_dwordx4 v35, s[70:71] offset:1024
    v_mfma_f32_16x16x32_bf16 a[80:83], a[116:119], v[144:147], a[80:83]
    s_waitcnt lgkmcnt(6)
    ds_read_b64_tr_b16 a[108:109], v7 offset:20480
    v_cvt_pk_bf16_f32 v225, v54, v55
    v_mfma_f32_16x16x32_bf16 a[88:91], a[116:119], v[148:151], a[88:91]
    ds_read_b64_tr_b16 a[110:111], v7 offset:20992
    v_lshlrev_b32 v52, 16, v226
    v_mfma_f32_16x16x32_bf16 a[4:7], a[120:123], v[144:147], a[4:7]
    s_add_u32 m0, s48, 30720
    ds_read_b64_tr_b16 a[112:113], v6 offset:22528
    v_and_b32 v53, s49, v226
    v_mfma_f32_16x16x32_bf16 a[12:15], a[120:123], v[148:151], a[12:15]
    ds_read_b64_tr_b16 a[114:115], v6 offset:23040
    v_fma_f32 v52, v52, v50, v51
    v_mfma_f32_16x16x32_bf16 a[20:23], a[124:127], v[144:147], a[20:23]
    ds_read_b64_tr_b16 a[116:117], v7 offset:22528
    ds_read_b64_tr_b16 a[118:119], v7 offset:23040
    v_mfma_f32_16x16x32_bf16 a[28:31], a[124:127], v[148:151], a[28:31]
    buffer_load_dwordx4 v44, s[36:39], s67 offen offset:0 lds
    v_mfma_f32_16x16x32_bf16 a[36:39], a[128:131], v[144:147], a[36:39]
    ds_read_b64_tr_b16 a[120:121], v8 offset:18432
    v_fma_f32 v53, v53, v50, v51
    v_mfma_f32_16x16x32_bf16 a[44:47], a[128:131], v[148:151], a[44:47]
    ds_read_b64_tr_b16 a[122:123], v8 offset:18944
    v_cvt_pk_bf16_f32 v226, v52, v53
    v_mfma_f32_16x16x32_bf16 a[52:55], a[132:135], v[144:147], a[52:55]
    ds_read_b64_tr_b16 a[124:125], v9 offset:18432
    ds_read_b64_tr_b16 a[126:127], v9 offset:18944
    v_mfma_f32_16x16x32_bf16 a[60:63], a[132:135], v[148:151], a[60:63]
    buffer_load_dwordx4 v45, s[36:39], s67 offen offset:1024 lds
    v_mfma_f32_16x16x32_bf16 a[68:71], a[136:139], v[144:147], a[68:71]
    ds_read_b64_tr_b16 a[128:129], v8 offset:20480
    v_lshlrev_b32 v54, 16, v227
    v_mfma_f32_16x16x32_bf16 a[76:79], a[136:139], v[148:151], a[76:79]
    ds_read_b64_tr_b16 a[130:131], v8 offset:20992
    v_and_b32 v55, s49, v227
    v_mfma_f32_16x16x32_bf16 a[84:87], a[140:143], v[144:147], a[84:87]
    s_waitcnt lgkmcnt(6)
    ds_read_b64_tr_b16 a[132:133], v9 offset:20480
    ds_read_b64_tr_b16 a[134:135], v9 offset:20992
    v_mfma_f32_16x16x32_bf16 a[92:95], a[140:143], v[148:151], a[92:95]
    buffer_load_dwordx4 v46, s[36:39], s67 offen offset:2048 lds
    v_mfma_f32_16x16x32_bf16 a[0:3], a[96:99], v[152:155], a[0:3]
    ds_read_b64_tr_b16 a[136:137], v8 offset:22528
    v_fma_f32 v54, v54, v50, v51
    v_mfma_f32_16x16x32_bf16 a[8:11], a[96:99], v[156:159], a[8:11]
    ds_read_b64_tr_b16 a[138:139], v8 offset:23040
    v_fma_f32 v55, v55, v50, v51
    v_mfma_f32_16x16x32_bf16 a[16:19], a[100:103], v[152:155], a[16:19]
    ds_read_b64_tr_b16 a[140:141], v9 offset:22528
    ds_read_b64_tr_b16 a[142:143], v9 offset:23040
    v_mfma_f32_16x16x32_bf16 a[24:27], a[100:103], v[156:159], a[24:27]
    buffer_load_dwordx4 v47, s[36:39], s67 offen offset:3072 lds
    v_mfma_f32_16x16x32_bf16 a[32:35], a[104:107], v[152:155], a[32:35]
    s_waitcnt vmcnt(16)
    s_barrier
    v_mfma_f32_16x16x32_bf16 a[40:43], a[104:107], v[156:159], a[40:43]
    ds_read_b64_tr_b16 a[96:97], v2 offset:24576
    ds_read_b64_tr_b16 a[98:99], v2 offset:25088
    v_mfma_f32_16x16x32_bf16 a[48:51], a[108:111], v[152:155], a[48:51]
    s_add_u32 m0, s48, 34816
    ds_read_b64_tr_b16 a[100:101], v3 offset:24576
    v_cvt_pk_bf16_f32 v227, v54, v55
    v_mfma_f32_16x16x32_bf16 a[56:59], a[108:111], v[156:159], a[56:59]
    ds_read_b64_tr_b16 a[102:103], v3 offset:25088
    v_lshlrev_b32 v52, 16, v228
    v_mfma_f32_16x16x32_bf16 a[64:67], a[112:115], v[152:155], a[64:67]
    ds_read_b64_tr_b16 a[104:105], v2 offset:26624
    ds_read_b64_tr_b16 a[106:107], v2 offset:27136
    v_mfma_f32_16x16x32_bf16 a[72:75], a[112:115], v[156:159], a[72:75]
    buffer_load_dwordx4 v48, s[36:39], s67 offen offset:0 lds
    v_mfma_f32_16x16x32_bf16 a[80:83], a[116:119], v[152:155], a[80:83]
    s_waitcnt lgkmcnt(6)
    ds_read_b64_tr_b16 a[108:109], v3 offset:26624
    v_and_b32 v53, s49, v228
    v_mfma_f32_16x16x32_bf16 a[88:91], a[116:119], v[156:159], a[88:91]
    ds_read_b64_tr_b16 a[110:111], v3 offset:27136
    v_fma_f32 v52, v52, v74, v75
    v_mfma_f32_16x16x32_bf16 a[4:7], a[120:123], v[152:155], a[4:7]
    s_add_u32 m0, s48, 12288
    ds_read_b64_tr_b16 a[112:113], v2 offset:28672
    v_fma_f32 v53, v53, v74, v75
    v_mfma_f32_16x16x32_bf16 a[12:15], a[120:123], v[156:159], a[12:15]
    ds_read_b64_tr_b16 a[114:115], v2 offset:29184
    v_cvt_pk_bf16_f32 v228, v52, v53
    v_mfma_f32_16x16x32_bf16 a[20:23], a[124:127], v[152:155], a[20:23]
    s_bfe_u32 s94, s92, 0x4001c
    ds_read_b64_tr_b16 a[116:117], v3 offset:28672
    v_lshlrev_b32 v54, 16, v229
    v_mfma_f32_16x16x32_bf16 a[28:31], a[124:127], v[156:159], a[28:31]
    ds_read_b64_tr_b16 a[118:119], v3 offset:29184
    v_and_b32 v55, s49, v229
    v_mfma_f32_16x16x32_bf16 a[36:39], a[128:131], v[152:155], a[36:39]
    s_mul_i32 s51, s94, 245760
    ds_read_b64_tr_b16 a[120:121], v4 offset:24576
    ds_read_b64_tr_b16 a[122:123], v4 offset:25088
    v_mfma_f32_16x16x32_bf16 a[44:47], a[128:131], v[156:159], a[44:47]
    buffer_load_dwordx4 v32, s[16:19], s51 offen offset:0 lds
    v_mfma_f32_16x16x32_bf16 a[52:55], a[132:135], v[152:155], a[52:55]
    ds_read_b64_tr_b16 a[124:125], v5 offset:24576
    v_fma_f32 v54, v54, v74, v75
    v_mfma_f32_16x16x32_bf16 a[60:63], a[132:135], v[156:159], a[60:63]
    ds_read_b64_tr_b16 a[126:127], v5 offset:25088
    v_fma_f32 v55, v55, v74, v75
    v_mfma_f32_16x16x32_bf16 a[68:71], a[136:139], v[152:155], a[68:71]
    ds_read_b64_tr_b16 a[128:129], v4 offset:26624
    ds_read_b64_tr_b16 a[130:131], v4 offset:27136
    v_mfma_f32_16x16x32_bf16 a[76:79], a[136:139], v[156:159], a[76:79]
    buffer_load_dwordx4 v33, s[16:19], s51 offen offset:1024 lds
    v_mfma_f32_16x16x32_bf16 a[84:87], a[140:143], v[152:155], a[84:87]
    s_waitcnt lgkmcnt(6)
    ds_read_b64_tr_b16 a[132:133], v5 offset:26624
    v_cvt_pk_bf16_f32 v229, v54, v55
    v_mfma_f32_16x16x32_bf16 a[92:95], a[140:143], v[156:159], a[92:95]
    ds_read_b64_tr_b16 a[134:135], v5 offset:27136
    v_lshlrev_b32 v52, 16, v230
    v_mfma_f32_16x16x32_bf16 a[0:3], a[96:99], v[160:163], a[0:3]
    s_mul_i32 s52, s94, s53
    ds_read_b64_tr_b16 a[136:137], v4 offset:28672
    v_and_b32 v53, s49, v230
    v_mfma_f32_16x16x32_bf16 a[8:11], a[96:99], v[164:167], a[8:11]
    ds_read_b64_tr_b16 a[138:139], v4 offset:29184
    v_fma_f32 v52, v52, v74, v75
    v_mfma_f32_16x16x32_bf16 a[16:19], a[100:103], v[160:163], a[16:19]
    s_add_u32 s70, s20, s52
    ds_read_b64_tr_b16 a[140:141], v5 offset:28672
    ds_read_b64_tr_b16 a[142:143], v5 offset:29184
    v_mfma_f32_16x16x32_bf16 a[24:27], a[100:103], v[164:167], a[24:27]
    s_addc_u32 s71, s21, 0
    global_load_lds_dwordx4 v34, s[70:71] offset:2048
    v_fma_f32 v53, v53, v74, v75
    v_mfma_f32_16x16x32_bf16 a[32:35], a[104:107], v[160:163], a[32:35]
    ds_read_b64_tr_b16 a[96:97], v6 offset:24576
    v_cvt_pk_bf16_f32 v230, v52, v53
    v_mfma_f32_16x16x32_bf16 a[40:43], a[104:107], v[164:167], a[40:43]
    ds_read_b64_tr_b16 a[98:99], v6 offset:25088
    v_lshlrev_b32 v54, 16, v231
    v_mfma_f32_16x16x32_bf16 a[48:51], a[108:111], v[160:163], a[48:51]
    ds_read_b64_tr_b16 a[100:101], v7 offset:24576
    v_and_b32 v55, s49, v231
    v_mfma_f32_16x16x32_bf16 a[56:59], a[108:111], v[164:167], a[56:59]
    ds_read_b64_tr_b16 a[102:103], v7 offset:25088
    global_load_lds_dwordx4 v35, s[70:71] offset:3072
    v_mfma_f32_16x16x32_bf16 a[64:67], a[112:115], v[160:163], a[64:67]
    s_add_u32 m0, s48, 16384
    ds_read_b64_tr_b16 a[104:105], v6 offset:26624
    v_fma_f32 v54, v54, v74, v75
    v_mfma_f32_16x16x32_bf16 a[72:75], a[112:115], v[164:167], a[72:75]
    ds_read_b64_tr_b16 a[106:107], v6 offset:27136
    v_fma_f32 v55, v55, v74, v75
    v_mfma_f32_16x16x32_bf16 a[80:83], a[116:119], v[160:163], a[80:83]
    s_waitcnt lgkmcnt(6)
    ds_read_b64_tr_b16 a[108:109], v7 offset:26624
    v_cvt_pk_bf16_f32 v231, v54, v55
    v_mfma_f32_16x16x32_bf16 a[88:91], a[116:119], v[164:167], a[88:91]
    ds_read_b64_tr_b16 a[110:111], v7 offset:27136
    v_lshlrev_b32 v52, 16, v232
    v_mfma_f32_16x16x32_bf16 a[4:7], a[120:123], v[160:163], a[4:7]
    s_add_u32 s70, s24, s52
    ds_read_b64_tr_b16 a[112:113], v6 offset:28672
    ds_read_b64_tr_b16 a[114:115], v6 offset:29184
    v_mfma_f32_16x16x32_bf16 a[12:15], a[120:123], v[164:167], a[12:15]
    s_addc_u32 s71, s25, 0
    global_load_lds_dwordx4 v34, s[70:71] offset:0
    v_and_b32 v53, s49, v232
    v_mfma_f32_16x16x32_bf16 a[20:23], a[124:127], v[160:163], a[20:23]
    ds_read_b64_tr_b16 a[116:117], v7 offset:28672
    v_fma_f32 v52, v52, v50, v51
    v_mfma_f32_16x16x32_bf16 a[28:31], a[124:127], v[164:167], a[28:31]
    ds_read_b64_tr_b16 a[118:119], v7 offset:29184
    v_fma_f32 v53, v53, v50, v51
    v_mfma_f32_16x16x32_bf16 a[36:39], a[128:131], v[160:163], a[36:39]
    ds_read_b64_tr_b16 a[120:121], v8 offset:24576
    v_cvt_pk_bf16_f32 v232, v52, v53
    v_mfma_f32_16x16x32_bf16 a[44:47], a[128:131], v[164:167], a[44:47]
    ds_read_b64_tr_b16 a[122:123], v8 offset:25088
    global_load_lds_dwordx4 v35, s[70:71] offset:1024
    v_mfma_f32_16x16x32_bf16 a[52:55], a[132:135], v[160:163], a[52:55]
    ds_read_b64_tr_b16 a[124:125], v9 offset:24576
    v_lshlrev_b32 v54, 16, v233
    v_mfma_f32_16x16x32_bf16 a[60:63], a[132:135], v[164:167], a[60:63]
    ds_read_b64_tr_b16 a[126:127], v9 offset:25088
    v_and_b32 v55, s49, v233
    v_mfma_f32_16x16x32_bf16 a[68:71], a[136:139], v[160:163], a[68:71]
    ds_read_b64_tr_b16 a[128:129], v8 offset:26624
    v_fma_f32 v54, v54, v50, v51
    v_mfma_f32_16x16x32_bf16 a[76:79], a[136:139], v[164:167], a[76:79]
    ds_read_b64_tr_b16 a[130:131], v8 offset:27136
    v_fma_f32 v55, v55, v50, v51
    v_mfma_f32_16x16x32_bf16 a[84:87], a[140:143], v[160:163], a[84:87]
    s_waitcnt lgkmcnt(6)
    ds_read_b64_tr_b16 a[132:133], v9 offset:26624
    v_cvt_pk_bf16_f32 v233, v54, v55
    v_mfma_f32_16x16x32_bf16 a[92:95], a[140:143], v[164:167], a[92:95]
    ds_read_b64_tr_b16 a[134:135], v9 offset:27136
    v_lshlrev_b32 v52, 16, v234
    v_mfma_f32_16x16x32_bf16 a[0:3], a[96:99], v[168:171], a[0:3]
    ds_read_b64_tr_b16 a[136:137], v8 offset:28672
    v_and_b32 v53, s49, v234
    v_mfma_f32_16x16x32_bf16 a[8:11], a[96:99], v[172:175], a[8:11]
    ds_read_b64_tr_b16 a[138:139], v8 offset:29184
    v_fma_f32 v52, v52, v50, v51
    v_mfma_f32_16x16x32_bf16 a[16:19], a[100:103], v[168:171], a[16:19]
    ds_read_b64_tr_b16 a[140:141], v9 offset:28672
    v_fma_f32 v53, v53, v50, v51
    v_mfma_f32_16x16x32_bf16 a[24:27], a[100:103], v[172:175], a[24:27]
    ds_read_b64_tr_b16 a[142:143], v9 offset:29184
    v_cvt_pk_bf16_f32 v234, v52, v53
    v_mfma_f32_16x16x32_bf16 a[32:35], a[104:107], v[168:171], a[32:35]
    s_waitcnt vmcnt(17)
    s_barrier
    v_mfma_f32_16x16x32_bf16 a[40:43], a[104:107], v[172:175], a[40:43]
    ds_read_b64_tr_b16 a[96:97], v2 offset:0
    ds_read_b64_tr_b16 a[98:99], v2 offset:512
    v_mfma_f32_16x16x32_bf16 a[48:51], a[108:111], v[168:171], a[48:51]
    s_add_u32 m0, s48, 18432
    ds_read_b64_tr_b16 a[100:101], v3 offset:0
    v_lshlrev_b32 v54, 16, v235
    v_mfma_f32_16x16x32_bf16 a[56:59], a[108:111], v[172:175], a[56:59]
    ds_read_b64_tr_b16 a[102:103], v3 offset:512
    v_and_b32 v55, s49, v235
    v_mfma_f32_16x16x32_bf16 a[64:67], a[112:115], v[168:171], a[64:67]
    s_bfe_u32 s94, s93, 0x40000
    ds_read_b64_tr_b16 a[104:105], v2 offset:2048
    v_fma_f32 v54, v54, v50, v51
    v_mfma_f32_16x16x32_bf16 a[72:75], a[112:115], v[172:175], a[72:75]
    ds_read_b64_tr_b16 a[106:107], v2 offset:2560
    v_fma_f32 v55, v55, v50, v51
    v_mfma_f32_16x16x32_bf16 a[80:83], a[116:119], v[168:171], a[80:83]
    s_waitcnt lgkmcnt(6)
    ds_read_b64_tr_b16 a[108:109], v3 offset:2048
    ds_read_b64_tr_b16 a[110:111], v3 offset:2560
    v_mfma_f32_16x16x32_bf16 a[88:91], a[116:119], v[172:175], a[88:91]
    buffer_atomic_add v14, v13, s[40:43], 0 offen sc1
    v_mfma_f32_16x16x32_bf16 a[4:7], a[120:123], v[168:171], a[4:7]
    s_mul_i32 s51, s94, 245760
    ds_read_b64_tr_b16 a[112:113], v2 offset:4096
    ds_read_b64_tr_b16 a[114:115], v2 offset:4608
    v_mfma_f32_16x16x32_bf16 a[12:15], a[120:123], v[172:175], a[12:15]
    buffer_load_dwordx4 v32, s[16:19], s51 offen offset:0 lds
    v_mfma_f32_16x16x32_bf16 a[20:23], a[124:127], v[168:171], a[20:23]
    ds_read_b64_tr_b16 a[116:117], v3 offset:4096
    v_cvt_pk_bf16_f32 v235, v54, v55
    v_mfma_f32_16x16x32_bf16 a[28:31], a[124:127], v[172:175], a[28:31]
    ds_read_b64_tr_b16 a[118:119], v3 offset:4608
    v_lshlrev_b32 v52, 16, v236
    v_mfma_f32_16x16x32_bf16 a[36:39], a[128:131], v[168:171], a[36:39]
    ds_read_b64_tr_b16 a[120:121], v4 offset:0
    ds_read_b64_tr_b16 a[122:123], v4 offset:512
    v_mfma_f32_16x16x32_bf16 a[44:47], a[128:131], v[172:175], a[44:47]
    buffer_load_dwordx4 v33, s[16:19], s51 offen offset:1024 lds
    v_mfma_f32_16x16x32_bf16 a[52:55], a[132:135], v[168:171], a[52:55]
    s_mul_i32 s52, s94, s53
    ds_read_b64_tr_b16 a[124:125], v5 offset:0
    v_and_b32 v53, s49, v236
    v_mfma_f32_16x16x32_bf16 a[60:63], a[132:135], v[172:175], a[60:63]
    ds_read_b64_tr_b16 a[126:127], v5 offset:512
    v_fma_f32 v52, v52, v74, v75
    v_mfma_f32_16x16x32_bf16 a[68:71], a[136:139], v[168:171], a[68:71]
    s_add_u32 s70, s20, s52
    ds_read_b64_tr_b16 a[128:129], v4 offset:2048
    ds_read_b64_tr_b16 a[130:131], v4 offset:2560
    v_mfma_f32_16x16x32_bf16 a[76:79], a[136:139], v[172:175], a[76:79]
    s_addc_u32 s71, s21, 0
    global_load_lds_dwordx4 v34, s[70:71] offset:2048
    v_fma_f32 v53, v53, v74, v75
    v_mfma_f32_16x16x32_bf16 a[84:87], a[140:143], v[168:171], a[84:87]
    s_waitcnt lgkmcnt(6)
    ds_read_b64_tr_b16 a[132:133], v5 offset:2048
    v_cvt_pk_bf16_f32 v236, v52, v53
    v_mfma_f32_16x16x32_bf16 a[92:95], a[140:143], v[172:175], a[92:95]
    ds_read_b64_tr_b16 a[134:135], v5 offset:2560
    v_lshlrev_b32 v54, 16, v237
    v_mfma_f32_16x16x32_bf16 a[0:3], a[96:99], v[176:179], a[0:3]
    ds_read_b64_tr_b16 a[136:137], v4 offset:4096
    v_and_b32 v55, s49, v237
    v_mfma_f32_16x16x32_bf16 a[8:11], a[96:99], v[180:183], a[8:11]
    ds_read_b64_tr_b16 a[138:139], v4 offset:4608
    global_load_lds_dwordx4 v35, s[70:71] offset:3072
    v_mfma_f32_16x16x32_bf16 a[16:19], a[100:103], v[176:179], a[16:19]
    s_add_u32 m0, s48, 22528
    ds_read_b64_tr_b16 a[140:141], v5 offset:4096
    v_fma_f32 v54, v54, v74, v75
    v_mfma_f32_16x16x32_bf16 a[24:27], a[100:103], v[180:183], a[24:27]
    ds_read_b64_tr_b16 a[142:143], v5 offset:4608
    v_fma_f32 v55, v55, v74, v75
    v_mfma_f32_16x16x32_bf16 a[32:35], a[104:107], v[176:179], a[32:35]
    s_add_u32 s70, s24, s52
    ds_read_b64_tr_b16 a[96:97], v6 offset:0
    ds_read_b64_tr_b16 a[98:99], v6 offset:512
    v_mfma_f32_16x16x32_bf16 a[40:43], a[104:107], v[180:183], a[40:43]
    s_addc_u32 s71, s25, 0
    global_load_lds_dwordx4 v34, s[70:71] offset:0
    v_cvt_pk_bf16_f32 v237, v54, v55
    v_mfma_f32_16x16x32_bf16 a[48:51], a[108:111], v[176:179], a[48:51]
    ds_read_b64_tr_b16 a[100:101], v7 offset:0
    v_lshlrev_b32 v52, 16, v238
    v_mfma_f32_16x16x32_bf16 a[56:59], a[108:111], v[180:183], a[56:59]
    ds_read_b64_tr_b16 a[102:103], v7 offset:512
    v_and_b32 v53, s49, v238
    v_mfma_f32_16x16x32_bf16 a[64:67], a[112:115], v[176:179], a[64:67]
    ds_read_b64_tr_b16 a[104:105], v6 offset:2048
    v_fma_f32 v52, v52, v74, v75
    v_mfma_f32_16x16x32_bf16 a[72:75], a[112:115], v[180:183], a[72:75]
    ds_read_b64_tr_b16 a[106:107], v6 offset:2560
    global_load_lds_dwordx4 v35, s[70:71] offset:1024
    v_mfma_f32_16x16x32_bf16 a[80:83], a[116:119], v[176:179], a[80:83]
    s_waitcnt lgkmcnt(6)
    ds_read_b64_tr_b16 a[108:109], v7 offset:2048
    v_fma_f32 v53, v53, v74, v75
    v_mfma_f32_16x16x32_bf16 a[88:91], a[116:119], v[180:183], a[88:91]
    ds_read_b64_tr_b16 a[110:111], v7 offset:2560
    global_load_dword v62, v49, s[96:97] offset:0
    v_mfma_f32_16x16x32_bf16 a[4:7], a[120:123], v[176:179], a[4:7]
    ds_read_b64_tr_b16 a[112:113], v6 offset:4096
    v_cvt_pk_bf16_f32 v238, v52, v53
    v_mfma_f32_16x16x32_bf16 a[12:15], a[120:123], v[180:183], a[12:15]
    ds_read_b64_tr_b16 a[114:115], v6 offset:4608
    v_lshlrev_b32 v54, 16, v239
    v_mfma_f32_16x16x32_bf16 a[20:23], a[124:127], v[176:179], a[20:23]
    ds_read_b64_tr_b16 a[116:117], v7 offset:4096
    v_and_b32 v55, s49, v239
    v_mfma_f32_16x16x32_bf16 a[28:31], a[124:127], v[180:183], a[28:31]
    ds_read_b64_tr_b16 a[118:119], v7 offset:4608
    v_fma_f32 v54, v54, v74, v75
    v_mfma_f32_16x16x32_bf16 a[36:39], a[128:131], v[176:179], a[36:39]
    ds_read_b64_tr_b16 a[120:121], v8 offset:0
    v_fma_f32 v55, v55, v74, v75
    v_mfma_f32_16x16x32_bf16 a[44:47], a[128:131], v[180:183], a[44:47]
    ds_read_b64_tr_b16 a[122:123], v8 offset:512
    v_cvt_pk_bf16_f32 v239, v54, v55
    v_mfma_f32_16x16x32_bf16 a[52:55], a[132:135], v[176:179], a[52:55]
    ds_read_b64_tr_b16 a[124:125], v9 offset:0
    v_lshlrev_b32 v52, 16, v240
    v_mfma_f32_16x16x32_bf16 a[60:63], a[132:135], v[180:183], a[60:63]
    ds_read_b64_tr_b16 a[126:127], v9 offset:512
    v_and_b32 v53, s49, v240
    v_mfma_f32_16x16x32_bf16 a[68:71], a[136:139], v[176:179], a[68:71]
    ds_read_b64_tr_b16 a[128:129], v8 offset:2048
    v_fma_f32 v52, v52, v50, v51
    v_mfma_f32_16x16x32_bf16 a[76:79], a[136:139], v[180:183], a[76:79]
    ds_read_b64_tr_b16 a[130:131], v8 offset:2560
    v_fma_f32 v53, v53, v50, v51
    v_mfma_f32_16x16x32_bf16 a[84:87], a[140:143], v[176:179], a[84:87]
    s_waitcnt lgkmcnt(6)
    ds_read_b64_tr_b16 a[132:133], v9 offset:2048
    v_cvt_pk_bf16_f32 v240, v52, v53
    v_mfma_f32_16x16x32_bf16 a[92:95], a[140:143], v[180:183], a[92:95]
    ds_read_b64_tr_b16 a[134:135], v9 offset:2560
    v_lshlrev_b32 v54, 16, v241
    v_mfma_f32_16x16x32_bf16 a[0:3], a[96:99], v[184:187], a[0:3]
    ds_read_b64_tr_b16 a[136:137], v8 offset:4096
    v_and_b32 v55, s49, v241
    v_mfma_f32_16x16x32_bf16 a[8:11], a[96:99], v[188:191], a[8:11]
    ds_read_b64_tr_b16 a[138:139], v8 offset:4608
    v_fma_f32 v54, v54, v50, v51
    v_mfma_f32_16x16x32_bf16 a[16:19], a[100:103], v[184:187], a[16:19]
    ds_read_b64_tr_b16 a[140:141], v9 offset:4096
    v_fma_f32 v55, v55, v50, v51
    v_mfma_f32_16x16x32_bf16 a[24:27], a[100:103], v[188:191], a[24:27]
    ds_read_b64_tr_b16 a[142:143], v9 offset:4608
    v_cvt_pk_bf16_f32 v241, v54, v55
    v_mfma_f32_16x16x32_bf16 a[32:35], a[104:107], v[184:187], a[32:35]
    s_waitcnt vmcnt(19)
    s_barrier
    v_mfma_f32_16x16x32_bf16 a[40:43], a[104:107], v[188:191], a[40:43]
    ds_read_b64_tr_b16 a[96:97], v2 offset:6144
    ds_read_b64_tr_b16 a[98:99], v2 offset:6656
    v_mfma_f32_16x16x32_bf16 a[48:51], a[108:111], v[184:187], a[48:51]
    s_add_u32 m0, s48, 24576
    ds_read_b64_tr_b16 a[100:101], v3 offset:6144
    v_lshlrev_b32 v52, 16, v242
    v_mfma_f32_16x16x32_bf16 a[56:59], a[108:111], v[188:191], a[56:59]
    ds_read_b64_tr_b16 a[102:103], v3 offset:6656
    v_and_b32 v53, s49, v242
    v_mfma_f32_16x16x32_bf16 a[64:67], a[112:115], v[184:187], a[64:67]
    s_bfe_u32 s94, s93, 0x40004
    ds_read_b64_tr_b16 a[104:105], v2 offset:8192
    v_fma_f32 v52, v52, v50, v51
    v_mfma_f32_16x16x32_bf16 a[72:75], a[112:115], v[188:191], a[72:75]
    ds_read_b64_tr_b16 a[106:107], v2 offset:8704
    v_fma_f32 v53, v53, v50, v51
    v_mfma_f32_16x16x32_bf16 a[80:83], a[116:119], v[184:187], a[80:83]
    s_waitcnt lgkmcnt(6)
    ds_read_b64_tr_b16 a[108:109], v3 offset:8192
    v_cvt_pk_bf16_f32 v242, v52, v53
    v_mfma_f32_16x16x32_bf16 a[88:91], a[116:119], v[188:191], a[88:91]
    ds_read_b64_tr_b16 a[110:111], v3 offset:8704
    v_lshlrev_b32 v54, 16, v243
    v_mfma_f32_16x16x32_bf16 a[4:7], a[120:123], v[184:187], a[4:7]
    s_mul_i32 s51, s94, 245760
    ds_read_b64_tr_b16 a[112:113], v2 offset:10240
    ds_read_b64_tr_b16 a[114:115], v2 offset:10752
    v_mfma_f32_16x16x32_bf16 a[12:15], a[120:123], v[188:191], a[12:15]
    buffer_load_dwordx4 v32, s[16:19], s51 offen offset:0 lds
    v_mfma_f32_16x16x32_bf16 a[20:23], a[124:127], v[184:187], a[20:23]
    ds_read_b64_tr_b16 a[116:117], v3 offset:10240
    v_and_b32 v55, s49, v243
    v_mfma_f32_16x16x32_bf16 a[28:31], a[124:127], v[188:191], a[28:31]
    ds_read_b64_tr_b16 a[118:119], v3 offset:10752
    v_fma_f32 v54, v54, v50, v51
    v_mfma_f32_16x16x32_bf16 a[36:39], a[128:131], v[184:187], a[36:39]
    ds_read_b64_tr_b16 a[120:121], v4 offset:6144
    ds_read_b64_tr_b16 a[122:123], v4 offset:6656
    v_mfma_f32_16x16x32_bf16 a[44:47], a[128:131], v[188:191], a[44:47]
    buffer_load_dwordx4 v33, s[16:19], s51 offen offset:1024 lds
    v_mfma_f32_16x16x32_bf16 a[52:55], a[132:135], v[184:187], a[52:55]
    s_mul_i32 s52, s94, s53
    ds_read_b64_tr_b16 a[124:125], v5 offset:6144
    v_fma_f32 v55, v55, v50, v51
    v_mfma_f32_16x16x32_bf16 a[60:63], a[132:135], v[188:191], a[60:63]
    ds_read_b64_tr_b16 a[126:127], v5 offset:6656
    v_cvt_pk_bf16_f32 v243, v54, v55
    v_mfma_f32_16x16x32_bf16 a[68:71], a[136:139], v[184:187], a[68:71]
    s_add_u32 s70, s20, s52
    ds_read_b64_tr_b16 a[128:129], v4 offset:8192
    ds_read_b64_tr_b16 a[130:131], v4 offset:8704
    v_mfma_f32_16x16x32_bf16 a[76:79], a[136:139], v[188:191], a[76:79]
    s_addc_u32 s71, s21, 0
    global_load_lds_dwordx4 v34, s[70:71] offset:2048
    v_lshlrev_b32 v52, 16, v244
    v_mfma_f32_16x16x32_bf16 a[84:87], a[140:143], v[184:187], a[84:87]
    s_waitcnt lgkmcnt(6)
    ds_read_b64_tr_b16 a[132:133], v5 offset:8192
    v_and_b32 v53, s49, v244
    v_mfma_f32_16x16x32_bf16 a[92:95], a[140:143], v[188:191], a[92:95]
    ds_read_b64_tr_b16 a[134:135], v5 offset:8704
    v_fma_f32 v52, v52, v74, v75
    v_mfma_f32_16x16x32_bf16 a[0:3], a[96:99], v[192:195], a[0:3]
    ds_read_b64_tr_b16 a[136:137], v4 offset:10240
    v_fma_f32 v53, v53, v74, v75
    v_mfma_f32_16x16x32_bf16 a[8:11], a[96:99], v[196:199], a[8:11]
    ds_read_b64_tr_b16 a[138:139], v4 offset:10752
    global_load_lds_dwordx4 v35, s[70:71] offset:3072
    v_mfma_f32_16x16x32_bf16 a[16:19], a[100:103], v[192:195], a[16:19]
    s_add_u32 m0, s48, 28672
    ds_read_b64_tr_b16 a[140:141], v5 offset:10240
    v_cvt_pk_bf16_f32 v244, v52, v53
    v_mfma_f32_16x16x32_bf16 a[24:27], a[100:103], v[196:199], a[24:27]
    ds_read_b64_tr_b16 a[142:143], v5 offset:10752
    v_lshlrev_b32 v54, 16, v245
    v_mfma_f32_16x16x32_bf16 a[32:35], a[104:107], v[192:195], a[32:35]
    s_add_u32 s70, s24, s52
    ds_read_b64_tr_b16 a[96:97], v6 offset:6144
    ds_read_b64_tr_b16 a[98:99], v6 offset:6656
    v_mfma_f32_16x16x32_bf16 a[40:43], a[104:107], v[196:199], a[40:43]
    s_addc_u32 s71, s25, 0
    global_load_lds_dwordx4 v34, s[70:71] offset:0
    v_and_b32 v55, s49, v245
    v_mfma_f32_16x16x32_bf16 a[48:51], a[108:111], v[192:195], a[48:51]
    ds_read_b64_tr_b16 a[100:101], v7 offset:6144
    v_fma_f32 v54, v54, v74, v75
    v_mfma_f32_16x16x32_bf16 a[56:59], a[108:111], v[196:199], a[56:59]
    ds_read_b64_tr_b16 a[102:103], v7 offset:6656
    v_fma_f32 v55, v55, v74, v75
    v_mfma_f32_16x16x32_bf16 a[64:67], a[112:115], v[192:195], a[64:67]
    ds_read_b64_tr_b16 a[104:105], v6 offset:8192
    v_cvt_pk_bf16_f32 v245, v54, v55
    v_mfma_f32_16x16x32_bf16 a[72:75], a[112:115], v[196:199], a[72:75]
    ds_read_b64_tr_b16 a[106:107], v6 offset:8704
    global_load_lds_dwordx4 v35, s[70:71] offset:1024
    v_mfma_f32_16x16x32_bf16 a[80:83], a[116:119], v[192:195], a[80:83]
    s_waitcnt lgkmcnt(6)
    ds_read_b64_tr_b16 a[108:109], v7 offset:8192
    v_lshlrev_b32 v52, 16, v246
    v_mfma_f32_16x16x32_bf16 a[88:91], a[116:119], v[196:199], a[88:91]
    ds_read_b64_tr_b16 a[110:111], v7 offset:8704
    v_and_b32 v53, s49, v246
    v_mfma_f32_16x16x32_bf16 a[4:7], a[120:123], v[192:195], a[4:7]
    ds_read_b64_tr_b16 a[112:113], v6 offset:10240
    v_fma_f32 v52, v52, v74, v75
    v_mfma_f32_16x16x32_bf16 a[12:15], a[120:123], v[196:199], a[12:15]
    ds_read_b64_tr_b16 a[114:115], v6 offset:10752
    v_fma_f32 v53, v53, v74, v75
    v_mfma_f32_16x16x32_bf16 a[20:23], a[124:127], v[192:195], a[20:23]
    ds_read_b64_tr_b16 a[116:117], v7 offset:10240
    v_cvt_pk_bf16_f32 v246, v52, v53
    v_mfma_f32_16x16x32_bf16 a[28:31], a[124:127], v[196:199], a[28:31]
    ds_read_b64_tr_b16 a[118:119], v7 offset:10752
    v_lshlrev_b32 v54, 16, v247
    v_mfma_f32_16x16x32_bf16 a[36:39], a[128:131], v[192:195], a[36:39]
    ds_read_b64_tr_b16 a[120:121], v8 offset:6144
    v_and_b32 v55, s49, v247
    v_mfma_f32_16x16x32_bf16 a[44:47], a[128:131], v[196:199], a[44:47]
    ds_read_b64_tr_b16 a[122:123], v8 offset:6656
    v_fma_f32 v54, v54, v74, v75
    v_mfma_f32_16x16x32_bf16 a[52:55], a[132:135], v[192:195], a[52:55]
    ds_read_b64_tr_b16 a[124:125], v9 offset:6144
    v_fma_f32 v55, v55, v74, v75
    v_mfma_f32_16x16x32_bf16 a[60:63], a[132:135], v[196:199], a[60:63]
    ds_read_b64_tr_b16 a[126:127], v9 offset:6656
    v_cvt_pk_bf16_f32 v247, v54, v55
    v_mfma_f32_16x16x32_bf16 a[68:71], a[136:139], v[192:195], a[68:71]
    ds_read_b64_tr_b16 a[128:129], v8 offset:8192
    v_lshlrev_b32 v52, 16, v248
    v_mfma_f32_16x16x32_bf16 a[76:79], a[136:139], v[196:199], a[76:79]
    ds_read_b64_tr_b16 a[130:131], v8 offset:8704
    v_and_b32 v53, s49, v248
    v_mfma_f32_16x16x32_bf16 a[84:87], a[140:143], v[192:195], a[84:87]
    s_waitcnt lgkmcnt(6)
    ds_read_b64_tr_b16 a[132:133], v9 offset:8192
    v_fma_f32 v52, v52, v50, v51
    v_mfma_f32_16x16x32_bf16 a[92:95], a[140:143], v[196:199], a[92:95]
    ds_read_b64_tr_b16 a[134:135], v9 offset:8704
    v_fma_f32 v53, v53, v50, v51
    v_mfma_f32_16x16x32_bf16 a[0:3], a[96:99], v[200:203], a[0:3]
    ds_read_b64_tr_b16 a[136:137], v8 offset:10240
    v_cvt_pk_bf16_f32 v248, v52, v53
    v_mfma_f32_16x16x32_bf16 a[8:11], a[96:99], v[204:207], a[8:11]
    ds_read_b64_tr_b16 a[138:139], v8 offset:10752
    v_lshlrev_b32 v54, 16, v249
    v_mfma_f32_16x16x32_bf16 a[16:19], a[100:103], v[200:203], a[16:19]
    ds_read_b64_tr_b16 a[140:141], v9 offset:10240
    v_and_b32 v55, s49, v249
    v_mfma_f32_16x16x32_bf16 a[24:27], a[100:103], v[204:207], a[24:27]
L_pad1:
    s_cbranch_execz L_pad5
    ds_read_b64_tr_b16 a[142:143], v9 offset:10752
    v_fma_f32 v54, v54, v50, v51
    v_mfma_f32_16x16x32_bf16 a[32:35], a[104:107], v[200:203], a[32:35]
    s_waitcnt vmcnt(14)
    s_barrier
    v_mfma_f32_16x16x32_bf16 a[40:43], a[104:107], v[204:207], a[40:43]
    ds_read_b64_tr_b16 a[96:97], v2 offset:12288
    ds_read_b64_tr_b16 a[98:99], v2 offset:12800
    v_mfma_f32_16x16x32_bf16 a[48:51], a[108:111], v[200:203], a[48:51]
    s_add_u32 m0, s48, 0
    ds_read_b64_tr_b16 a[100:101], v3 offset:12288
    v_fma_f32 v55, v55, v50, v51
    v_mfma_f32_16x16x32_bf16 a[56:59], a[108:111], v[204:207], a[56:59]
    ds_read_b64_tr_b16 a[102:103], v3 offset:12800
    v_cvt_pk_bf16_f32 v249, v54, v55
    v_mfma_f32_16x16x32_bf16 a[64:67], a[112:115], v[200:203], a[64:67]
    s_bfe_u32 s94, s92, 0x40000
    ds_read_b64_tr_b16 a[104:105], v2 offset:14336
    v_lshlrev_b32 v52, 16, v250
    v_mfma_f32_16x16x32_bf16 a[72:75], a[112:115], v[204:207], a[72:75]
    ds_read_b64_tr_b16 a[106:107], v2 offset:14848
    v_and_b32 v53, s49, v250
    v_mfma_f32_16x16x32_bf16 a[80:83], a[116:119], v[200:203], a[80:83]
    s_waitcnt lgkmcnt(6)
    ds_read_b64_tr_b16 a[108:109], v3 offset:14336
    v_fma_f32 v52, v52, v50, v51
    v_mfma_f32_16x16x32_bf16 a[88:91], a[116:119], v[204:207], a[88:91]
    ds_read_b64_tr_b16 a[110:111], v3 offset:14848
    v_fma_f32 v53, v53, v50, v51
    v_mfma_f32_16x16x32_bf16 a[4:7], a[120:123], v[200:203], a[4:7]
    s_mul_i32 s54, s94, 196608
    ds_read_b64_tr_b16 a[112:113], v2 offset:16384
    v_cvt_pk_bf16_f32 v250, v52, v53
    v_mfma_f32_16x16x32_bf16 a[12:15], a[120:123], v[204:207], a[12:15]
    ds_read_b64_tr_b16 a[114:115], v2 offset:16896
    v_lshlrev_b32 v54, 16, v251
    v_mfma_f32_16x16x32_bf16 a[20:23], a[124:127], v[200:203], a[20:23]
    s_add_u32 s70, s28, s54
    ds_read_b64_tr_b16 a[116:117], v3 offset:16384
    ds_read_b64_tr_b16 a[118:119], v3 offset:16896
    v_mfma_f32_16x16x32_bf16 a[28:31], a[124:127], v[204:207], a[28:31]
    s_addc_u32 s71, s29, 0
    global_load_lds_dwordx4 v10, s[70:71] offset:0
    v_and_b32 v55, s49, v251
    v_mfma_f32_16x16x32_bf16 a[36:39], a[128:131], v[200:203], a[36:39]
    ds_read_b64_tr_b16 a[120:121], v4 offset:12288
    v_fma_f32 v54, v54, v50, v51
    v_mfma_f32_16x16x32_bf16 a[44:47], a[128:131], v[204:207], a[44:47]
    ds_read_b64_tr_b16 a[122:123], v4 offset:12800
    v_fma_f32 v55, v55, v50, v51
    v_mfma_f32_16x16x32_bf16 a[52:55], a[132:135], v[200:203], a[52:55]
    ds_read_b64_tr_b16 a[124:125], v5 offset:12288
    v_cvt_pk_bf16_f32 v251, v54, v55
    v_mfma_f32_16x16x32_bf16 a[60:63], a[132:135], v[204:207], a[60:63]
    ds_read_b64_tr_b16 a[126:127], v5 offset:12800
    global_load_lds_dwordx4 v11, s[70:71] offset:1024
    v_mfma_f32_16x16x32_bf16 a[68:71], a[136:139], v[200:203], a[68:71]
    ds_read_b64_tr_b16 a[128:129], v4 offset:14336
    v_lshlrev_b32 v52, 16, v252
    v_mfma_f32_16x16x32_bf16 a[76:79], a[136:139], v[204:207], a[76:79]
    ds_read_b64_tr_b16 a[130:131], v4 offset:14848
    v_and_b32 v53, s49, v252
    v_mfma_f32_16x16x32_bf16 a[84:87], a[140:143], v[200:203], a[84:87]
    s_waitcnt lgkmcnt(6)
    ds_read_b64_tr_b16 a[132:133], v5 offset:14336
    v_fma_f32 v52, v52, v74, v75
    v_mfma_f32_16x16x32_bf16 a[92:95], a[140:143], v[204:207], a[92:95]
    ds_read_b64_tr_b16 a[134:135], v5 offset:14848
    v_fma_f32 v53, v53, v74, v75
    v_mfma_f32_16x16x32_bf16 a[0:3], a[96:99], v[208:211], a[0:3]
    s_add_u32 s70, s32, s54
    ds_read_b64_tr_b16 a[136:137], v4 offset:16384
    ds_read_b64_tr_b16 a[138:139], v4 offset:16896
    v_mfma_f32_16x16x32_bf16 a[8:11], a[96:99], v[212:215], a[8:11]
    s_addc_u32 s71, s33, 0
    global_load_lds_dwordx4 v10, s[70:71] offset:2048
    v_cvt_pk_bf16_f32 v252, v52, v53
    v_mfma_f32_16x16x32_bf16 a[16:19], a[100:103], v[208:211], a[16:19]
    ds_read_b64_tr_b16 a[140:141], v5 offset:16384
    v_lshlrev_b32 v54, 16, v253
    v_mfma_f32_16x16x32_bf16 a[24:27], a[100:103], v[212:215], a[24:27]
    ds_read_b64_tr_b16 a[142:143], v5 offset:16896
    v_and_b32 v55, s49, v253
    v_mfma_f32_16x16x32_bf16 a[32:35], a[104:107], v[208:211], a[32:35]
    ds_read_b64_tr_b16 a[96:97], v6 offset:12288
    v_fma_f32 v54, v54, v74, v75
    v_mfma_f32_16x16x32_bf16 a[40:43], a[104:107], v[212:215], a[40:43]
    ds_read_b64_tr_b16 a[98:99], v6 offset:12800
    global_load_lds_dwordx4 v11, s[70:71] offset:3072
    v_mfma_f32_16x16x32_bf16 a[48:51], a[108:111], v[208:211], a[48:51]
    ds_read_b64_tr_b16 a[100:101], v7 offset:12288
    v_fma_f32 v55, v55, v74, v75
    v_mfma_f32_16x16x32_bf16 a[56:59], a[108:111], v[212:215], a[56:59]
    ds_read_b64_tr_b16 a[102:103], v7 offset:12800
    v_cvt_pk_bf16_f32 v253, v54, v55
    v_mfma_f32_16x16x32_bf16 a[64:67], a[112:115], v[208:211], a[64:67]
    ds_read_b64_tr_b16 a[104:105], v6 offset:14336
    v_lshlrev_b32 v52, 16, v254
    v_mfma_f32_16x16x32_bf16 a[72:75], a[112:115], v[212:215], a[72:75]
    ds_read_b64_tr_b16 a[106:107], v6 offset:14848
    v_and_b32 v53, s49, v254
    v_mfma_f32_16x16x32_bf16 a[80:83], a[116:119], v[208:211], a[80:83]
    s_waitcnt lgkmcnt(6)
    ds_read_b64_tr_b16 a[108:109], v7 offset:14336
    v_fma_f32 v52, v52, v74, v75
    v_mfma_f32_16x16x32_bf16 a[88:91], a[116:119], v[212:215], a[88:91]
    ds_read_b64_tr_b16 a[110:111], v7 offset:14848
    v_fma_f32 v53, v53, v74, v75
    v_mfma_f32_16x16x32_bf16 a[4:7], a[120:123], v[208:211], a[4:7]
    ds_read_b64_tr_b16 a[112:113], v6 offset:16384
    v_cvt_pk_bf16_f32 v254, v52, v53
    v_mfma_f32_16x16x32_bf16 a[12:15], a[120:123], v[212:215], a[12:15]
    ds_read_b64_tr_b16 a[114:115], v6 offset:16896
    v_lshlrev_b32 v54, 16, v255
    v_mfma_f32_16x16x32_bf16 a[20:23], a[124:127], v[208:211], a[20:23]
    ds_read_b64_tr_b16 a[116:117], v7 offset:16384
    v_and_b32 v55, s49, v255
    v_mfma_f32_16x16x32_bf16 a[28:31], a[124:127], v[212:215], a[28:31]
    ds_read_b64_tr_b16 a[118:119], v7 offset:16896
    v_fma_f32 v54, v54, v74, v75
    v_mfma_f32_16x16x32_bf16 a[36:39], a[128:131], v[208:211], a[36:39]
    ds_read_b64_tr_b16 a[120:121], v8 offset:12288
    v_fma_f32 v55, v55, v74, v75
    v_mfma_f32_16x16x32_bf16 a[44:47], a[128:131], v[212:215], a[44:47]
    ds_read_b64_tr_b16 a[122:123], v8 offset:12800
    v_cvt_pk_bf16_f32 v255, v54, v55
    v_mfma_f32_16x16x32_bf16 a[52:55], a[132:135], v[208:211], a[52:55]
    ds_read_b64_tr_b16 a[124:125], v9 offset:12288
    v_accvgpr_write_b32 a242, v13
    v_mfma_f32_16x16x32_bf16 a[60:63], a[132:135], v[212:215], a[60:63]
    ds_read_b64_tr_b16 a[126:127], v9 offset:12800
    v_lshrrev_b32 v13, 4, v0
    v_mfma_f32_16x16x32_bf16 a[68:71], a[136:139], v[208:211], a[68:71]
    ds_read_b64_tr_b16 a[128:129], v8 offset:14336
    v_mul_u32_u24 v13, 256, v13
    v_mfma_f32_16x16x32_bf16 a[76:79], a[136:139], v[212:215], a[76:79]
    ds_read_b64_tr_b16 a[130:131], v8 offset:14848
    v_add_u32 v13, v13, v1
    v_mfma_f32_16x16x32_bf16 a[84:87], a[140:143], v[208:211], a[84:87]
    s_waitcnt lgkmcnt(6)
    ds_read_b64_tr_b16 a[132:133], v9 offset:14336
    v_mfma_f32_16x16x32_bf16 a[92:95], a[140:143], v[212:215], a[92:95]
    ds_read_b64_tr_b16 a[134:135], v9 offset:14848
    v_mfma_f32_16x16x32_bf16 a[0:3], a[96:99], v[216:219], a[0:3]
    ds_read_b64_tr_b16 a[136:137], v8 offset:16384
    v_mfma_f32_16x16x32_bf16 a[8:11], a[96:99], v[220:223], a[8:11]
    ds_read_b64_tr_b16 a[138:139], v8 offset:16896
    v_mfma_f32_16x16x32_bf16 a[16:19], a[100:103], v[216:219], a[16:19]
    ds_read_b64_tr_b16 a[140:141], v9 offset:16384
    v_mfma_f32_16x16x32_bf16 a[24:27], a[100:103], v[220:223], a[24:27]
    ds_read_b64_tr_b16 a[142:143], v9 offset:16896
    v_mfma_f32_16x16x32_bf16 a[32:35], a[104:107], v[216:219], a[32:35]
    s_waitcnt vmcnt(4)
    s_barrier
    v_mfma_f32_16x16x32_bf16 a[40:43], a[104:107], v[220:223], a[40:43]
    ds_read_b64_tr_b16 a[96:97], v2 offset:18432
    ds_read_b64_tr_b16 a[98:99], v2 offset:18944
    v_mfma_f32_16x16x32_bf16 a[48:51], a[108:111], v[216:219], a[48:51]
    s_add_u32 m0, s48, 4096
    ds_read_b64_tr_b16 a[100:101], v4 offset:18432
    v_mfma_f32_16x16x32_bf16 a[56:59], a[108:111], v[220:223], a[56:59]
    ds_read_b64_tr_b16 a[102:103], v4 offset:18944
    v_mfma_f32_16x16x32_bf16 a[64:67], a[112:115], v[216:219], a[64:67]
    s_bfe_u32 s94, s92, 0x40004
    ds_read_b64_tr_b16 a[104:105], v6 offset:18432
    v_mfma_f32_16x16x32_bf16 a[72:75], a[112:115], v[220:223], a[72:75]
    ds_read_b64_tr_b16 a[106:107], v6 offset:18944
    v_mfma_f32_16x16x32_bf16 a[80:83], a[116:119], v[216:219], a[80:83]
    s_waitcnt lgkmcnt(6)
    ds_read_b64_tr_b16 a[108:109], v8 offset:18432
    v_mfma_f32_16x16x32_bf16 a[88:91], a[116:119], v[220:223], a[88:91]
    ds_read_b64_tr_b16 a[110:111], v8 offset:18944
    v_mfma_f32_16x16x32_bf16 a[4:7], a[120:123], v[216:219], a[4:7]
    s_mul_i32 s54, s94, 196608
    ds_read_b64_tr_b16 a[112:113], v2 offset:24576
    v_mfma_f32_16x16x32_bf16 a[12:15], a[120:123], v[220:223], a[12:15]
    ds_read_b64_tr_b16 a[114:115], v2 offset:25088
    v_mfma_f32_16x16x32_bf16 a[20:23], a[124:127], v[216:219], a[20:23]
    s_add_u32 s70, s28, s54
    ds_read_b64_tr_b16 a[116:117], v4 offset:24576
    ds_read_b64_tr_b16 a[118:119], v4 offset:25088
    v_mfma_f32_16x16x32_bf16 a[28:31], a[124:127], v[220:223], a[28:31]
    s_addc_u32 s71, s29, 0
    global_load_lds_dwordx4 v10, s[70:71] offset:0
    v_mfma_f32_16x16x32_bf16 a[36:39], a[128:131], v[216:219], a[36:39]
    ds_read_b64_tr_b16 a[120:121], v6 offset:24576
    v_mfma_f32_16x16x32_bf16 a[44:47], a[128:131], v[220:223], a[44:47]
    ds_read_b64_tr_b16 a[122:123], v6 offset:25088
    v_mfma_f32_16x16x32_bf16 a[52:55], a[132:135], v[216:219], a[52:55]
    ds_read_b64_tr_b16 a[124:125], v8 offset:24576
    v_mfma_f32_16x16x32_bf16 a[60:63], a[132:135], v[220:223], a[60:63]
    ds_read_b64_tr_b16 a[126:127], v8 offset:25088
    global_load_lds_dwordx4 v11, s[70:71] offset:1024
    v_mfma_f32_16x16x32_bf16 a[68:71], a[136:139], v[216:219], a[68:71]
    ds_read_b64_tr_b16 a[128:129], v3 offset:18432
    v_mfma_f32_16x16x32_bf16 a[76:79], a[136:139], v[220:223], a[76:79]
    ds_read_b64_tr_b16 a[130:131], v3 offset:18944
    v_mfma_f32_16x16x32_bf16 a[84:87], a[140:143], v[216:219], a[84:87]
    s_waitcnt lgkmcnt(6)
    ds_read_b64_tr_b16 a[132:133], v5 offset:18432
    v_mfma_f32_16x16x32_bf16 a[92:95], a[140:143], v[220:223], a[92:95]
    ds_read_b64_tr_b16 a[134:135], v5 offset:18944
    v_mfma_f32_16x16x32_bf16 a[0:3], a[96:99], v[224:227], a[0:3]
    s_add_u32 s70, s32, s54
    ds_read_b64_tr_b16 a[136:137], v7 offset:18432
    ds_read_b64_tr_b16 a[138:139], v7 offset:18944
    v_mfma_f32_16x16x32_bf16 a[8:11], a[96:99], v[228:231], a[8:11]
    s_addc_u32 s71, s33, 0
    global_load_lds_dwordx4 v10, s[70:71] offset:2048
    v_mfma_f32_16x16x32_bf16 a[4:7], a[100:103], v[224:227], a[4:7]
    ds_read_b64_tr_b16 a[140:141], v9 offset:18432
    v_mfma_f32_16x16x32_bf16 a[12:15], a[100:103], v[228:231], a[12:15]
    ds_read_b64_tr_b16 a[142:143], v9 offset:18944
    v_mfma_f32_16x16x32_bf16 a[0:3], a[104:107], v[232:235], a[0:3]
    ds_read_b64_tr_b16 a[96:97], v3 offset:24576
    v_mfma_f32_16x16x32_bf16 a[8:11], a[104:107], v[236:239], a[8:11]
    ds_read_b64_tr_b16 a[98:99], v3 offset:25088
    global_load_lds_dwordx4 v11, s[70:71] offset:3072
    v_mfma_f32_16x16x32_bf16 a[4:7], a[108:111], v[232:235], a[4:7]
    s_add_u32 m0, s48, 8192
    ds_read_b64_tr_b16 a[100:101], v5 offset:24576
    v_mfma_f32_16x16x32_bf16 a[12:15], a[108:111], v[236:239], a[12:15]
    ds_read_b64_tr_b16 a[102:103], v5 offset:25088
    v_mfma_f32_16x16x32_bf16 a[0:3], a[112:115], v[240:243], a[0:3]
    s_bfe_u32 s94, s92, 0x40008
    ds_read_b64_tr_b16 a[104:105], v7 offset:24576
    v_mfma_f32_16x16x32_bf16 a[8:11], a[112:115], v[244:247], a[8:11]
    ds_read_b64_tr_b16 a[106:107], v7 offset:25088
    v_mfma_f32_16x16x32_bf16 a[4:7], a[116:119], v[240:243], a[4:7]
    s_waitcnt lgkmcnt(6)
    ds_read_b64_tr_b16 a[108:109], v9 offset:24576
    v_mfma_f32_16x16x32_bf16 a[12:15], a[116:119], v[244:247], a[12:15]
    ds_read_b64_tr_b16 a[110:111], v9 offset:25088
    s_add_u32 s64, s56, 4096
    s_cmp_eq_u32 s60, 0
    s_cbranch_scc1 L_passb0
    v_mfma_f32_16x16x32_bf16 a[0:3], a[120:123], v[248:251], a[0:3]
    s_mul_i32 s54, s94, 196608
    ds_read_b64_tr_b16 a[112:113], v2 offset:20480
    v_mfma_f32_16x16x32_bf16 a[8:11], a[120:123], v[252:255], a[8:11]
    ds_read_b64_tr_b16 a[114:115], v2 offset:20992
    v_mfma_f32_16x16x32_bf16 a[4:7], a[124:127], v[248:251], a[4:7]
    s_add_u32 s70, s28, s54
    ds_read_b64_tr_b16 a[116:117], v4 offset:20480
    ds_read_b64_tr_b16 a[118:119], v4 offset:20992
    v_mfma_f32_16x16x32_bf16 a[12:15], a[124:127], v[252:255], a[12:15]
    s_addc_u32 s71, s29, 0
    global_load_lds_dwordx4 v10, s[70:71] offset:0
    v_mfma_f32_16x16x32_bf16 a[16:19], a[128:131], v[224:227], a[16:19]
    s_barrier
    v_mfma_f32_16x16x32_bf16 a[24:27], a[128:131], v[228:231], a[24:27]
    ds_read_b64_tr_b16 a[120:121], v6 offset:20480
    ds_read_b64_tr_b16 a[122:123], v6 offset:20992
    v_mfma_f32_16x16x32_bf16 a[20:23], a[132:135], v[224:227], a[20:23]
    ds_read_b64_tr_b16 a[124:125], v8 offset:20480
    v_mfma_f32_16x16x32_bf16 a[28:31], a[132:135], v[228:231], a[28:31]
    ds_read_b64_tr_b16 a[126:127], v8 offset:20992
    global_load_lds_dwordx4 v11, s[70:71] offset:1024
    v_mfma_f32_16x16x32_bf16 a[16:19], a[136:139], v[232:235], a[16:19]
    ds_read_b64_tr_b16 a[128:129], v2 offset:26624
    v_mfma_f32_16x16x32_bf16 a[24:27], a[136:139], v[236:239], a[24:27]
    ds_read_b64_tr_b16 a[130:131], v2 offset:27136
    v_mfma_f32_16x16x32_bf16 a[20:23], a[140:143], v[232:235], a[20:23]
    s_waitcnt lgkmcnt(6)
    ds_read_b64_tr_b16 a[132:133], v4 offset:26624
    v_accvgpr_read_b32 v16, a0
    v_mfma_f32_16x16x32_bf16 a[28:31], a[140:143], v[236:239], a[28:31]
    ds_read_b64_tr_b16 a[134:135], v4 offset:27136
    v_accvgpr_read_b32 v17, a1
    v_accvgpr_read_b32 v18, a2
    v_mfma_f32_16x16x32_bf16 a[16:19], a[96:99], v[240:243], a[16:19]
    s_add_u32 s70, s32, s54
    ds_read_b64_tr_b16 a[136:137], v6 offset:26624
    ds_read_b64_tr_b16 a[138:139], v6 offset:27136
    v_mfma_f32_16x16x32_bf16 a[24:27], a[96:99], v[244:247], a[24:27]
    s_addc_u32 s71, s33, 0
    global_load_lds_dwordx4 v10, s[70:71] offset:2048
    v_accvgpr_read_b32 v19, a3
    v_accvgpr_read_b32 v20, a4
    v_mfma_f32_16x16x32_bf16 a[20:23], a[100:103], v[240:243], a[20:23]
    ds_read_b64_tr_b16 a[140:141], v8 offset:26624
    v_accvgpr_read_b32 v21, a5
    v_mfma_f32_16x16x32_bf16 a[28:31], a[100:103], v[244:247], a[28:31]
    ds_read_b64_tr_b16 a[142:143], v8 offset:27136
    v_accvgpr_read_b32 v22, a6
    v_accvgpr_read_b32 v23, a7
    v_mfma_f32_16x16x32_bf16 a[16:19], a[104:107], v[248:251], a[16:19]
    ds_read_b64_tr_b16 a[96:97], v3 offset:20480
    v_mul_f32 v16, s58, v16
    v_mfma_f32_16x16x32_bf16 a[24:27], a[104:107], v[252:255], a[24:27]
    ds_read_b64_tr_b16 a[98:99], v3 offset:20992
    global_load_lds_dwordx4 v11, s[70:71] offset:3072
    v_mul_f32 v17, s58, v17
    v_mfma_f32_16x16x32_bf16 a[20:23], a[108:111], v[248:251], a[20:23]
    s_add_u32 m0, s48, 12288
    ds_read_b64_tr_b16 a[100:101], v5 offset:20480
    v_mul_f32 v18, s58, v18
    v_mfma_f32_16x16x32_bf16 a[28:31], a[108:111], v[252:255], a[28:31]
    ds_read_b64_tr_b16 a[102:103], v5 offset:20992
    v_mul_f32 v19, s58, v19
    v_mul_f32 v20, s58, v20
    v_mfma_f32_16x16x32_bf16 a[32:35], a[112:115], v[224:227], a[32:35]
    s_bfe_u32 s94, s92, 0x4000c
    ds_read_b64_tr_b16 a[104:105], v7 offset:20480
    v_mul_f32 v21, s58, v21
    v_mfma_f32_16x16x32_bf16 a[40:43], a[112:115], v[228:231], a[40:43]
    ds_read_b64_tr_b16 a[106:107], v7 offset:20992
    v_mul_f32 v22, s58, v22
    v_mul_f32 v23, s58, v23
    v_mfma_f32_16x16x32_bf16 a[36:39], a[116:119], v[224:227], a[36:39]
    s_waitcnt lgkmcnt(6)
    ds_read_b64_tr_b16 a[108:109], v9 offset:20480
    v_cvt_pk_bf16_f32 v24, v16, v17
    v_mfma_f32_16x16x32_bf16 a[44:47], a[116:119], v[228:231], a[44:47]
    ds_read_b64_tr_b16 a[110:111], v9 offset:20992
    v_cvt_pk_bf16_f32 v25, v18, v19
    v_cvt_pk_bf16_f32 v26, v20, v21
    v_mfma_f32_16x16x32_bf16 a[32:35], a[120:123], v[232:235], a[32:35]
    s_mul_i32 s54, s94, 196608
    ds_read_b64_tr_b16 a[112:113], v3 offset:26624
    v_cvt_pk_bf16_f32 v27, v22, v23
    v_mfma_f32_16x16x32_bf16 a[40:43], a[120:123], v[236:239], a[40:43]
    ds_read_b64_tr_b16 a[114:115], v3 offset:27136
    buffer_store_dwordx4 v[24:27], v13, s[12:15], s55 offen offset:0 sc1
    v_mfma_f32_16x16x32_bf16 a[36:39], a[124:127], v[232:235], a[36:39]
    s_add_u32 s70, s28, s54
    ds_read_b64_tr_b16 a[116:117], v5 offset:26624
    ds_read_b64_tr_b16 a[118:119], v5 offset:27136
    v_mfma_f32_16x16x32_bf16 a[44:47], a[124:127], v[236:239], a[44:47]
    s_addc_u32 s71, s29, 0
    global_load_lds_dwordx4 v10, s[70:71] offset:0
    v_accvgpr_read_b32 v16, a8
    v_accvgpr_read_b32 v17, a9
    v_mfma_f32_16x16x32_bf16 a[32:35], a[128:131], v[240:243], a[32:35]
    ds_read_b64_tr_b16 a[120:121], v7 offset:26624
    v_accvgpr_read_b32 v18, a10
    v_mfma_f32_16x16x32_bf16 a[40:43], a[128:131], v[244:247], a[40:43]
    ds_read_b64_tr_b16 a[122:123], v7 offset:27136
    v_accvgpr_read_b32 v19, a11
    v_accvgpr_read_b32 v20, a12
    v_mfma_f32_16x16x32_bf16 a[36:39], a[132:135], v[240:243], a[36:39]
    ds_read_b64_tr_b16 a[124:125], v9 offset:26624
    v_accvgpr_read_b32 v21, a13
    v_mfma_f32_16x16x32_bf16 a[44:47], a[132:135], v[244:247], a[44:47]
    ds_read_b64_tr_b16 a[126:127], v9 offset:27136
    global_load_lds_dwordx4 v11, s[70:71] offset:1024
    v_accvgpr_read_b32 v22, a14
    v_mfma_f32_16x16x32_bf16 a[32:35], a[136:139], v[248:251], a[32:35]
    ds_read_b64_tr_b16 a[128:129], v2 offset:22528
    v_accvgpr_read_b32 v23, a15
    v_mfma_f32_16x16x32_bf16 a[40:43], a[136:139], v[252:255], a[40:43]
    ds_read_b64_tr_b16 a[130:131], v2 offset:23040
    v_mul_f32 v16, s58, v16
    v_mul_f32 v17, s58, v17
    v_mfma_f32_16x16x32_bf16 a[36:39], a[140:143], v[248:251], a[36:39]
    s_waitcnt lgkmcnt(6)
    ds_read_b64_tr_b16 a[132:133], v4 offset:22528
    v_mul_f32 v18, s58, v18
    v_mfma_f32_16x16x32_bf16 a[44:47], a[140:143], v[252:255], a[44:47]
    ds_read_b64_tr_b16 a[134:135], v4 offset:23040
    v_mul_f32 v19, s58, v19
    v_mul_f32 v20, s58, v20
    v_mfma_f32_16x16x32_bf16 a[48:51], a[96:99], v[224:227], a[48:51]
    s_add_u32 s70, s32, s54
    ds_read_b64_tr_b16 a[136:137], v6 offset:22528
    ds_read_b64_tr_b16 a[138:139], v6 offset:23040
    v_mfma_f32_16x16x32_bf16 a[56:59], a[96:99], v[228:231], a[56:59]
    s_addc_u32 s71, s33, 0
    global_load_lds_dwordx4 v10, s[70:71] offset:2048
    v_mul_f32 v21, s58, v21
    v_mul_f32 v22, s58, v22
    v_mfma_f32_16x16x32_bf16 a[52:55], a[100:103], v[224:227], a[52:55]
    ds_read_b64_tr_b16 a[140:141], v8 offset:22528
    v_mul_f32 v23, s58, v23
    v_mfma_f32_16x16x32_bf16 a[60:63], a[100:103], v[228:231], a[60:63]
    ds_read_b64_tr_b16 a[142:143], v8 offset:23040
    v_cvt_pk_bf16_f32 v28, v16, v17
    v_cvt_pk_bf16_f32 v29, v18, v19
    v_mfma_f32_16x16x32_bf16 a[48:51], a[104:107], v[232:235], a[48:51]
    ds_read_b64_tr_b16 a[96:97], v2 offset:28672
    v_cvt_pk_bf16_f32 v30, v20, v21
    v_mfma_f32_16x16x32_bf16 a[56:59], a[104:107], v[236:239], a[56:59]
    ds_read_b64_tr_b16 a[98:99], v2 offset:29184
    global_load_lds_dwordx4 v11, s[70:71] offset:3072
    v_cvt_pk_bf16_f32 v31, v22, v23
    v_mfma_f32_16x16x32_bf16 a[52:55], a[108:111], v[232:235], a[52:55]
    ds_read_b64_tr_b16 a[100:101], v4 offset:28672
    buffer_store_dwordx4 v[28:31], v13, s[12:15], s55 offen offset:256 sc1
    v_mfma_f32_16x16x32_bf16 a[60:63], a[108:111], v[236:239], a[60:63]
    ds_read_b64_tr_b16 a[102:103], v4 offset:29184
    v_accvgpr_read_b32 v16, a16
    v_accvgpr_read_b32 v17, a17
    v_mfma_f32_16x16x32_bf16 a[48:51], a[112:115], v[240:243], a[48:51]
    ds_read_b64_tr_b16 a[104:105], v6 offset:28672
    v_accvgpr_read_b32 v18, a18
    v_mfma_f32_16x16x32_bf16 a[56:59], a[112:115], v[244:247], a[56:59]
    ds_read_b64_tr_b16 a[106:107], v6 offset:29184
    v_accvgpr_read_b32 v19, a19
    v_accvgpr_read_b32 v20, a20
    v_mfma_f32_16x16x32_bf16 a[52:55], a[116:119], v[240:243], a[52:55]
    s_waitcnt lgkmcnt(6)
    ds_read_b64_tr_b16 a[108:109], v8 offset:28672
    v_accvgpr_read_b32 v21, a21
    v_mfma_f32_16x16x32_bf16 a[60:63], a[116:119], v[244:247], a[60:63]
    ds_read_b64_tr_b16 a[110:111], v8 offset:29184
    v_accvgpr_read_b32 v22, a22
    v_accvgpr_read_b32 v23, a23
    v_mfma_f32_16x16x32_bf16 a[48:51], a[120:123], v[248:251], a[48:51]
    ds_read_b64_tr_b16 a[112:113], v3 offset:22528
    v_mul_f32 v16, s58, v16
    v_mfma_f32_16x16x32_bf16 a[56:59], a[120:123], v[252:255], a[56:59]
    ds_read_b64_tr_b16 a[114:115], v3 offset:23040
    v_mul_f32 v17, s58, v17
    v_mul_f32 v18, s58, v18
    v_mfma_f32_16x16x32_bf16 a[52:55], a[124:127], v[248:251], a[52:55]
    ds_read_b64_tr_b16 a[116:117], v5 offset:22528
    v_mul_f32 v19, s58, v19
    v_mfma_f32_16x16x32_bf16 a[60:63], a[124:127], v[252:255], a[60:63]
    ds_read_b64_tr_b16 a[118:119], v5 offset:23040
    v_mul_f32 v20, s58, v20
    v_mul_f32 v21, s58, v21
    v_mfma_f32_16x16x32_bf16 a[64:67], a[128:131], v[224:227], a[64:67]
    ds_read_b64_tr_b16 a[120:121], v7 offset:22528
    v_mul_f32 v22, s58, v22
    v_mfma_f32_16x16x32_bf16 a[72:75], a[128:131], v[228:231], a[72:75]
    ds_read_b64_tr_b16 a[122:123], v7 offset:23040
    v_mul_f32 v23, s58, v23
    v_cvt_pk_bf16_f32 v24, v16, v17
    v_mfma_f32_16x16x32_bf16 a[68:71], a[132:135], v[224:227], a[68:71]
    ds_read_b64_tr_b16 a[124:125], v9 offset:22528
    v_cvt_pk_bf16_f32 v25, v18, v19
    v_mfma_f32_16x16x32_bf16 a[76:79], a[132:135], v[228:231], a[76:79]
    ds_read_b64_tr_b16 a[126:127], v9 offset:23040
    v_cvt_pk_bf16_f32 v26, v20, v21
    v_cvt_pk_bf16_f32 v27, v22, v23
    v_mfma_f32_16x16x32_bf16 a[64:67], a[136:139], v[232:235], a[64:67]
    ds_read_b64_tr_b16 a[128:129], v3 offset:28672
    buffer_store_dwordx4 v[24:27], v13, s[12:15], s55 offen offset:2048 sc1
    v_mfma_f32_16x16x32_bf16 a[72:75], a[136:139], v[236:239], a[72:75]
    ds_read_b64_tr_b16 a[130:131], v3 offset:29184
    v_accvgpr_read_b32 v16, a24
    v_accvgpr_read_b32 v17, a25
    v_mfma_f32_16x16x32_bf16 a[68:71], a[140:143], v[232:235], a[68:71]
    s_waitcnt lgkmcnt(6)
    ds_read_b64_tr_b16 a[132:133], v5 offset:28672
    v_accvgpr_read_b32 v18, a26
    v_mfma_f32_16x16x32_bf16 a[76:79], a[140:143], v[236:239], a[76:79]
    ds_read_b64_tr_b16 a[134:135], v5 offset:29184
    v_accvgpr_read_b32 v19, a27
    v_accvgpr_read_b32 v20, a28
    v_mfma_f32_16x16x32_bf16 a[64:67], a[96:99], v[240:243], a[64:67]
    ds_read_b64_tr_b16 a[136:137], v7 offset:28672
    v_accvgpr_read_b32 v21, a29
    v_mfma_f32_16x16x32_bf16 a[72:75], a[96:99], v[244:247], a[72:75]
    ds_read_b64_tr_b16 a[138:139], v7 offset:29184
    v_accvgpr_read_b32 v22, a30
    v_accvgpr_read_b32 v23, a31
    v_mfma_f32_16x16x32_bf16 a[68:71], a[100:103], v[240:243], a[68:71]
    ds_read_b64_tr_b16 a[140:141], v9 offset:28672
    v_mul_f32 v16, s58, v16
    v_mfma_f32_16x16x32_bf16 a[76:79], a[100:103], v[244:247], a[76:79]
    ds_read_b64_tr_b16 a[142:143], v9 offset:29184
    v_mul_f32 v17, s58, v17
    v_mul_f32 v18, s58, v18
    v_mfma_f32_16x16x32_bf16 a[64:67], a[104:107], v[248:251], a[64:67]
    s_waitcnt vmcnt(15)
    s_barrier
    v_mfma_f32_16x16x32_bf16 a[72:75], a[104:107], v[252:255], a[72:75]
    ds_read_b64_tr_b16 a[96:97], v2 offset:0
    ds_read_b64_tr_b16 a[98:99], v2 offset:512
    v_mul_f32 v19, s58, v19
    v_mfma_f32_16x16x32_bf16 a[68:71], a[108:111], v[248:251], a[68:71]
    ds_read_b64_tr_b16 a[100:101], v3 offset:0
    v_mul_f32 v20, s58, v20
    v_mfma_f32_16x16x32_bf16 a[76:79], a[108:111], v[252:255], a[76:79]
    ds_read_b64_tr_b16 a[102:103], v3 offset:512
    v_mul_f32 v21, s58, v21
    v_mul_f32 v22, s58, v22
    v_mfma_f32_16x16x32_bf16 a[80:83], a[112:115], v[224:227], a[80:83]
    ds_read_b64_tr_b16 a[104:105], v2 offset:2048
    v_mul_f32 v23, s58, v23
    v_mfma_f32_16x16x32_bf16 a[88:91], a[112:115], v[228:231], a[88:91]
    ds_read_b64_tr_b16 a[106:107], v2 offset:2560
    v_cvt_pk_bf16_f32 v28, v16, v17
    v_cvt_pk_bf16_f32 v29, v18, v19
    v_mfma_f32_16x16x32_bf16 a[84:87], a[116:119], v[224:227], a[84:87]
    s_waitcnt lgkmcnt(6)
    ds_read_b64_tr_b16 a[108:109], v3 offset:2048
    v_cvt_pk_bf16_f32 v30, v20, v21
    v_mfma_f32_16x16x32_bf16 a[92:95], a[116:119], v[228:231], a[92:95]
    ds_read_b64_tr_b16 a[110:111], v3 offset:2560
    v_cvt_pk_bf16_f32 v31, v22, v23
    v_accvgpr_read_b32 v16, a32
    v_mfma_f32_16x16x32_bf16 a[80:83], a[120:123], v[232:235], a[80:83]
    ds_read_b64_tr_b16 a[112:113], v4 offset:0
    buffer_store_dwordx4 v[28:31], v13, s[12:15], s55 offen offset:2304 sc1
    v_mfma_f32_16x16x32_bf16 a[88:91], a[120:123], v[236:239], a[88:91]
    ds_read_b64_tr_b16 a[114:115], v4 offset:512
    v_accvgpr_read_b32 v17, a33
    v_accvgpr_read_b32 v18, a34
    v_mfma_f32_16x16x32_bf16 a[84:87], a[124:127], v[232:235], a[84:87]
    ds_read_b64_tr_b16 a[116:117], v5 offset:0
    v_accvgpr_read_b32 v19, a35
    v_mfma_f32_16x16x32_bf16 a[92:95], a[124:127], v[236:239], a[92:95]
    ds_read_b64_tr_b16 a[118:119], v5 offset:512
    v_accvgpr_read_b32 v20, a36
    v_accvgpr_read_b32 v21, a37
    v_mfma_f32_16x16x32_bf16 a[80:83], a[128:131], v[240:243], a[80:83]
    ds_read_b64_tr_b16 a[120:121], v4 offset:2048
    v_accvgpr_read_b32 v22, a38
    v_mfma_f32_16x16x32_bf16 a[88:91], a[128:131], v[244:247], a[88:91]
    ds_read_b64_tr_b16 a[122:123], v4 offset:2560
    v_accvgpr_read_b32 v23, a39
    v_cvt_pk_bf16_f32 v24, v16, v17
    v_mfma_f32_16x16x32_bf16 a[84:87], a[132:135], v[240:243], a[84:87]
    ds_read_b64_tr_b16 a[124:125], v5 offset:2048
    v_cvt_pk_bf16_f32 v25, v18, v19
    v_mfma_f32_16x16x32_bf16 a[92:95], a[132:135], v[244:247], a[92:95]
    ds_read_b64_tr_b16 a[126:127], v5 offset:2560
    v_cvt_pk_bf16_f32 v26, v20, v21
    v_cvt_pk_bf16_f32 v27, v22, v23
    v_mfma_f32_16x16x32_bf16 a[80:83], a[136:139], v[248:251], a[80:83]
    ds_read_b64_tr_b16 a[128:129], v6 offset:0
    buffer_store_dwordx4 v[24:27], v13, s[12:15], s56 offen offset:0 sc1
    v_mfma_f32_16x16x32_bf16 a[88:91], a[136:139], v[252:255], a[88:91]
    ds_read_b64_tr_b16 a[130:131], v6 offset:512
    v_accvgpr_read_b32 v16, a40
    v_accvgpr_read_b32 v17, a41
    v_mfma_f32_16x16x32_bf16 a[84:87], a[140:143], v[248:251], a[84:87]
    s_waitcnt lgkmcnt(6)
    ds_read_b64_tr_b16 a[132:133], v7 offset:0
    v_accvgpr_read_b32 v18, a42
    v_mfma_f32_16x16x32_bf16 a[92:95], a[140:143], v[252:255], a[92:95]
    ds_read_b64_tr_b16 a[134:135], v7 offset:512
    v_accvgpr_read_b32 v19, a43
    v_accvgpr_read_b32 v20, a44
    v_mfma_f32_16x16x32_bf16 v[32:35], a[96:99], v[96:99], 0
    ds_read_b64_tr_b16 a[136:137], v6 offset:2048
    v_accvgpr_read_b32 v21, a45
    v_mfma_f32_16x16x32_bf16 v[40:43], a[96:99], v[100:103], 0
    ds_read_b64_tr_b16 a[138:139], v6 offset:2560
    v_accvgpr_read_b32 v22, a46
    v_accvgpr_read_b32 v23, a47
    v_mfma_f32_16x16x32_bf16 v[48:51], a[100:103], v[96:99], 0
    ds_read_b64_tr_b16 a[140:141], v7 offset:2048
    v_cvt_pk_bf16_f32 v28, v16, v17
    v_mfma_f32_16x16x32_bf16 v[56:59], a[100:103], v[100:103], 0
    ds_read_b64_tr_b16 a[142:143], v7 offset:2560
    v_cvt_pk_bf16_f32 v29, v18, v19
    v_cvt_pk_bf16_f32 v30, v20, v21
    v_mfma_f32_16x16x32_bf16 v[64:67], a[104:107], v[96:99], 0
    ds_read_b64_tr_b16 a[96:97], v8 offset:0
    v_cvt_pk_bf16_f32 v31, v22, v23
    v_mfma_f32_16x16x32_bf16 v[72:75], a[104:107], v[100:103], 0
L_pad2:
    s_cbranch_execz L_pad6
    ds_read_b64_tr_b16 a[98:99], v8 offset:512
    buffer_store_dwordx4 v[28:31], v13, s[12:15], s56 offen offset:256 sc1
    v_mfma_f32_16x16x32_bf16 v[80:83], a[108:111], v[96:99], 0
    ds_read_b64_tr_b16 a[100:101], v9 offset:0
    v_accvgpr_read_b32 v16, a48
    v_mfma_f32_16x16x32_bf16 v[88:91], a[108:111], v[100:103], 0
    ds_read_b64_tr_b16 a[102:103], v9 offset:512
    v_accvgpr_read_b32 v17, a49
    v_accvgpr_read_b32 v18, a50
    v_mfma_f32_16x16x32_bf16 v[36:39], a[112:115], v[96:99], 0
    ds_read_b64_tr_b16 a[104:105], v8 offset:2048
    v_accvgpr_read_b32 v19, a51
    v_mfma_f32_16x16x32_bf16 v[44:47], a[112:115], v[100:103], 0
    ds_read_b64_tr_b16 a[106:107], v8 offset:2560
    v_accvgpr_read_b32 v20, a52
    v_accvgpr_read_b32 v21, a53
    v_mfma_f32_16x16x32_bf16 v[52:55], a[116:119], v[96:99], 0
    s_waitcnt lgkmcnt(6)
    ds_read_b64_tr_b16 a[108:109], v9 offset:2048
    v_accvgpr_read_b32 v22, a54
    v_mfma_f32_16x16x32_bf16 v[60:63], a[116:119], v[100:103], 0
    ds_read_b64_tr_b16 a[110:111], v9 offset:2560
    v_accvgpr_read_b32 v23, a55
    v_cvt_pk_bf16_f32 v24, v16, v17
    v_mfma_f32_16x16x32_bf16 v[68:71], a[120:123], v[96:99], 0
    s_waitcnt vmcnt(14)
    s_barrier
    v_mfma_f32_16x16x32_bf16 v[76:79], a[120:123], v[100:103], 0
    ds_read_b64_tr_b16 a[112:113], v2 offset:4096
    ds_read_b64_tr_b16 a[114:115], v2 offset:4608
    v_cvt_pk_bf16_f32 v25, v18, v19
    v_mfma_f32_16x16x32_bf16 v[84:87], a[124:127], v[96:99], 0
    s_add_u32 m0, s48, 16384
    ds_read_b64_tr_b16 a[116:117], v3 offset:4096
    v_cvt_pk_bf16_f32 v26, v20, v21
    v_mfma_f32_16x16x32_bf16 v[92:95], a[124:127], v[100:103], 0
    ds_read_b64_tr_b16 a[118:119], v3 offset:4608
    v_cvt_pk_bf16_f32 v27, v22, v23
    v_accvgpr_read_b32 v16, a56
    v_mfma_f32_16x16x32_bf16 v[32:35], a[128:131], v[104:107], v[32:35]
    s_bfe_u32 s94, s92, 0x40010
    ds_read_b64_tr_b16 a[120:121], v2 offset:6144
    buffer_store_dwordx4 v[24:27], v13, s[12:15], s56 offen offset:2048 sc1
    v_mfma_f32_16x16x32_bf16 v[40:43], a[128:131], v[108:111], v[40:43]
    ds_read_b64_tr_b16 a[122:123], v2 offset:6656
    v_accvgpr_read_b32 v17, a57
    v_accvgpr_read_b32 v18, a58
    v_mfma_f32_16x16x32_bf16 v[48:51], a[132:135], v[104:107], v[48:51]
    s_mul_i32 s54, s94, 196608
    ds_read_b64_tr_b16 a[124:125], v3 offset:6144
    v_accvgpr_read_b32 v19, a59
    v_mfma_f32_16x16x32_bf16 v[56:59], a[132:135], v[108:111], v[56:59]
    ds_read_b64_tr_b16 a[126:127], v3 offset:6656
    v_accvgpr_read_b32 v20, a60
    v_accvgpr_read_b32 v21, a61
    v_mfma_f32_16x16x32_bf16 v[64:67], a[136:139], v[104:107], v[64:67]
    s_add_u32 s70, s28, s54
    ds_read_b64_tr_b16 a[128:129], v4 offset:4096
    ds_read_b64_tr_b16 a[130:131], v4 offset:4608
    v_mfma_f32_16x16x32_bf16 v[72:75], a[136:139], v[108:111], v[72:75]
    s_addc_u32 s71, s29, 0
    global_load_lds_dwordx4 v10, s[70:71] offset:0
    v_accvgpr_read_b32 v22, a62
    v_accvgpr_read_b32 v23, a63
    v_mfma_f32_16x16x32_bf16 v[80:83], a[140:143], v[104:107], v[80:83]
    s_waitcnt lgkmcnt(6)
    ds_read_b64_tr_b16 a[132:133], v5 offset:4096
    v_cvt_pk_bf16_f32 v28, v16, v17
    v_mfma_f32_16x16x32_bf16 v[88:91], a[140:143], v[108:111], v[88:91]
    ds_read_b64_tr_b16 a[134:135], v5 offset:4608
    v_cvt_pk_bf16_f32 v29, v18, v19
    v_cvt_pk_bf16_f32 v30, v20, v21
    v_mfma_f32_16x16x32_bf16 v[36:39], a[96:99], v[104:107], v[36:39]
    ds_read_b64_tr_b16 a[136:137], v4 offset:6144
    v_cvt_pk_bf16_f32 v31, v22, v23
    v_mfma_f32_16x16x32_bf16 v[44:47], a[96:99], v[108:111], v[44:47]
    ds_read_b64_tr_b16 a[138:139], v4 offset:6656
    global_load_lds_dwordx4 v11, s[70:71] offset:1024
    buffer_store_dwordx4 v[28:31], v13, s[12:15], s56 offen offset:2304 sc1
    v_mfma_f32_16x16x32_bf16 v[52:55], a[100:103], v[104:107], v[52:55]
    ds_read_b64_tr_b16 a[140:141], v5 offset:6144
    v_accvgpr_read_b32 v16, a64
    v_mfma_f32_16x16x32_bf16 v[60:63], a[100:103], v[108:111], v[60:63]
    ds_read_b64_tr_b16 a[142:143], v5 offset:6656
    v_accvgpr_read_b32 v17, a65
    v_accvgpr_read_b32 v18, a66
    v_mfma_f32_16x16x32_bf16 v[68:71], a[104:107], v[104:107], v[68:71]
    s_add_u32 s70, s32, s54
    ds_read_b64_tr_b16 a[96:97], v6 offset:4096
    ds_read_b64_tr_b16 a[98:99], v6 offset:4608
    v_mfma_f32_16x16x32_bf16 v[76:79], a[104:107], v[108:111], v[76:79]
    s_addc_u32 s71, s33, 0
    global_load_lds_dwordx4 v10, s[70:71] offset:2048
    v_accvgpr_read_b32 v19, a67
    v_accvgpr_read_b32 v20, a68
    v_mfma_f32_16x16x32_bf16 v[84:87], a[108:111], v[104:107], v[84:87]
    ds_read_b64_tr_b16 a[100:101], v7 offset:4096
    v_accvgpr_read_b32 v21, a69
    v_mfma_f32_16x16x32_bf16 v[92:95], a[108:111], v[108:111], v[92:95]
    ds_read_b64_tr_b16 a[102:103], v7 offset:4608
    v_accvgpr_read_b32 v22, a70
    v_accvgpr_read_b32 v23, a71
    v_mfma_f32_16x16x32_bf16 v[32:35], a[112:115], v[112:115], v[32:35]
    ds_read_b64_tr_b16 a[104:105], v6 offset:6144
    v_cvt_pk_bf16_f32 v24, v16, v17
    v_mfma_f32_16x16x32_bf16 v[40:43], a[112:115], v[116:119], v[40:43]
    ds_read_b64_tr_b16 a[106:107], v6 offset:6656
    global_load_lds_dwordx4 v11, s[70:71] offset:3072
    v_cvt_pk_bf16_f32 v25, v18, v19
    v_mfma_f32_16x16x32_bf16 v[48:51], a[116:119], v[112:115], v[48:51]
    s_waitcnt lgkmcnt(6)
    ds_read_b64_tr_b16 a[108:109], v7 offset:6144
    v_cvt_pk_bf16_f32 v26, v20, v21
    v_mfma_f32_16x16x32_bf16 v[56:59], a[116:119], v[116:119], v[56:59]
    ds_read_b64_tr_b16 a[110:111], v7 offset:6656
    v_cvt_pk_bf16_f32 v27, v22, v23
    v_accvgpr_read_b32 v16, a72
    v_mfma_f32_16x16x32_bf16 v[64:67], a[120:123], v[112:115], v[64:67]
    s_add_u32 m0, s48, 20480
    ds_read_b64_tr_b16 a[112:113], v8 offset:4096
    buffer_store_dwordx4 v[24:27], v13, s[12:15], s64 offen offset:0 sc1
    v_mfma_f32_16x16x32_bf16 v[72:75], a[120:123], v[116:119], v[72:75]
    ds_read_b64_tr_b16 a[114:115], v8 offset:4608
    v_accvgpr_read_b32 v17, a73
    v_accvgpr_read_b32 v18, a74
    v_mfma_f32_16x16x32_bf16 v[80:83], a[124:127], v[112:115], v[80:83]
    s_bfe_u32 s94, s92, 0x40014
    ds_read_b64_tr_b16 a[116:117], v9 offset:4096
    v_accvgpr_read_b32 v19, a75
    v_mfma_f32_16x16x32_bf16 v[88:91], a[124:127], v[116:119], v[88:91]
    ds_read_b64_tr_b16 a[118:119], v9 offset:4608
    v_accvgpr_read_b32 v20, a76
    v_accvgpr_read_b32 v21, a77
    v_mfma_f32_16x16x32_bf16 v[36:39], a[128:131], v[112:115], v[36:39]
    s_mul_i32 s54, s94, 196608
    ds_read_b64_tr_b16 a[120:121], v8 offset:6144
    v_accvgpr_read_b32 v22, a78
    v_mfma_f32_16x16x32_bf16 v[44:47], a[128:131], v[116:119], v[44:47]
    ds_read_b64_tr_b16 a[122:123], v8 offset:6656
    v_accvgpr_read_b32 v23, a79
    v_cvt_pk_bf16_f32 v28, v16, v17
    v_mfma_f32_16x16x32_bf16 v[52:55], a[132:135], v[112:115], v[52:55]
    s_add_u32 s70, s28, s54
    ds_read_b64_tr_b16 a[124:125], v9 offset:6144
    ds_read_b64_tr_b16 a[126:127], v9 offset:6656
    v_mfma_f32_16x16x32_bf16 v[60:63], a[132:135], v[116:119], v[60:63]
    s_addc_u32 s71, s29, 0
    global_load_lds_dwordx4 v10, s[70:71] offset:0
    v_cvt_pk_bf16_f32 v29, v18, v19
    v_cvt_pk_bf16_f32 v30, v20, v21
    v_mfma_f32_16x16x32_bf16 v[68:71], a[136:139], v[112:115], v[68:71]
    s_waitcnt vmcnt(18)
    s_barrier
    v_mfma_f32_16x16x32_bf16 v[76:79], a[136:139], v[116:119], v[76:79]
    ds_read_b64_tr_b16 a[128:129], v2 offset:8192
    ds_read_b64_tr_b16 a[130:131], v2 offset:8704
    v_cvt_pk_bf16_f32 v31, v22, v23
    v_mfma_f32_16x16x32_bf16 v[84:87], a[140:143], v[112:115], v[84:87]
    s_waitcnt lgkmcnt(6)
    ds_read_b64_tr_b16 a[132:133], v3 offset:8192
    buffer_store_dwordx4 v[28:31], v13, s[12:15], s64 offen offset:256 sc1
    v_mfma_f32_16x16x32_bf16 v[92:95], a[140:143], v[116:119], v[92:95]
    ds_read_b64_tr_b16 a[134:135], v3 offset:8704
    global_load_lds_dwordx4 v11, s[70:71] offset:1024
    v_accvgpr_read_b32 v16, a80
    v_mfma_f32_16x16x32_bf16 v[32:35], a[96:99], v[120:123], v[32:35]
    ds_read_b64_tr_b16 a[136:137], v2 offset:10240
    v_accvgpr_read_b32 v17, a81
    v_mfma_f32_16x16x32_bf16 v[40:43], a[96:99], v[124:127], v[40:43]
    ds_read_b64_tr_b16 a[138:139], v2 offset:10752
    v_accvgpr_read_b32 v18, a82
    v_accvgpr_read_b32 v19, a83
    v_mfma_f32_16x16x32_bf16 v[48:51], a[100:103], v[120:123], v[48:51]
    s_add_u32 s70, s32, s54
    ds_read_b64_tr_b16 a[140:141], v3 offset:10240
    ds_read_b64_tr_b16 a[142:143], v3 offset:10752
    v_mfma_f32_16x16x32_bf16 v[56:59], a[100:103], v[124:127], v[56:59]
    s_addc_u32 s71, s33, 0
    global_load_lds_dwordx4 v10, s[70:71] offset:2048
    v_accvgpr_read_b32 v20, a84
    v_accvgpr_read_b32 v21, a85
    v_mfma_f32_16x16x32_bf16 v[64:67], a[104:107], v[120:123], v[64:67]
    ds_read_b64_tr_b16 a[96:97], v4 offset:8192
    v_accvgpr_read_b32 v22, a86
    v_mfma_f32_16x16x32_bf16 v[72:75], a[104:107], v[124:127], v[72:75]
    ds_read_b64_tr_b16 a[98:99], v4 offset:8704
    v_accvgpr_read_b32 v23, a87
    v_cvt_pk_bf16_f32 v24, v16, v17
    v_mfma_f32_16x16x32_bf16 v[80:83], a[108:111], v[120:123], v[80:83]
    ds_read_b64_tr_b16 a[100:101], v5 offset:8192
    v_cvt_pk_bf16_f32 v25, v18, v19
    v_mfma_f32_16x16x32_bf16 v[88:91], a[108:111], v[124:127], v[88:91]
    ds_read_b64_tr_b16 a[102:103], v5 offset:8704
    global_load_lds_dwordx4 v11, s[70:71] offset:3072
    v_cvt_pk_bf16_f32 v26, v20, v21
    v_mfma_f32_16x16x32_bf16 v[36:39], a[112:115], v[120:123], v[36:39]
    s_add_u32 m0, s48, 24576
    ds_read_b64_tr_b16 a[104:105], v4 offset:10240
    v_cvt_pk_bf16_f32 v27, v22, v23
    v_mfma_f32_16x16x32_bf16 v[44:47], a[112:115], v[124:127], v[44:47]
    ds_read_b64_tr_b16 a[106:107], v4 offset:10752
    buffer_store_dwordx4 v[24:27], v13, s[12:15], s64 offen offset:2048 sc1
    v_mfma_f32_16x16x32_bf16 v[52:55], a[116:119], v[120:123], v[52:55]
    s_waitcnt lgkmcnt(6)
    ds_read_b64_tr_b16 a[108:109], v5 offset:10240
    v_accvgpr_read_b32 v16, a88
    v_mfma_f32_16x16x32_bf16 v[60:63], a[116:119], v[124:127], v[60:63]
    ds_read_b64_tr_b16 a[110:111], v5 offset:10752
    v_accvgpr_read_b32 v17, a89
    v_accvgpr_read_b32 v18, a90
    v_mfma_f32_16x16x32_bf16 v[68:71], a[120:123], v[120:123], v[68:71]
    s_bfe_u32 s94, s92, 0x40018
    ds_read_b64_tr_b16 a[112:113], v6 offset:8192
    v_accvgpr_read_b32 v19, a91
    v_mfma_f32_16x16x32_bf16 v[76:79], a[120:123], v[124:127], v[76:79]
    ds_read_b64_tr_b16 a[114:115], v6 offset:8704
    v_accvgpr_read_b32 v20, a92
    v_accvgpr_read_b32 v21, a93
    v_mfma_f32_16x16x32_bf16 v[84:87], a[124:127], v[120:123], v[84:87]
    s_mul_i32 s54, s94, 196608
    ds_read_b64_tr_b16 a[116:117], v7 offset:8192
    v_accvgpr_read_b32 v22, a94
    v_mfma_f32_16x16x32_bf16 v[92:95], a[124:127], v[124:127], v[92:95]
    ds_read_b64_tr_b16 a[118:119], v7 offset:8704
    v_accvgpr_read_b32 v23, a95
    v_cvt_pk_bf16_f32 v28, v16, v17
    v_mfma_f32_16x16x32_bf16 v[32:35], a[128:131], v[128:131], v[32:35]
    s_add_u32 s70, s28, s54
    ds_read_b64_tr_b16 a[120:121], v6 offset:10240
    ds_read_b64_tr_b16 a[122:123], v6 offset:10752
    v_mfma_f32_16x16x32_bf16 v[40:43], a[128:131], v[132:135], v[40:43]
    s_addc_u32 s71, s29, 0
    global_load_lds_dwordx4 v10, s[70:71] offset:0
    v_cvt_pk_bf16_f32 v29, v18, v19
    v_cvt_pk_bf16_f32 v30, v20, v21
    v_mfma_f32_16x16x32_bf16 v[48:51], a[132:135], v[128:131], v[48:51]
    ds_read_b64_tr_b16 a[124:125], v7 offset:10240
    v_cvt_pk_bf16_f32 v31, v22, v23
    v_mfma_f32_16x16x32_bf16 v[56:59], a[132:135], v[132:135], v[56:59]
    ds_read_b64_tr_b16 a[126:127], v7 offset:10752
    buffer_store_dwordx4 v[28:31], v13, s[12:15], s64 offen offset:2304 sc1
    v_mfma_f32_16x16x32_bf16 v[64:67], a[136:139], v[128:131], v[64:67]
    ds_read_b64_tr_b16 a[128:129], v8 offset:8192
    ds_read_b64_tr_b16 a[220:221], v12 offset:0
    ds_read_b64_tr_b16 a[222:223], v12 offset:1280
    v_mfma_f32_16x16x32_bf16 v[72:75], a[136:139], v[132:135], v[72:75]
    ds_read_b64_tr_b16 a[130:131], v8 offset:8704
    global_load_lds_dwordx4 v11, s[70:71] offset:1024
    ds_read_b64_tr_b16 a[224:225], v12 offset:8
    ds_read_b64_tr_b16 a[226:227], v12 offset:1288
    v_mfma_f32_16x16x32_bf16 v[80:83], a[140:143], v[128:131], v[80:83]
    s_waitcnt lgkmcnt(10)
    ds_read_b64_tr_b16 a[132:133], v9 offset:8192
    ds_read_b64_tr_b16 a[228:229], v12 offset:16
    ds_read_b64_tr_b16 a[230:231], v12 offset:1296
    v_mfma_f32_16x16x32_bf16 v[88:91], a[140:143], v[132:135], v[88:91]
    ds_read_b64_tr_b16 a[134:135], v9 offset:8704
    ds_read_b64_tr_b16 a[232:233], v12 offset:24
    ds_read_b64_tr_b16 a[234:235], v12 offset:1304
    v_mfma_f32_16x16x32_bf16 v[36:39], a[96:99], v[128:131], v[36:39]
    s_add_u32 s70, s32, s54
    ds_read_b64_tr_b16 a[136:137], v8 offset:10240
    ds_read_b64_tr_b16 a[138:139], v8 offset:10752
    v_mfma_f32_16x16x32_bf16 v[44:47], a[96:99], v[132:135], v[44:47]
    s_addc_u32 s71, s33, 0
    global_load_lds_dwordx4 v10, s[70:71] offset:2048
    ds_read_b64_tr_b16 a[236:237], v12 offset:32
    ds_read_b64_tr_b16 a[238:239], v12 offset:1312
    v_mfma_f32_16x16x32_bf16 v[52:55], a[100:103], v[128:131], v[52:55]
    ds_read_b64_tr_b16 a[140:141], v9 offset:10240
    v_mfma_f32_16x16x32_bf16 v[60:63], a[100:103], v[132:135], v[60:63]
    ds_read_b64_tr_b16 a[142:143], v9 offset:10752
    v_mfma_f32_16x16x32_bf16 v[68:71], a[104:107], v[128:131], v[68:71]
    s_waitcnt vmcnt(22)
    s_barrier
    v_mfma_f32_16x16x32_bf16 v[76:79], a[104:107], v[132:135], v[76:79]
    ds_read_b64_tr_b16 a[96:97], v2 offset:12288
    ds_read_b64_tr_b16 a[98:99], v2 offset:12800
    v_mfma_f32_16x16x32_bf16 v[84:87], a[108:111], v[128:131], v[84:87]
    ds_read_b64_tr_b16 a[100:101], v3 offset:12288
    v_mfma_f32_16x16x32_bf16 v[92:95], a[108:111], v[132:135], v[92:95]
    ds_read_b64_tr_b16 a[102:103], v3 offset:12800
    global_load_lds_dwordx4 v11, s[70:71] offset:3072
    v_mfma_f32_16x16x32_bf16 v[32:35], a[112:115], v[136:139], v[32:35]
    s_add_u32 m0, s48, 0
    ds_read_b64_tr_b16 a[104:105], v2 offset:14336
    v_mfma_f32_16x16x32_bf16 v[40:43], a[112:115], v[140:143], v[40:43]
    ds_read_b64_tr_b16 a[106:107], v2 offset:14848
    v_mfma_f32_16x16x32_bf16 v[48:51], a[116:119], v[136:139], v[48:51]
    s_waitcnt lgkmcnt(6)
    ds_read_b64_tr_b16 a[108:109], v3 offset:14336
    v_mfma_f32_16x16x32_bf16 v[56:59], a[116:119], v[140:143], v[56:59]
    ds_read_b64_tr_b16 a[110:111], v3 offset:14848
    v_mfma_f32_16x16x32_bf16 v[64:67], a[120:123], v[136:139], v[64:67]
    s_bfe_u32 s94, s92, 0x4001c
    ds_read_b64_tr_b16 a[112:113], v4 offset:12288
    v_mfma_f32_16x16x32_bf16 v[72:75], a[120:123], v[140:143], v[72:75]
    ds_read_b64_tr_b16 a[114:115], v4 offset:12800
    v_mfma_f32_16x16x32_bf16 v[80:83], a[124:127], v[136:139], v[80:83]
    s_mul_i32 s54, s94, 196608
    ds_read_b64_tr_b16 a[116:117], v5 offset:12288
    v_mfma_f32_16x16x32_bf16 v[88:91], a[124:127], v[140:143], v[88:91]
    ds_read_b64_tr_b16 a[118:119], v5 offset:12800
    v_mfma_f32_16x16x32_bf16 v[36:39], a[128:131], v[136:139], v[36:39]
    s_add_u32 s70, s28, s54
    ds_read_b64_tr_b16 a[120:121], v4 offset:14336
    ds_read_b64_tr_b16 a[122:123], v4 offset:14848
    v_mfma_f32_16x16x32_bf16 v[44:47], a[128:131], v[140:143], v[44:47]
    s_addc_u32 s71, s29, 0
    global_load_lds_dwordx4 v10, s[70:71] offset:0
    v_mfma_f32_16x16x32_bf16 v[52:55], a[132:135], v[136:139], v[52:55]
    ds_read_b64_tr_b16 a[124:125], v5 offset:14336
    v_mfma_f32_16x16x32_bf16 v[60:63], a[132:135], v[140:143], v[60:63]
    ds_read_b64_tr_b16 a[126:127], v5 offset:14848
    v_mfma_f32_16x16x32_bf16 v[68:71], a[136:139], v[136:139], v[68:71]
    ds_read_b64_tr_b16 a[128:129], v6 offset:12288
    v_mfma_f32_16x16x32_bf16 v[76:79], a[136:139], v[140:143], v[76:79]
    ds_read_b64_tr_b16 a[130:131], v6 offset:12800
    global_load_lds_dwordx4 v11, s[70:71] offset:1024
    v_mfma_f32_16x16x32_bf16 v[84:87], a[140:143], v[136:139], v[84:87]
    s_waitcnt lgkmcnt(6)
    ds_read_b64_tr_b16 a[132:133], v7 offset:12288
    v_mfma_f32_16x16x32_bf16 v[92:95], a[140:143], v[140:143], v[92:95]
    ds_read_b64_tr_b16 a[134:135], v7 offset:12800
    v_mfma_f32_16x16x32_bf16 v[32:35], a[96:99], v[144:147], v[32:35]
    s_add_u32 s70, s32, s54
    ds_read_b64_tr_b16 a[136:137], v6 offset:14336
    ds_read_b64_tr_b16 a[138:139], v6 offset:14848
    v_mfma_f32_16x16x32_bf16 v[40:43], a[96:99], v[148:151], v[40:43]
    s_addc_u32 s71, s33, 0
    global_load_lds_dwordx4 v10, s[70:71] offset:2048
    v_mfma_f32_16x16x32_bf16 v[48:51], a[100:103], v[144:147], v[48:51]
    ds_read_b64_tr_b16 a[140:141], v7 offset:14336
    v_mfma_f32_16x16x32_bf16 v[56:59], a[100:103], v[148:151], v[56:59]
    ds_read_b64_tr_b16 a[142:143], v7 offset:14848
    v_mfma_f32_16x16x32_bf16 v[64:67], a[104:107], v[144:147], v[64:67]
    ds_read_b64_tr_b16 a[96:97], v8 offset:12288
    v_mfma_f32_16x16x32_bf16 v[72:75], a[104:107], v[148:151], v[72:75]
    ds_read_b64_tr_b16 a[98:99], v8 offset:12800
    global_load_lds_dwordx4 v11, s[70:71] offset:3072
    v_mfma_f32_16x16x32_bf16 v[80:83], a[108:111], v[144:147], v[80:83]
    s_add_u32 m0, s48, 4096
    ds_read_b64_tr_b16 a[100:101], v9 offset:12288
    v_mfma_f32_16x16x32_bf16 v[88:91], a[108:111], v[148:151], v[88:91]
    ds_read_b64_tr_b16 a[102:103], v9 offset:12800
    v_mfma_f32_16x16x32_bf16 v[36:39], a[112:115], v[144:147], v[36:39]
    s_bfe_u32 s94, s93, 0x40000
    ds_read_b64_tr_b16 a[104:105], v8 offset:14336
    v_mfma_f32_16x16x32_bf16 v[44:47], a[112:115], v[148:151], v[44:47]
    ds_read_b64_tr_b16 a[106:107], v8 offset:14848
    v_mfma_f32_16x16x32_bf16 v[52:55], a[116:119], v[144:147], v[52:55]
    s_waitcnt lgkmcnt(6)
    ds_read_b64_tr_b16 a[108:109], v9 offset:14336
    v_mfma_f32_16x16x32_bf16 v[60:63], a[116:119], v[148:151], v[60:63]
    ds_read_b64_tr_b16 a[110:111], v9 offset:14848
    v_mfma_f32_16x16x32_bf16 v[68:71], a[120:123], v[144:147], v[68:71]
    s_waitcnt vmcnt(16)
    s_barrier
    v_mfma_f32_16x16x32_bf16 v[76:79], a[120:123], v[148:151], v[76:79]
    ds_read_b64_tr_b16 a[112:113], v2 offset:16384
    ds_read_b64_tr_b16 a[114:115], v2 offset:16896
    v_mfma_f32_16x16x32_bf16 v[84:87], a[124:127], v[144:147], v[84:87]
    s_mul_i32 s54, s94, 196608
    ds_read_b64_tr_b16 a[116:117], v3 offset:16384
    v_mfma_f32_16x16x32_bf16 v[92:95], a[124:127], v[148:151], v[92:95]
    ds_read_b64_tr_b16 a[118:119], v3 offset:16896
    v_mfma_f32_16x16x32_bf16 v[32:35], a[128:131], v[152:155], v[32:35]
    s_add_u32 s70, s28, s54
    ds_read_b64_tr_b16 a[120:121], v2 offset:18432
    ds_read_b64_tr_b16 a[122:123], v2 offset:18944
    v_mfma_f32_16x16x32_bf16 v[40:43], a[128:131], v[156:159], v[40:43]
    s_addc_u32 s71, s29, 0
    global_load_lds_dwordx4 v10, s[70:71] offset:0
    v_mfma_f32_16x16x32_bf16 v[48:51], a[132:135], v[152:155], v[48:51]
    ds_read_b64_tr_b16 a[124:125], v3 offset:18432
    v_mfma_f32_16x16x32_bf16 v[56:59], a[132:135], v[156:159], v[56:59]
    ds_read_b64_tr_b16 a[126:127], v3 offset:18944
    v_mfma_f32_16x16x32_bf16 v[64:67], a[136:139], v[152:155], v[64:67]
    ds_read_b64_tr_b16 a[128:129], v4 offset:16384
    v_mfma_f32_16x16x32_bf16 v[72:75], a[136:139], v[156:159], v[72:75]
    ds_read_b64_tr_b16 a[130:131], v4 offset:16896
    global_load_lds_dwordx4 v11, s[70:71] offset:1024
    v_mfma_f32_16x16x32_bf16 v[80:83], a[140:143], v[152:155], v[80:83]
    s_waitcnt lgkmcnt(6)
    ds_read_b64_tr_b16 a[132:133], v5 offset:16384
    v_mfma_f32_16x16x32_bf16 v[88:91], a[140:143], v[156:159], v[88:91]
    ds_read_b64_tr_b16 a[134:135], v5 offset:16896
    v_mfma_f32_16x16x32_bf16 v[36:39], a[96:99], v[152:155], v[36:39]
    s_add_u32 s70, s32, s54
    ds_read_b64_tr_b16 a[136:137], v4 offset:18432
    ds_read_b64_tr_b16 a[138:139], v4 offset:18944
    v_mfma_f32_16x16x32_bf16 v[44:47], a[96:99], v[156:159], v[44:47]
    s_addc_u32 s71, s33, 0
    global_load_lds_dwordx4 v10, s[70:71] offset:2048
    v_mfma_f32_16x16x32_bf16 v[52:55], a[100:103], v[152:155], v[52:55]
    ds_read_b64_tr_b16 a[140:141], v5 offset:18432
    v_mfma_f32_16x16x32_bf16 v[60:63], a[100:103], v[156:159], v[60:63]
    ds_read_b64_tr_b16 a[142:143], v5 offset:18944
    v_accvgpr_read_b32 v96, a240
    v_mfma_f32_16x16x32_bf16 v[68:71], a[104:107], v[152:155], v[68:71]
    ds_read_b64_tr_b16 a[96:97], v6 offset:16384
    ds_read_b64_tr_b16 a[98:99], v6 offset:16896
    v_mfma_f32_16x16x32_bf16 v[76:79], a[104:107], v[156:159], v[76:79]
    global_load_lds_dwordx4 v11, s[70:71] offset:3072
    s_waitcnt vmcnt(11)
    buffer_store_dword v14, v96, s[12:15], 0 offen offset:0 sc1
    v_mfma_f32_16x16x32_bf16 v[84:87], a[108:111], v[152:155], v[84:87]
    s_add_u32 m0, s48, 8192
    ds_read_b64_tr_b16 a[100:101], v7 offset:16384
    v_mfma_f32_16x16x32_bf16 v[92:95], a[108:111], v[156:159], v[92:95]
    ds_read_b64_tr_b16 a[102:103], v7 offset:16896
    v_mfma_f32_16x16x32_bf16 v[32:35], a[112:115], v[160:163], v[32:35]
    s_bfe_u32 s94, s93, 0x40004
    ds_read_b64_tr_b16 a[104:105], v6 offset:18432
    s_mul_i32 s4, s61, 5
    v_mfma_f32_16x16x32_bf16 v[40:43], a[112:115], v[164:167], v[40:43]
    s_lshr_b32 s5, s4, 2
    ds_read_b64_tr_b16 a[106:107], v6 offset:18944
    s_lshl_b32 s5, s5, 10
    v_add_u32 v149, s5, v1
    v_mfma_f32_16x16x32_bf16 v[48:51], a[116:119], v[160:163], v[48:51]
    s_waitcnt lgkmcnt(6)
    ds_read_b64_tr_b16 a[108:109], v7 offset:18432
    v_add_u32 v146, 81920, v149
    v_mfma_f32_16x16x32_bf16 v[56:59], a[116:119], v[164:167], v[56:59]
    s_bfe_u32 s6, s4, 0x10001
    ds_read_b64_tr_b16 a[110:111], v7 offset:18944
    s_lshl_b32 s4, s6, 10
    s_add_u32 s4, s4, 40960
    v_mfma_f32_16x16x32_bf16 v[64:67], a[120:123], v[160:163], v[64:67]
    s_mul_i32 s54, s94, 196608
    ds_read_b64_tr_b16 a[112:113], v8 offset:16384
    v_add_u32 v144, s4, v149
    v_mfma_f32_16x16x32_bf16 v[72:75], a[120:123], v[164:167], v[72:75]
    s_mul_i32 s7, s6, 1016
    ds_read_b64_tr_b16 a[114:115], v8 offset:16896
    s_sub_u32 s4, 41984, s7
    v_add_u32 v145, s4, v149
    v_mfma_f32_16x16x32_bf16 v[80:83], a[124:127], v[160:163], v[80:83]
    s_add_u32 s70, s28, s54
    ds_read_b64_tr_b16 a[116:117], v9 offset:16384
    ds_read_b64_tr_b16 a[118:119], v9 offset:16896
    v_mfma_f32_16x16x32_bf16 v[88:91], a[124:127], v[164:167], v[88:91]
    s_addc_u32 s71, s29, 0
    global_load_lds_dwordx4 v10, s[70:71] offset:0
    v_add_u32 v155, s48, v1
    s_sub_u32 s4, s3, 1
    v_mfma_f32_16x16x32_bf16 v[36:39], a[128:131], v[160:163], v[36:39]
    s_and_b32 s4, s4, 3
    ds_read_b64_tr_b16 a[120:121], v8 offset:18432
    s_mul_i32 s4, s4, 40960
    v_mfma_f32_16x16x32_bf16 v[44:47], a[128:131], v[164:167], v[44:47]
    ds_read_b64_tr_b16 a[122:123], v8 offset:18944
    v_add_u32 v152, s4, v1
    s_sub_u32 s4, s3, 2
    v_mfma_f32_16x16x32_bf16 v[52:55], a[132:135], v[160:163], v[52:55]
    s_and_b32 s4, s4, 3
    ds_read_b64_tr_b16 a[124:125], v9 offset:18432
    s_mul_i32 s4, s4, 40960
    v_mfma_f32_16x16x32_bf16 v[60:63], a[132:135], v[164:167], v[60:63]
    ds_read_b64_tr_b16 a[126:127], v9 offset:18944
    global_load_lds_dwordx4 v11, s[70:71] offset:1024
    v_add_u32 v153, s4, v1
    v_mfma_f32_16x16x32_bf16 v[68:71], a[136:139], v[160:163], v[68:71]
    s_sub_u32 s4, s3, 3
    s_barrier
    v_mfma_f32_16x16x32_bf16 v[76:79], a[136:139], v[164:167], v[76:79]
    s_and_b32 s4, s4, 3
    ds_read_b64_tr_b16 a[128:129], v2 offset:20480
    ds_read_b64_tr_b16 a[130:131], v2 offset:20992
    s_mul_i32 s4, s4, 40960
    v_mfma_f32_16x16x32_bf16 v[84:87], a[140:143], v[160:163], v[84:87]
    s_waitcnt lgkmcnt(6)
    ds_read_b64_tr_b16 a[132:133], v3 offset:20480
    v_add_u32 v154, s4, v1
    v_mfma_f32_16x16x32_bf16 v[92:95], a[140:143], v[164:167], v[92:95]
    ds_read_b64_tr_b16 a[134:135], v3 offset:20992
    v_lshrrev_b32 v136, 5, v0
    s_and_b32 s4, s61, 1
    v_mfma_f32_16x16x32_bf16 v[32:35], a[96:99], v[168:171], v[32:35]
    s_add_u32 s70, s32, s54
    ds_read_b64_tr_b16 a[136:137], v2 offset:22528
    ds_read_b64_tr_b16 a[138:139], v2 offset:23040
    v_mfma_f32_16x16x32_bf16 v[40:43], a[96:99], v[172:175], v[40:43]
    s_addc_u32 s71, s33, 0
    global_load_lds_dwordx4 v10, s[70:71] offset:2048
    v_xor_b32 v137, s4, v136
    v_sub_u32 v138, 28672, v1
    v_mfma_f32_16x16x32_bf16 v[48:51], a[100:103], v[168:171], v[48:51]
    s_and_b32 s5, s61, 3
    ds_read_b64_tr_b16 a[140:141], v3 offset:22528
    s_lshl_b32 s4, s5, 1
    v_mfma_f32_16x16x32_bf16 v[56:59], a[100:103], v[172:175], v[56:59]
    s_lshr_b32 s4, 0x92, s4
    ds_read_b64_tr_b16 a[142:143], v3 offset:23040
    s_and_b32 s4, s4, 3
    s_add_u32 s4, s4, 1
    v_mfma_f32_16x16x32_bf16 v[64:67], a[104:107], v[168:171], v[64:67]
    ds_read_b64_tr_b16 a[96:97], v4 offset:20480
    v_mul_u32_u24 v137, s4, v137
    v_mfma_f32_16x16x32_bf16 v[72:75], a[104:107], v[172:175], v[72:75]
    s_lshl_b32 s4, s6, 11
    ds_read_b64_tr_b16 a[98:99], v4 offset:20992
    global_load_lds_dwordx4 v11, s[70:71] offset:3072
    s_add_u32 s4, s4, 12288
    v_mfma_f32_16x16x32_bf16 v[80:83], a[108:111], v[168:171], v[80:83]
    s_mul_i32 s7, s6, 2040
    ds_read_b64_tr_b16 a[100:101], v5 offset:20480
    s_sub_u32 s7, 14336, s7
    v_mfma_f32_16x16x32_bf16 v[88:91], a[108:111], v[172:175], v[88:91]
    ds_read_b64_tr_b16 a[102:103], v5 offset:20992
    v_cmp_eq_u32 vcc, 1, v137
    v_mov_b32 v139, s4
    v_mfma_f32_16x16x32_bf16 v[36:39], a[112:115], v[168:171], v[36:39]
    ds_read_b64_tr_b16 a[104:105], v4 offset:22528
    v_add_u32 v139, 0, v139
    v_mfma_f32_16x16x32_bf16 v[44:47], a[112:115], v[172:175], v[44:47]
    ds_read_b64_tr_b16 a[106:107], v4 offset:23040
    v_cndmask_b32 v139, v139, v138, vcc
    v_add_u32 v112, v139, v154
    v_mfma_f32_16x16x32_bf16 v[52:55], a[116:119], v[168:171], v[52:55]
    s_waitcnt lgkmcnt(6)
    ds_read_b64_tr_b16 a[108:109], v5 offset:22528
    v_add_u32 v115, v139, v153
    v_mfma_f32_16x16x32_bf16 v[60:63], a[116:119], v[172:175], v[60:63]
    ds_read_b64_tr_b16 a[110:111], v5 offset:23040
    v_add_u32 v118, v139, v152
    v_add_u32 v121, v139, v155
    v_mfma_f32_16x16x32_bf16 v[68:71], a[120:123], v[168:171], v[68:71]
    ds_read_b64_tr_b16 a[112:113], v6 offset:20480
    v_cmp_eq_u32 vcc, 2, v137
    v_mfma_f32_16x16x32_bf16 v[76:79], a[120:123], v[172:175], v[76:79]
    ds_read_b64_tr_b16 a[114:115], v6 offset:20992
    v_mov_b32 v139, s4
    v_add_u32 v139, 8, v139
    v_mfma_f32_16x16x32_bf16 v[84:87], a[124:127], v[168:171], v[84:87]
    ds_read_b64_tr_b16 a[116:117], v7 offset:20480
    v_cndmask_b32 v139, v139, v138, vcc
    v_mfma_f32_16x16x32_bf16 v[92:95], a[124:127], v[172:175], v[92:95]
    ds_read_b64_tr_b16 a[118:119], v7 offset:20992
    v_add_u32 v113, v139, v154
    v_add_u32 v116, v139, v153
    v_mfma_f32_16x16x32_bf16 v[32:35], a[128:131], v[176:179], v[32:35]
    ds_read_b64_tr_b16 a[120:121], v6 offset:22528
    v_add_u32 v119, v139, v152
    v_mfma_f32_16x16x32_bf16 v[40:43], a[128:131], v[180:183], v[40:43]
    ds_read_b64_tr_b16 a[122:123], v6 offset:23040
    v_add_u32 v122, v139, v155
    v_cmp_eq_u32 vcc, 3, v137
    v_mfma_f32_16x16x32_bf16 v[48:51], a[132:135], v[176:179], v[48:51]
    ds_read_b64_tr_b16 a[124:125], v7 offset:22528
    v_mov_b32 v139, s7
    v_mfma_f32_16x16x32_bf16 v[56:59], a[132:135], v[180:183], v[56:59]
    ds_read_b64_tr_b16 a[126:127], v7 offset:23040
    v_add_u32 v139, 0, v139
    v_cndmask_b32 v139, v139, v138, vcc
    v_mfma_f32_16x16x32_bf16 v[64:67], a[136:139], v[176:179], v[64:67]
    ds_read_b64_tr_b16 a[128:129], v8 offset:20480
    v_add_u32 v114, v139, v154
    v_mfma_f32_16x16x32_bf16 v[72:75], a[136:139], v[180:183], v[72:75]
L_pad3:
    s_cbranch_execz L_pad7
    ds_read_b64_tr_b16 a[130:131], v8 offset:20992
    v_add_u32 v117, v139, v153
    v_add_u32 v120, v139, v152
    v_mfma_f32_16x16x32_bf16 v[80:83], a[140:143], v[176:179], v[80:83]
    s_waitcnt lgkmcnt(6)
    ds_read_b64_tr_b16 a[132:133], v9 offset:20480
    v_add_u32 v123, v139, v155
    v_mfma_f32_16x16x32_bf16 v[88:91], a[140:143], v[180:183], v[88:91]
    ds_read_b64_tr_b16 a[134:135], v9 offset:20992
    v_bfe_u32 v137, v0, 4, 1
    v_and_b32 v138, 3, v0
    v_mfma_f32_16x16x32_bf16 v[36:39], a[96:99], v[176:179], v[36:39]
    ds_read_b64_tr_b16 a[136:137], v8 offset:22528
    v_lshl_add_u32 v137, v137, 2, v138
    v_mfma_f32_16x16x32_bf16 v[44:47], a[96:99], v[180:183], v[44:47]
    ds_read_b64_tr_b16 a[138:139], v8 offset:23040
    v_add_u32 v138, s5, v137
    v_lshrrev_b32 v139, 2, v138
    v_mfma_f32_16x16x32_bf16 v[52:55], a[100:103], v[176:179], v[52:55]
    ds_read_b64_tr_b16 a[140:141], v9 offset:22528
    v_lshlrev_b32 v139, 10, v139
    v_mfma_f32_16x16x32_bf16 v[60:63], a[100:103], v[180:183], v[60:63]
    ds_read_b64_tr_b16 a[142:143], v9 offset:23040
    v_and_b32 v140, 1, v138
    v_lshl_add_u32 v139, v140, 9, v139
    v_mfma_f32_16x16x32_bf16 v[68:71], a[104:107], v[176:179], v[68:71]
    s_waitcnt vmcnt(13)
    s_barrier
    v_mfma_f32_16x16x32_bf16 v[76:79], a[104:107], v[180:183], v[76:79]
    ds_read_b64_tr_b16 a[96:97], v2 offset:24576
    ds_read_b64_tr_b16 a[98:99], v2 offset:25088
    v_bfe_u32 v140, v138, 1, 1
    v_mfma_f32_16x16x32_bf16 v[84:87], a[108:111], v[176:179], v[84:87]
    ds_read_b64_tr_b16 a[100:101], v3 offset:24576
    v_lshl_add_u32 v139, v140, 3, v139
    v_mfma_f32_16x16x32_bf16 v[92:95], a[108:111], v[180:183], v[92:95]
    ds_read_b64_tr_b16 a[102:103], v3 offset:25088
    v_add_u32 v139, 35840, v139
    v_add_u32 v140, 2048, v139
    v_mfma_f32_16x16x32_bf16 v[32:35], a[112:115], v[184:187], v[32:35]
    ds_read_b64_tr_b16 a[104:105], v2 offset:26624
    v_min_u32 v141, 6, v137
    v_mfma_f32_16x16x32_bf16 v[40:43], a[112:115], v[188:191], v[40:43]
    ds_read_b64_tr_b16 a[106:107], v2 offset:27136
    v_lshlrev_b32 v141, 3, v141
    v_add_u32 v141, 39896, v141
    v_mfma_f32_16x16x32_bf16 v[48:51], a[116:119], v[184:187], v[48:51]
    s_waitcnt lgkmcnt(6)
    ds_read_b64_tr_b16 a[108:109], v3 offset:26624
    v_cmp_gt_u32 vcc, 5, v137
    v_mfma_f32_16x16x32_bf16 v[56:59], a[116:119], v[188:191], v[56:59]
    ds_read_b64_tr_b16 a[110:111], v3 offset:27136
    v_bfe_u32 v142, v0, 2, 2
    v_lshl_add_u32 v142, v136, 3, v142
    v_mfma_f32_16x16x32_bf16 v[64:67], a[120:123], v[184:187], v[64:67]
    ds_read_b64_tr_b16 a[112:113], v4 offset:24576
    v_lshlrev_b32 v142, 4, v142
    v_mfma_f32_16x16x32_bf16 v[72:75], a[120:123], v[188:191], v[72:75]
    ds_read_b64_tr_b16 a[114:115], v4 offset:25088
    v_add_u32 v142, s48, v142
    v_cndmask_b32 v139, v141, v139, vcc
    v_mfma_f32_16x16x32_bf16 v[80:83], a[124:127], v[184:187], v[80:83]
    ds_read_b64_tr_b16 a[116:117], v5 offset:24576
    v_cndmask_b32 v140, v141, v140, vcc
    v_mfma_f32_16x16x32_bf16 v[88:91], a[124:127], v[188:191], v[88:91]
    ds_read_b64_tr_b16 a[118:119], v5 offset:25088
    v_add_u32 v147, v139, v142
    v_add_u32 v148, v140, v142
    v_mfma_f32_16x16x32_bf16 v[36:39], a[128:131], v[184:187], v[36:39]
    ds_read_b64_tr_b16 a[120:121], v4 offset:26624
    v_mov_b32 v128, 0x3f80
    v_mfma_f32_16x16x32_bf16 v[44:47], a[128:131], v[188:191], v[44:47]
    ds_read_b64_tr_b16 a[122:123], v4 offset:27136
    v_mov_b32 v129, 0
    v_mov_b32 v130, 0
    v_mfma_f32_16x16x32_bf16 v[52:55], a[132:135], v[184:187], v[52:55]
    ds_read_b64_tr_b16 a[124:125], v5 offset:26624
    v_mov_b32 v131, 0
    v_mfma_f32_16x16x32_bf16 v[60:63], a[132:135], v[188:191], v[60:63]
    ds_read_b64_tr_b16 a[126:127], v5 offset:27136
    v_add_u32 v143, v155, v1
    v_lshlrev_b32 v156, 2, v0
    v_mfma_f32_16x16x32_bf16 v[68:71], a[136:139], v[184:187], v[68:71]
    ds_read_b64_tr_b16 a[128:129], v6 offset:24576
    v_mov_b32 v150, 0xdddd
    v_mfma_f32_16x16x32_bf16 v[76:79], a[136:139], v[188:191], v[76:79]
    s_mul_i32 s4, s61, 5
    ds_read_b64_tr_b16 a[130:131], v6 offset:25088
    s_lshr_b32 s4, s4, 2
    v_bfe_u32 v137, v0, 4, 1
    v_mfma_f32_16x16x32_bf16 v[84:87], a[140:143], v[184:187], v[84:87]
    s_waitcnt lgkmcnt(6)
    ds_read_b64_tr_b16 a[132:133], v7 offset:24576
    v_add_u32 v137, s4, v137
    v_mfma_f32_16x16x32_bf16 v[92:95], a[140:143], v[188:191], v[92:95]
    ds_read_b64_tr_b16 a[134:135], v7 offset:25088
    v_lshrrev_b32 v137, 2, v137
    v_lshlrev_b32 v137, 11, v137
    v_mfma_f32_16x16x32_bf16 v[32:35], a[96:99], v[192:195], v[32:35]
    ds_read_b64_tr_b16 a[136:137], v6 offset:26624
    v_and_b32 v138, 1, v0
    v_mfma_f32_16x16x32_bf16 v[40:43], a[96:99], v[196:199], v[40:43]
    ds_read_b64_tr_b16 a[138:139], v6 offset:27136
    v_lshl_add_u32 v138, v138, 2, v137
    s_lshl_b32 s4, s62, 2
    v_mfma_f32_16x16x32_bf16 v[48:51], a[100:103], v[192:195], v[48:51]
    s_add_u32 s4, s4, s3
    ds_read_b64_tr_b16 a[140:141], v7 offset:26624
    s_mul_i32 s65, s4, 247808
    v_mfma_f32_16x16x32_bf16 v[56:59], a[100:103], v[196:199], v[56:59]
    s_and_b32 s6, s4, 1
    ds_read_b64_tr_b16 a[142:143], v7 offset:27136
    s_lshl_b32 s6, s6, 3
    s_lshr_b32 s4, s4, 1
    v_mfma_f32_16x16x32_bf16 v[64:67], a[104:107], v[192:195], v[64:67]
    s_lshl_b32 s4, s4, 7
    ds_read_b64_tr_b16 a[96:97], v8 offset:24576
    s_add_u32 s4, s4, s6
    v_mfma_f32_16x16x32_bf16 v[72:75], a[104:107], v[196:199], v[72:75]
    s_add_u32 s4, s4, 19712000
    ds_read_b64_tr_b16 a[98:99], v8 offset:25088
    v_add_u32 v127, s4, v138
    v_and_b32 v138, 3, v0
    v_mfma_f32_16x16x32_bf16 v[80:83], a[108:111], v[192:195], v[80:83]
    ds_read_b64_tr_b16 a[100:101], v9 offset:24576
    v_lshl_add_u32 v137, v138, 2, v137
    v_mfma_f32_16x16x32_bf16 v[88:91], a[108:111], v[196:199], v[88:91]
    ds_read_b64_tr_b16 a[102:103], v9 offset:25088
    v_bfe_u32 v138, v0, 2, 2
    v_lshl_add_u32 v138, v138, 7, v137
    v_mfma_f32_16x16x32_bf16 v[36:39], a[112:115], v[192:195], v[36:39]
    ds_read_b64_tr_b16 a[104:105], v8 offset:26624
    v_mul_u32_u24 v137, 20480, v136
    v_mfma_f32_16x16x32_bf16 v[44:47], a[112:115], v[196:199], v[44:47]
    s_lshl_b32 s4, s3, 9
    ds_read_b64_tr_b16 a[106:107], v8 offset:27136
    global_load_dword a241, v1, s[98:99] offset:0
    s_add_u32 s4, s4, 19732480
    v_mfma_f32_16x16x32_bf16 v[52:55], a[116:119], v[192:195], v[52:55]
    s_waitcnt lgkmcnt(6)
    ds_read_b64_tr_b16 a[108:109], v9 offset:26624
    v_add3_u32 v126, v137, v138, s4
    v_mfma_f32_16x16x32_bf16 v[60:63], a[116:119], v[196:199], v[60:63]
    s_mul_i32 s4, s3, 1982464
    ds_read_b64_tr_b16 a[110:111], v9 offset:27136
    s_add_u32 s16, s12, s4
    s_addc_u32 s17, s13, 0
    v_mfma_f32_16x16x32_bf16 v[68:71], a[120:123], v[192:195], v[68:71]
    s_waitcnt vmcnt(10)
    s_barrier
    buffer_load_dword v157, v156, s[40:43], 0 offen offset:0 sc1
    v_mfma_f32_16x16x32_bf16 v[76:79], a[120:123], v[196:199], v[76:79]
    ds_read_b64_tr_b16 a[112:113], v2 offset:0
    ds_read_b64_tr_b16 a[114:115], v2 offset:512
    v_mfma_f32_16x16x32_bf16 v[84:87], a[124:127], v[192:195], v[84:87]
    ds_read_b64_tr_b16 a[116:117], v3 offset:0
    v_mfma_f32_16x16x32_bf16 v[92:95], a[124:127], v[196:199], v[92:95]
    ds_read_b64_tr_b16 a[118:119], v3 offset:512
    v_mfma_f32_16x16x32_bf16 v[32:35], a[128:131], v[200:203], v[32:35]
    ds_read_b64_tr_b16 a[120:121], v2 offset:2048
    v_mfma_f32_16x16x32_bf16 v[40:43], a[128:131], v[204:207], v[40:43]
    ds_read_b64_tr_b16 a[122:123], v2 offset:2560
    v_mfma_f32_16x16x32_bf16 v[48:51], a[132:135], v[200:203], v[48:51]
    ds_read_b64_tr_b16 a[124:125], v3 offset:2048
    v_mfma_f32_16x16x32_bf16 v[56:59], a[132:135], v[204:207], v[56:59]
    ds_read_b64_tr_b16 a[126:127], v3 offset:2560
    v_mfma_f32_16x16x32_bf16 v[64:67], a[136:139], v[200:203], v[64:67]
    ds_read_b64_tr_b16 a[128:129], v4 offset:0
    v_mfma_f32_16x16x32_bf16 v[72:75], a[136:139], v[204:207], v[72:75]
    ds_read_b64_tr_b16 a[130:131], v4 offset:512
    v_mfma_f32_16x16x32_bf16 v[80:83], a[140:143], v[200:203], v[80:83]
    s_waitcnt lgkmcnt(6)
    ds_read_b64_tr_b16 a[132:133], v5 offset:0
    v_mfma_f32_16x16x32_bf16 v[88:91], a[140:143], v[204:207], v[88:91]
    ds_read_b64_tr_b16 a[134:135], v5 offset:512
    v_mfma_f32_16x16x32_bf16 v[36:39], a[96:99], v[200:203], v[36:39]
    ds_read_b64_tr_b16 a[136:137], v4 offset:2048
    v_mfma_f32_16x16x32_bf16 v[44:47], a[96:99], v[204:207], v[44:47]
    ds_read_b64_tr_b16 a[138:139], v4 offset:2560
    v_mfma_f32_16x16x32_bf16 v[52:55], a[100:103], v[200:203], v[52:55]
    ds_read_b64_tr_b16 a[140:141], v5 offset:2048
    v_mfma_f32_16x16x32_bf16 v[60:63], a[100:103], v[204:207], v[60:63]
    ds_read_b64_tr_b16 a[142:143], v5 offset:2560
    v_mfma_f32_16x16x32_bf16 v[68:71], a[104:107], v[200:203], v[68:71]
    ds_read_b64_tr_b16 a[96:97], v6 offset:0
    v_mfma_f32_16x16x32_bf16 v[76:79], a[104:107], v[204:207], v[76:79]
    ds_read_b64_tr_b16 a[98:99], v6 offset:512
    v_mfma_f32_16x16x32_bf16 v[84:87], a[108:111], v[200:203], v[84:87]
    ds_read_b64_tr_b16 a[100:101], v7 offset:0
    v_mfma_f32_16x16x32_bf16 v[92:95], a[108:111], v[204:207], v[92:95]
    ds_read_b64_tr_b16 a[102:103], v7 offset:512
    v_mfma_f32_16x16x32_bf16 v[32:35], a[112:115], v[208:211], v[32:35]
    ds_read_b64_tr_b16 a[104:105], v6 offset:2048
    v_mfma_f32_16x16x32_bf16 v[40:43], a[112:115], v[212:215], v[40:43]
    ds_read_b64_tr_b16 a[106:107], v6 offset:2560
    v_mfma_f32_16x16x32_bf16 v[48:51], a[116:119], v[208:211], v[48:51]
    s_waitcnt lgkmcnt(6)
    ds_read_b64_tr_b16 a[108:109], v7 offset:2048
    v_mfma_f32_16x16x32_bf16 v[56:59], a[116:119], v[212:215], v[56:59]
    ds_read_b64_tr_b16 a[110:111], v7 offset:2560
    v_mfma_f32_16x16x32_bf16 v[64:67], a[120:123], v[208:211], v[64:67]
    ds_read_b64_tr_b16 a[112:113], v8 offset:0
    v_mfma_f32_16x16x32_bf16 v[72:75], a[120:123], v[212:215], v[72:75]
    ds_read_b64_tr_b16 a[114:115], v8 offset:512
    v_mfma_f32_16x16x32_bf16 v[80:83], a[124:127], v[208:211], v[80:83]
    ds_read_b64_tr_b16 a[116:117], v9 offset:0
    v_mfma_f32_16x16x32_bf16 v[88:91], a[124:127], v[212:215], v[88:91]
    ds_read_b64_tr_b16 a[118:119], v9 offset:512
    v_mfma_f32_16x16x32_bf16 v[36:39], a[128:131], v[208:211], v[36:39]
    ds_read_b64_tr_b16 a[120:121], v8 offset:2048
    v_mfma_f32_16x16x32_bf16 v[44:47], a[128:131], v[212:215], v[44:47]
    ds_read_b64_tr_b16 a[122:123], v8 offset:2560
    v_mfma_f32_16x16x32_bf16 v[52:55], a[132:135], v[208:211], v[52:55]
    ds_read_b64_tr_b16 a[124:125], v9 offset:2048
    v_mfma_f32_16x16x32_bf16 v[60:63], a[132:135], v[212:215], v[60:63]
    ds_read_b64_tr_b16 a[126:127], v9 offset:2560
    v_mfma_f32_16x16x32_bf16 v[68:71], a[136:139], v[208:211], v[68:71]
    s_waitcnt vmcnt(7)
    s_barrier
    v_mfma_f32_16x16x32_bf16 v[76:79], a[136:139], v[212:215], v[76:79]
    ds_read_b64_tr_b16 a[128:129], v2 offset:4096
    ds_read_b64_tr_b16 a[130:131], v2 offset:4608
    v_mfma_f32_16x16x32_bf16 v[84:87], a[140:143], v[208:211], v[84:87]
    s_waitcnt lgkmcnt(6)
    ds_read_b64_tr_b16 a[132:133], v3 offset:4096
    v_mfma_f32_16x16x32_bf16 v[92:95], a[140:143], v[212:215], v[92:95]
    ds_read_b64_tr_b16 a[134:135], v3 offset:4608
    v_mfma_f32_16x16x32_bf16 v[32:35], a[96:99], v[216:219], v[32:35]
    ds_read_b64_tr_b16 a[136:137], v2 offset:6144
    v_mfma_f32_16x16x32_bf16 v[40:43], a[96:99], v[220:223], v[40:43]
    ds_read_b64_tr_b16 a[138:139], v2 offset:6656
    v_mfma_f32_16x16x32_bf16 v[48:51], a[100:103], v[216:219], v[48:51]
    ds_read_b64_tr_b16 a[140:141], v3 offset:6144
    v_mfma_f32_16x16x32_bf16 v[56:59], a[100:103], v[220:223], v[56:59]
    ds_read_b64_tr_b16 a[142:143], v3 offset:6656
    v_mfma_f32_16x16x32_bf16 v[64:67], a[104:107], v[216:219], v[64:67]
    ds_read_b64_tr_b16 a[96:97], v4 offset:4096
    v_mfma_f32_16x16x32_bf16 v[72:75], a[104:107], v[220:223], v[72:75]
    ds_read_b64_tr_b16 a[98:99], v4 offset:4608
    v_mfma_f32_16x16x32_bf16 v[80:83], a[108:111], v[216:219], v[80:83]
    ds_read_b64_tr_b16 a[100:101], v5 offset:4096
    v_mfma_f32_16x16x32_bf16 v[88:91], a[108:111], v[220:223], v[88:91]
    ds_read_b64_tr_b16 a[102:103], v5 offset:4608
    v_mfma_f32_16x16x32_bf16 v[36:39], a[112:115], v[216:219], v[36:39]
    ds_read_b64_tr_b16 a[104:105], v4 offset:6144
    v_mfma_f32_16x16x32_bf16 v[44:47], a[112:115], v[220:223], v[44:47]
    ds_read_b64_tr_b16 a[106:107], v4 offset:6656
    v_mfma_f32_16x16x32_bf16 v[52:55], a[116:119], v[216:219], v[52:55]
    s_waitcnt lgkmcnt(6)
    ds_read_b64_tr_b16 a[108:109], v5 offset:6144
    v_mfma_f32_16x16x32_bf16 v[60:63], a[116:119], v[220:223], v[60:63]
    ds_read_b64_tr_b16 a[110:111], v5 offset:6656
    v_mfma_f32_16x16x32_bf16 v[68:71], a[120:123], v[216:219], v[68:71]
    ds_read_b64_tr_b16 a[112:113], v6 offset:4096
    v_mfma_f32_16x16x32_bf16 v[76:79], a[120:123], v[220:223], v[76:79]
    ds_read_b64_tr_b16 a[114:115], v6 offset:4608
    v_mfma_f32_16x16x32_bf16 v[84:87], a[124:127], v[216:219], v[84:87]
    ds_read_b64_tr_b16 a[116:117], v7 offset:4096
    v_mfma_f32_16x16x32_bf16 v[92:95], a[124:127], v[220:223], v[92:95]
    ds_read_b64_tr_b16 a[118:119], v7 offset:4608
    v_mfma_f32_16x16x32_bf16 v[32:35], a[128:131], v[224:227], v[32:35]
    ds_read_b64_tr_b16 a[120:121], v6 offset:6144
    v_mfma_f32_16x16x32_bf16 v[40:43], a[128:131], v[228:231], v[40:43]
    ds_read_b64_tr_b16 a[122:123], v6 offset:6656
    v_mfma_f32_16x16x32_bf16 v[48:51], a[132:135], v[224:227], v[48:51]
    ds_read_b64_tr_b16 a[124:125], v7 offset:6144
    v_mfma_f32_16x16x32_bf16 v[56:59], a[132:135], v[228:231], v[56:59]
    ds_read_b64_tr_b16 a[126:127], v7 offset:6656
    s_waitcnt vmcnt(0)
    v_bfe_u32 v157, v157, 0, 8
    v_cmp_gt_u32 vcc, 4, v157
    s_cbranch_vccnz L_ps1
L_pd1:
    buffer_load_dword v157, v126, s[12:15], 0 offen offset:0 sc1
    buffer_load_dword v158, v127, s[12:15], 0 offen offset:0 sc1
    v_mfma_f32_16x16x32_bf16 v[64:67], a[136:139], v[224:227], v[64:67]
    ds_read_b64_tr_b16 a[128:129], v8 offset:4096
    v_mfma_f32_16x16x32_bf16 v[72:75], a[136:139], v[228:231], v[72:75]
    ds_read_b64_tr_b16 a[130:131], v8 offset:4608
    v_mfma_f32_16x16x32_bf16 v[80:83], a[140:143], v[224:227], v[80:83]
    s_waitcnt lgkmcnt(6)
    ds_read_b64_tr_b16 a[132:133], v9 offset:4096
    v_mfma_f32_16x16x32_bf16 v[88:91], a[140:143], v[228:231], v[88:91]
    ds_read_b64_tr_b16 a[134:135], v9 offset:4608
    v_mfma_f32_16x16x32_bf16 v[36:39], a[96:99], v[224:227], v[36:39]
    ds_read_b64_tr_b16 a[136:137], v8 offset:6144
    v_mfma_f32_16x16x32_bf16 v[44:47], a[96:99], v[228:231], v[44:47]
    ds_read_b64_tr_b16 a[138:139], v8 offset:6656
    v_mfma_f32_16x16x32_bf16 v[52:55], a[100:103], v[224:227], v[52:55]
    ds_read_b64_tr_b16 a[140:141], v9 offset:6144
    v_mfma_f32_16x16x32_bf16 v[60:63], a[100:103], v[228:231], v[60:63]
    ds_read_b64_tr_b16 a[142:143], v9 offset:6656
    v_mfma_f32_16x16x32_bf16 v[68:71], a[104:107], v[224:227], v[68:71]
    s_barrier
    v_mfma_f32_16x16x32_bf16 v[76:79], a[104:107], v[228:231], v[76:79]
    ds_read_b64_tr_b16 a[96:97], v2 offset:8192
    ds_read_b64_tr_b16 a[98:99], v2 offset:8704
    v_mfma_f32_16x16x32_bf16 v[84:87], a[108:111], v[224:227], v[84:87]
    ds_read_b64_tr_b16 a[100:101], v3 offset:8192
    v_mfma_f32_16x16x32_bf16 v[92:95], a[108:111], v[228:231], v[92:95]
    ds_read_b64_tr_b16 a[102:103], v3 offset:8704
    v_mfma_f32_16x16x32_bf16 v[32:35], a[112:115], v[232:235], v[32:35]
    ds_read_b64_tr_b16 a[104:105], v2 offset:10240
    v_mfma_f32_16x16x32_bf16 v[40:43], a[112:115], v[236:239], v[40:43]
    ds_read_b64_tr_b16 a[106:107], v2 offset:10752
    v_mfma_f32_16x16x32_bf16 v[48:51], a[116:119], v[232:235], v[48:51]
    s_waitcnt lgkmcnt(6)
    ds_read_b64_tr_b16 a[108:109], v3 offset:10240
    v_mfma_f32_16x16x32_bf16 v[56:59], a[116:119], v[236:239], v[56:59]
    ds_read_b64_tr_b16 a[110:111], v3 offset:10752
    v_mfma_f32_16x16x32_bf16 v[64:67], a[120:123], v[232:235], v[64:67]
    ds_read_b64_tr_b16 a[112:113], v4 offset:8192
    v_mfma_f32_16x16x32_bf16 v[72:75], a[120:123], v[236:239], v[72:75]
    ds_read_b64_tr_b16 a[114:115], v4 offset:8704
    v_mfma_f32_16x16x32_bf16 v[80:83], a[124:127], v[232:235], v[80:83]
    ds_read_b64_tr_b16 a[116:117], v5 offset:8192
    v_mfma_f32_16x16x32_bf16 v[88:91], a[124:127], v[236:239], v[88:91]
    ds_read_b64_tr_b16 a[118:119], v5 offset:8704
    v_mfma_f32_16x16x32_bf16 v[36:39], a[128:131], v[232:235], v[36:39]
    ds_read_b64_tr_b16 a[120:121], v4 offset:10240
    v_mfma_f32_16x16x32_bf16 v[44:47], a[128:131], v[236:239], v[44:47]
    ds_read_b64_tr_b16 a[122:123], v4 offset:10752
    v_mfma_f32_16x16x32_bf16 v[52:55], a[132:135], v[232:235], v[52:55]
    ds_read_b64_tr_b16 a[124:125], v5 offset:10240
    v_mfma_f32_16x16x32_bf16 v[60:63], a[132:135], v[236:239], v[60:63]
    ds_read_b64_tr_b16 a[126:127], v5 offset:10752
    v_mfma_f32_16x16x32_bf16 v[68:71], a[136:139], v[232:235], v[68:71]
    ds_read_b64_tr_b16 a[128:129], v6 offset:8192
    v_mfma_f32_16x16x32_bf16 v[76:79], a[136:139], v[236:239], v[76:79]
    ds_read_b64_tr_b16 a[130:131], v6 offset:8704
    v_mfma_f32_16x16x32_bf16 v[84:87], a[140:143], v[232:235], v[84:87]
    s_waitcnt lgkmcnt(6)
    ds_read_b64_tr_b16 a[132:133], v7 offset:8192
    v_mfma_f32_16x16x32_bf16 v[92:95], a[140:143], v[236:239], v[92:95]
    ds_read_b64_tr_b16 a[134:135], v7 offset:8704
    v_mfma_f32_16x16x32_bf16 v[32:35], a[96:99], v[240:243], v[32:35]
    ds_read_b64_tr_b16 a[136:137], v6 offset:10240
    v_mfma_f32_16x16x32_bf16 v[40:43], a[96:99], v[244:247], v[40:43]
    ds_read_b64_tr_b16 a[138:139], v6 offset:10752
    v_mfma_f32_16x16x32_bf16 v[48:51], a[100:103], v[240:243], v[48:51]
    ds_read_b64_tr_b16 a[140:141], v7 offset:10240
    v_mfma_f32_16x16x32_bf16 v[56:59], a[100:103], v[244:247], v[56:59]
    ds_read_b64_tr_b16 a[142:143], v7 offset:10752
    s_waitcnt vmcnt(0)
    v_min_u32 v157, v157, v158
    v_cmp_gt_u32 vcc, 1, v157
    s_cbranch_vccnz L_ps2
L_pd2:
    v_mfma_f32_16x16x32_bf16 v[64:67], a[104:107], v[240:243], v[64:67]
    ds_read_b64_tr_b16 a[96:97], v8 offset:8192
    v_mfma_f32_16x16x32_bf16 v[72:75], a[104:107], v[244:247], v[72:75]
    ds_read_b64_tr_b16 a[98:99], v8 offset:8704
    s_add_u32 m0, s48, 12288
    s_add_u32 s4, s65, 0
    buffer_load_dwordx4 v149, s[12:15], s4 offen offset:0 sc1 lds
    v_mfma_f32_16x16x32_bf16 v[80:83], a[108:111], v[240:243], v[80:83]
    ds_read_b64_tr_b16 a[100:101], v9 offset:8192
    v_mfma_f32_16x16x32_bf16 v[88:91], a[108:111], v[244:247], v[88:91]
    ds_read_b64_tr_b16 a[102:103], v9 offset:8704
    v_mfma_f32_16x16x32_bf16 v[36:39], a[112:115], v[240:243], v[36:39]
    ds_read_b64_tr_b16 a[104:105], v8 offset:10240
    v_mfma_f32_16x16x32_bf16 v[44:47], a[112:115], v[244:247], v[44:47]
    ds_read_b64_tr_b16 a[106:107], v8 offset:10752
    s_add_u32 m0, s48, 14336
    s_add_u32 s4, s65, 1024
    buffer_load_dwordx4 v149, s[12:15], s4 offen offset:0 sc1 lds
    v_mfma_f32_16x16x32_bf16 v[52:55], a[116:119], v[240:243], v[52:55]
    s_waitcnt lgkmcnt(6)
    ds_read_b64_tr_b16 a[108:109], v9 offset:10240
    v_mfma_f32_16x16x32_bf16 v[60:63], a[116:119], v[244:247], v[60:63]
    ds_read_b64_tr_b16 a[110:111], v9 offset:10752
    v_mfma_f32_16x16x32_bf16 v[68:71], a[120:123], v[240:243], v[68:71]
    v_mfma_f32_16x16x32_bf16 v[76:79], a[120:123], v[244:247], v[76:79]
    s_add_u32 m0, s48, 13312
    s_add_u32 s4, s65, 123904
    buffer_load_dwordx4 v149, s[12:15], s4 offen offset:0 sc1 lds
    v_mfma_f32_16x16x32_bf16 v[84:87], a[124:127], v[240:243], v[84:87]
    v_mfma_f32_16x16x32_bf16 v[92:95], a[124:127], v[244:247], v[92:95]
    v_mfma_f32_16x16x32_bf16 v[32:35], a[128:131], v[248:251], v[32:35]
    v_mfma_f32_16x16x32_bf16 v[40:43], a[128:131], v[252:255], v[40:43]
    ds_write_b128 v155, v[128:131] offset:39936
    s_add_u32 m0, s48, 15360
    s_add_u32 s4, s65, 124928
    buffer_load_dwordx4 v149, s[12:15], s4 offen offset:0 sc1 lds
    v_mfma_f32_16x16x32_bf16 v[48:51], a[132:135], v[248:251], v[48:51]
    v_mfma_f32_16x16x32_bf16 v[56:59], a[132:135], v[252:255], v[56:59]
    v_mfma_f32_16x16x32_bf16 v[64:67], a[136:139], v[248:251], v[64:67]
    v_mfma_f32_16x16x32_bf16 v[72:75], a[136:139], v[252:255], v[72:75]
    s_add_u32 m0, s48, 35840
    global_load_dwordx4 a[192:195], v144, s[16:17] offset:0 sc1
    v_mfma_f32_16x16x32_bf16 v[80:83], a[140:143], v[248:251], v[80:83]
    s_waitcnt lgkmcnt(1)
    v_mfma_f32_16x16x32_bf16 v[88:91], a[140:143], v[252:255], v[88:91]
    ds_write_b64 v143, v[130:131] offset:28672
    v_mfma_f32_16x16x32_bf16 v[36:39], a[96:99], v[248:251], v[36:39]
    v_mfma_f32_16x16x32_bf16 v[44:47], a[96:99], v[252:255], v[44:47]
    global_load_dwordx2 a[196:197], v145, s[16:17] offset:0 sc1
    v_mfma_f32_16x16x32_bf16 v[52:55], a[100:103], v[248:251], v[52:55]
    v_mfma_f32_16x16x32_bf16 v[60:63], a[100:103], v[252:255], v[60:63]
    v_mfma_f32_16x16x32_bf16 v[68:71], a[104:107], v[248:251], v[68:71]
    v_mfma_f32_16x16x32_bf16 v[76:79], a[104:107], v[252:255], v[76:79]
    global_load_lds_dwordx4 v146, s[16:17] offset:0 sc1
    v_mfma_f32_16x16x32_bf16 v[84:87], a[108:111], v[248:251], v[84:87]
    v_mfma_f32_16x16x32_bf16 v[92:95], a[108:111], v[252:255], v[92:95]
    global_load_lds_dwordx4 v146, s[16:17] offset:1024 sc1
    s_add_u32 m0, s48, 37888
    s_add_u32 s16, s16, 123904
    s_addc_u32 s17, s17, 0
    global_load_lds_dwordx4 v146, s[16:17] offset:0 sc1
    global_load_lds_dwordx4 v146, s[16:17] offset:1024 sc1
    global_load_dwordx4 a[198:201], v144, s[16:17] offset:0 sc1
    global_load_dwordx2 a[202:203], v145, s[16:17] offset:0 sc1
    s_add_u32 s16, s16, 123904
    s_addc_u32 s17, s17, 0
    s_branch L_passb_end
L_passb0:
L_pad4:
    s_cbranch_execz L_pad8
    v_mfma_f32_16x16x32_bf16 a[0:3], a[120:123], v[248:251], a[0:3]
    s_mul_i32 s54, s94, 196608
    ds_read_b64_tr_b16 a[112:113], v2 offset:20480
    v_mfma_f32_16x16x32_bf16 a[8:11], a[120:123], v[252:255], a[8:11]
    ds_read_b64_tr_b16 a[114:115], v2 offset:20992
    v_mfma_f32_16x16x32_bf16 a[4:7], a[124:127], v[248:251], a[4:7]
    s_add_u32 s70, s28, s54
    ds_read_b64_tr_b16 a[116:117], v2 offset:22528
    ds_read_b64_tr_b16 a[118:119], v2 offset:23040
    v_mfma_f32_16x16x32_bf16 a[12:15], a[124:127], v[252:255], a[12:15]
    s_addc_u32 s71, s29, 0
    global_load_lds_dwordx4 v10, s[70:71] offset:0
    v_mfma_f32_16x16x32_bf16 a[16:19], a[128:131], v[224:227], a[16:19]
    s_barrier
    v_mfma_f32_16x16x32_bf16 a[24:27], a[128:131], v[228:231], a[24:27]
    ds_read_b64_tr_b16 a[120:121], v4 offset:20480
    ds_read_b64_tr_b16 a[122:123], v4 offset:20992
    v_mfma_f32_16x16x32_bf16 a[20:23], a[132:135], v[224:227], a[20:23]
    ds_read_b64_tr_b16 a[124:125], v4 offset:22528
    v_mfma_f32_16x16x32_bf16 a[28:31], a[132:135], v[228:231], a[28:31]
    ds_read_b64_tr_b16 a[126:127], v4 offset:23040
    global_load_lds_dwordx4 v11, s[70:71] offset:1024
    v_mfma_f32_16x16x32_bf16 a[16:19], a[136:139], v[232:235], a[16:19]
    ds_read_b64_tr_b16 a[128:129], v6 offset:20480
    v_mfma_f32_16x16x32_bf16 a[24:27], a[136:139], v[236:239], a[24:27]
    ds_read_b64_tr_b16 a[130:131], v6 offset:20992
    v_mfma_f32_16x16x32_bf16 a[20:23], a[140:143], v[232:235], a[20:23]
    s_waitcnt lgkmcnt(6)
    ds_read_b64_tr_b16 a[132:133], v6 offset:22528
    v_accvgpr_read_b32 v16, a0
    v_mfma_f32_16x16x32_bf16 a[28:31], a[140:143], v[236:239], a[28:31]
    ds_read_b64_tr_b16 a[134:135], v6 offset:23040
    v_accvgpr_read_b32 v17, a1
    v_mfma_f32_16x16x32_bf16 a[16:19], a[96:99], v[240:243], a[16:19]
    s_add_u32 s70, s32, s54
    ds_read_b64_tr_b16 a[136:137], v8 offset:20480
    ds_read_b64_tr_b16 a[138:139], v8 offset:20992
    v_mfma_f32_16x16x32_bf16 a[24:27], a[96:99], v[244:247], a[24:27]
    s_addc_u32 s71, s33, 0
    global_load_lds_dwordx4 v10, s[70:71] offset:2048
    v_accvgpr_read_b32 v18, a2
    v_mfma_f32_16x16x32_bf16 a[20:23], a[100:103], v[240:243], a[20:23]
    ds_read_b64_tr_b16 a[140:141], v8 offset:22528
    v_accvgpr_read_b32 v19, a3
    v_mfma_f32_16x16x32_bf16 a[28:31], a[100:103], v[244:247], a[28:31]
    ds_read_b64_tr_b16 a[142:143], v8 offset:23040
    v_accvgpr_read_b32 v20, a4
    v_mfma_f32_16x16x32_bf16 a[16:19], a[104:107], v[248:251], a[16:19]
    ds_read_b64_tr_b16 a[96:97], v2 offset:26624
    v_accvgpr_read_b32 v21, a5
    v_mfma_f32_16x16x32_bf16 a[24:27], a[104:107], v[252:255], a[24:27]
    ds_read_b64_tr_b16 a[98:99], v2 offset:27136
    global_load_lds_dwordx4 v11, s[70:71] offset:3072
    v_mfma_f32_16x16x32_bf16 a[20:23], a[108:111], v[248:251], a[20:23]
    s_add_u32 m0, s48, 12288
    ds_read_b64_tr_b16 a[100:101], v2 offset:28672
    v_accvgpr_read_b32 v22, a6
    v_mfma_f32_16x16x32_bf16 a[28:31], a[108:111], v[252:255], a[28:31]
    ds_read_b64_tr_b16 a[102:103], v2 offset:29184
    v_accvgpr_read_b32 v23, a7
    v_mfma_f32_16x16x32_bf16 a[32:35], a[112:115], v[224:227], a[32:35]
    s_bfe_u32 s94, s92, 0x4000c
    ds_read_b64_tr_b16 a[104:105], v4 offset:26624
    v_mul_f32 v16, s58, v16
    v_mfma_f32_16x16x32_bf16 a[40:43], a[112:115], v[228:231], a[40:43]
    ds_read_b64_tr_b16 a[106:107], v4 offset:27136
    v_mul_f32 v17, s58, v17
    v_mfma_f32_16x16x32_bf16 a[64:67], a[116:119], v[224:227], a[64:67]
    s_waitcnt lgkmcnt(6)
    ds_read_b64_tr_b16 a[108:109], v4 offset:28672
    v_mul_f32 v18, s58, v18
    v_mfma_f32_16x16x32_bf16 a[72:75], a[116:119], v[228:231], a[72:75]
    ds_read_b64_tr_b16 a[110:111], v4 offset:29184
    v_mul_f32 v19, s58, v19
    v_mfma_f32_16x16x32_bf16 a[36:39], a[120:123], v[224:227], a[36:39]
    s_mul_i32 s54, s94, 196608
    ds_read_b64_tr_b16 a[112:113], v6 offset:26624
    v_mul_f32 v20, s58, v20
    v_mfma_f32_16x16x32_bf16 a[44:47], a[120:123], v[228:231], a[44:47]
    ds_read_b64_tr_b16 a[114:115], v6 offset:27136
    v_mul_f32 v21, s58, v21
    v_mfma_f32_16x16x32_bf16 a[68:71], a[124:127], v[224:227], a[68:71]
    s_add_u32 s70, s28, s54
    ds_read_b64_tr_b16 a[116:117], v6 offset:28672
    ds_read_b64_tr_b16 a[118:119], v6 offset:29184
    v_mfma_f32_16x16x32_bf16 a[76:79], a[124:127], v[228:231], a[76:79]
    s_addc_u32 s71, s29, 0
    global_load_lds_dwordx4 v10, s[70:71] offset:0
    v_mul_f32 v22, s58, v22
    v_mfma_f32_16x16x32_bf16 a[32:35], a[128:131], v[232:235], a[32:35]
    ds_read_b64_tr_b16 a[120:121], v8 offset:26624
    v_mul_f32 v23, s58, v23
    v_mfma_f32_16x16x32_bf16 a[40:43], a[128:131], v[236:239], a[40:43]
    ds_read_b64_tr_b16 a[122:123], v8 offset:27136
    v_cvt_pk_bf16_f32 v24, v16, v17
    v_mfma_f32_16x16x32_bf16 a[64:67], a[132:135], v[232:235], a[64:67]
    ds_read_b64_tr_b16 a[124:125], v8 offset:28672
    v_cvt_pk_bf16_f32 v25, v18, v19
    v_mfma_f32_16x16x32_bf16 a[72:75], a[132:135], v[236:239], a[72:75]
    ds_read_b64_tr_b16 a[126:127], v8 offset:29184
    global_load_lds_dwordx4 v11, s[70:71] offset:1024
    v_mfma_f32_16x16x32_bf16 a[36:39], a[136:139], v[232:235], a[36:39]
    ds_read_b64_tr_b16 a[128:129], v3 offset:20480
    v_cvt_pk_bf16_f32 v26, v20, v21
    v_mfma_f32_16x16x32_bf16 a[44:47], a[136:139], v[236:239], a[44:47]
    ds_read_b64_tr_b16 a[130:131], v3 offset:20992
    v_cvt_pk_bf16_f32 v27, v22, v23
    v_mfma_f32_16x16x32_bf16 a[68:71], a[140:143], v[232:235], a[68:71]
    s_waitcnt lgkmcnt(6)
    ds_read_b64_tr_b16 a[132:133], v3 offset:22528
    buffer_store_dwordx4 v[24:27], v13, s[12:15], s55 offen offset:0 sc1
    v_mfma_f32_16x16x32_bf16 a[76:79], a[140:143], v[236:239], a[76:79]
    ds_read_b64_tr_b16 a[134:135], v3 offset:23040
    v_accvgpr_read_b32 v16, a8
    v_mfma_f32_16x16x32_bf16 a[32:35], a[96:99], v[240:243], a[32:35]
    s_add_u32 s70, s32, s54
    ds_read_b64_tr_b16 a[136:137], v5 offset:20480
    ds_read_b64_tr_b16 a[138:139], v5 offset:20992
    v_mfma_f32_16x16x32_bf16 a[40:43], a[96:99], v[244:247], a[40:43]
    s_addc_u32 s71, s33, 0
    global_load_lds_dwordx4 v10, s[70:71] offset:2048
    v_accvgpr_read_b32 v17, a9
    v_mfma_f32_16x16x32_bf16 a[64:67], a[100:103], v[240:243], a[64:67]
    ds_read_b64_tr_b16 a[140:141], v5 offset:22528
    v_accvgpr_read_b32 v18, a10
    v_mfma_f32_16x16x32_bf16 a[72:75], a[100:103], v[244:247], a[72:75]
    ds_read_b64_tr_b16 a[142:143], v5 offset:23040
    v_accvgpr_read_b32 v19, a11
    v_mfma_f32_16x16x32_bf16 a[36:39], a[104:107], v[240:243], a[36:39]
    ds_read_b64_tr_b16 a[96:97], v7 offset:20480
    v_accvgpr_read_b32 v20, a12
    v_mfma_f32_16x16x32_bf16 a[44:47], a[104:107], v[244:247], a[44:47]
    ds_read_b64_tr_b16 a[98:99], v7 offset:20992
    global_load_lds_dwordx4 v11, s[70:71] offset:3072
    v_mfma_f32_16x16x32_bf16 a[68:71], a[108:111], v[240:243], a[68:71]
    ds_read_b64_tr_b16 a[100:101], v7 offset:22528
    v_accvgpr_read_b32 v21, a13
    v_mfma_f32_16x16x32_bf16 a[76:79], a[108:111], v[244:247], a[76:79]
    ds_read_b64_tr_b16 a[102:103], v7 offset:23040
    v_accvgpr_read_b32 v22, a14
    v_mfma_f32_16x16x32_bf16 a[32:35], a[112:115], v[248:251], a[32:35]
    ds_read_b64_tr_b16 a[104:105], v9 offset:20480
    v_accvgpr_read_b32 v23, a15
    v_mfma_f32_16x16x32_bf16 a[40:43], a[112:115], v[252:255], a[40:43]
L_pad5:
    s_cbranch_execz L_pad9
    ds_read_b64_tr_b16 a[106:107], v9 offset:20992
    v_mul_f32 v16, s58, v16
    v_mfma_f32_16x16x32_bf16 a[64:67], a[116:119], v[248:251], a[64:67]
    s_waitcnt lgkmcnt(6)
    ds_read_b64_tr_b16 a[108:109], v9 offset:22528
    v_mul_f32 v17, s58, v17
    v_mfma_f32_16x16x32_bf16 a[72:75], a[116:119], v[252:255], a[72:75]
    ds_read_b64_tr_b16 a[110:111], v9 offset:23040
    v_mul_f32 v18, s58, v18
    v_mfma_f32_16x16x32_bf16 a[36:39], a[120:123], v[248:251], a[36:39]
    ds_read_b64_tr_b16 a[112:113], v3 offset:26624
    v_mul_f32 v19, s58, v19
    v_mfma_f32_16x16x32_bf16 a[44:47], a[120:123], v[252:255], a[44:47]
    ds_read_b64_tr_b16 a[114:115], v3 offset:27136
    v_mul_f32 v20, s58, v20
    v_mfma_f32_16x16x32_bf16 a[68:71], a[124:127], v[248:251], a[68:71]
    ds_read_b64_tr_b16 a[116:117], v3 offset:28672
    v_mul_f32 v21, s58, v21
    v_mfma_f32_16x16x32_bf16 a[76:79], a[124:127], v[252:255], a[76:79]
    ds_read_b64_tr_b16 a[118:119], v3 offset:29184
    v_mul_f32 v22, s58, v22
    v_mfma_f32_16x16x32_bf16 a[48:51], a[128:131], v[224:227], a[48:51]
    ds_read_b64_tr_b16 a[120:121], v5 offset:26624
    v_mul_f32 v23, s58, v23
    v_mfma_f32_16x16x32_bf16 a[56:59], a[128:131], v[228:231], a[56:59]
    ds_read_b64_tr_b16 a[122:123], v5 offset:27136
    v_cvt_pk_bf16_f32 v28, v16, v17
    v_mfma_f32_16x16x32_bf16 a[80:83], a[132:135], v[224:227], a[80:83]
    ds_read_b64_tr_b16 a[124:125], v5 offset:28672
    v_cvt_pk_bf16_f32 v29, v18, v19
    v_mfma_f32_16x16x32_bf16 a[88:91], a[132:135], v[228:231], a[88:91]
    ds_read_b64_tr_b16 a[126:127], v5 offset:29184
    v_cvt_pk_bf16_f32 v30, v20, v21
    v_mfma_f32_16x16x32_bf16 a[52:55], a[136:139], v[224:227], a[52:55]
    ds_read_b64_tr_b16 a[128:129], v7 offset:26624
    v_cvt_pk_bf16_f32 v31, v22, v23
    v_mfma_f32_16x16x32_bf16 a[60:63], a[136:139], v[228:231], a[60:63]
    ds_read_b64_tr_b16 a[130:131], v7 offset:27136
    buffer_store_dwordx4 v[28:31], v13, s[12:15], s55 offen offset:256 sc1
    v_mfma_f32_16x16x32_bf16 a[84:87], a[140:143], v[224:227], a[84:87]
    s_waitcnt lgkmcnt(6)
    ds_read_b64_tr_b16 a[132:133], v7 offset:28672
    v_accvgpr_read_b32 v16, a16
    v_mfma_f32_16x16x32_bf16 a[92:95], a[140:143], v[228:231], a[92:95]
    ds_read_b64_tr_b16 a[134:135], v7 offset:29184
    v_accvgpr_read_b32 v17, a17
    v_mfma_f32_16x16x32_bf16 a[48:51], a[96:99], v[232:235], a[48:51]
    ds_read_b64_tr_b16 a[136:137], v9 offset:26624
    v_accvgpr_read_b32 v18, a18
    v_mfma_f32_16x16x32_bf16 a[56:59], a[96:99], v[236:239], a[56:59]
    ds_read_b64_tr_b16 a[138:139], v9 offset:27136
    v_accvgpr_read_b32 v19, a19
    v_mfma_f32_16x16x32_bf16 a[80:83], a[100:103], v[232:235], a[80:83]
    ds_read_b64_tr_b16 a[140:141], v9 offset:28672
    v_accvgpr_read_b32 v20, a20
    v_mfma_f32_16x16x32_bf16 a[88:91], a[100:103], v[236:239], a[88:91]
    ds_read_b64_tr_b16 a[142:143], v9 offset:29184
    v_accvgpr_read_b32 v21, a21
    v_mfma_f32_16x16x32_bf16 a[52:55], a[104:107], v[232:235], a[52:55]
    s_waitcnt vmcnt(14)
    s_barrier
    v_mfma_f32_16x16x32_bf16 a[60:63], a[104:107], v[236:239], a[60:63]
    ds_read_b64_tr_b16 a[96:97], v2 offset:0
    ds_read_b64_tr_b16 a[98:99], v2 offset:512
    v_mfma_f32_16x16x32_bf16 a[84:87], a[108:111], v[232:235], a[84:87]
    ds_read_b64_tr_b16 a[100:101], v3 offset:0
    v_accvgpr_read_b32 v22, a22
    v_mfma_f32_16x16x32_bf16 a[92:95], a[108:111], v[236:239], a[92:95]
    ds_read_b64_tr_b16 a[102:103], v3 offset:512
    v_accvgpr_read_b32 v23, a23
    v_mfma_f32_16x16x32_bf16 a[48:51], a[112:115], v[240:243], a[48:51]
    ds_read_b64_tr_b16 a[104:105], v2 offset:2048
    v_mul_f32 v16, s58, v16
    v_mfma_f32_16x16x32_bf16 a[56:59], a[112:115], v[244:247], a[56:59]
    ds_read_b64_tr_b16 a[106:107], v2 offset:2560
    v_mul_f32 v17, s58, v17
    v_mfma_f32_16x16x32_bf16 a[80:83], a[116:119], v[240:243], a[80:83]
    s_waitcnt lgkmcnt(6)
    ds_read_b64_tr_b16 a[108:109], v3 offset:2048
    v_mul_f32 v18, s58, v18
    v_mfma_f32_16x16x32_bf16 a[88:91], a[116:119], v[244:247], a[88:91]
    ds_read_b64_tr_b16 a[110:111], v3 offset:2560
    v_mul_f32 v19, s58, v19
    v_mfma_f32_16x16x32_bf16 a[52:55], a[120:123], v[240:243], a[52:55]
    ds_read_b64_tr_b16 a[112:113], v4 offset:0
    v_mul_f32 v20, s58, v20
    v_mfma_f32_16x16x32_bf16 a[60:63], a[120:123], v[244:247], a[60:63]
    ds_read_b64_tr_b16 a[114:115], v4 offset:512
    v_mul_f32 v21, s58, v21
    v_mfma_f32_16x16x32_bf16 a[84:87], a[124:127], v[240:243], a[84:87]
    ds_read_b64_tr_b16 a[116:117], v5 offset:0
    v_mul_f32 v22, s58, v22
    v_mfma_f32_16x16x32_bf16 a[92:95], a[124:127], v[244:247], a[92:95]
    ds_read_b64_tr_b16 a[118:119], v5 offset:512
    v_mul_f32 v23, s58, v23
    v_mfma_f32_16x16x32_bf16 a[48:51], a[128:131], v[248:251], a[48:51]
    ds_read_b64_tr_b16 a[120:121], v4 offset:2048
    v_cvt_pk_bf16_f32 v24, v16, v17
    v_mfma_f32_16x16x32_bf16 a[56:59], a[128:131], v[252:255], a[56:59]
    ds_read_b64_tr_b16 a[122:123], v4 offset:2560
    v_cvt_pk_bf16_f32 v25, v18, v19
    v_mfma_f32_16x16x32_bf16 a[80:83], a[132:135], v[248:251], a[80:83]
    ds_read_b64_tr_b16 a[124:125], v5 offset:2048
    v_cvt_pk_bf16_f32 v26, v20, v21
    v_mfma_f32_16x16x32_bf16 a[88:91], a[132:135], v[252:255], a[88:91]
    ds_read_b64_tr_b16 a[126:127], v5 offset:2560
    v_cvt_pk_bf16_f32 v27, v22, v23
    v_mfma_f32_16x16x32_bf16 a[52:55], a[136:139], v[248:251], a[52:55]
    ds_read_b64_tr_b16 a[128:129], v6 offset:0
    buffer_store_dwordx4 v[24:27], v13, s[12:15], s55 offen offset:2048 sc1
    v_mfma_f32_16x16x32_bf16 a[60:63], a[136:139], v[252:255], a[60:63]
    ds_read_b64_tr_b16 a[130:131], v6 offset:512
    v_accvgpr_read_b32 v16, a24
    v_mfma_f32_16x16x32_bf16 a[84:87], a[140:143], v[248:251], a[84:87]
    s_waitcnt lgkmcnt(6)
    ds_read_b64_tr_b16 a[132:133], v7 offset:0
    v_accvgpr_read_b32 v17, a25
    v_mfma_f32_16x16x32_bf16 a[92:95], a[140:143], v[252:255], a[92:95]
    ds_read_b64_tr_b16 a[134:135], v7 offset:512
    v_accvgpr_read_b32 v18, a26
    v_mfma_f32_16x16x32_bf16 v[32:35], a[96:99], v[96:99], 0
    ds_read_b64_tr_b16 a[136:137], v6 offset:2048
    v_accvgpr_read_b32 v19, a27
    v_mfma_f32_16x16x32_bf16 v[40:43], a[96:99], v[100:103], 0
    ds_read_b64_tr_b16 a[138:139], v6 offset:2560
    v_accvgpr_read_b32 v20, a28
    v_mfma_f32_16x16x32_bf16 v[48:51], a[100:103], v[96:99], 0
    ds_read_b64_tr_b16 a[140:141], v7 offset:2048
    v_accvgpr_read_b32 v21, a29
    v_mfma_f32_16x16x32_bf16 v[56:59], a[100:103], v[100:103], 0
    ds_read_b64_tr_b16 a[142:143], v7 offset:2560
    v_accvgpr_read_b32 v22, a30
    v_mfma_f32_16x16x32_bf16 v[64:67], a[104:107], v[96:99], 0
    ds_read_b64_tr_b16 a[96:97], v8 offset:0
    v_accvgpr_read_b32 v23, a31
    v_mfma_f32_16x16x32_bf16 v[72:75], a[104:107], v[100:103], 0
    ds_read_b64_tr_b16 a[98:99], v8 offset:512
    v_mul_f32 v16, s58, v16
    v_mfma_f32_16x16x32_bf16 v[80:83], a[108:111], v[96:99], 0
    ds_read_b64_tr_b16 a[100:101], v9 offset:0
    v_mul_f32 v17, s58, v17
    v_mfma_f32_16x16x32_bf16 v[88:91], a[108:111], v[100:103], 0
    ds_read_b64_tr_b16 a[102:103], v9 offset:512
    v_mul_f32 v18, s58, v18
    v_mfma_f32_16x16x32_bf16 v[36:39], a[112:115], v[96:99], 0
    ds_read_b64_tr_b16 a[104:105], v8 offset:2048
    v_mul_f32 v19, s58, v19
    v_mfma_f32_16x16x32_bf16 v[44:47], a[112:115], v[100:103], 0
    ds_read_b64_tr_b16 a[106:107], v8 offset:2560
    v_mul_f32 v20, s58, v20
    v_mfma_f32_16x16x32_bf16 v[52:55], a[116:119], v[96:99], 0
    s_waitcnt lgkmcnt(6)
    ds_read_b64_tr_b16 a[108:109], v9 offset:2048
    v_mul_f32 v21, s58, v21
    v_mfma_f32_16x16x32_bf16 v[60:63], a[116:119], v[100:103], 0
    ds_read_b64_tr_b16 a[110:111], v9 offset:2560
    v_mul_f32 v22, s58, v22
    v_mfma_f32_16x16x32_bf16 v[68:71], a[120:123], v[96:99], 0
    s_waitcnt vmcnt(11)
    s_barrier
    v_mfma_f32_16x16x32_bf16 v[76:79], a[120:123], v[100:103], 0
    ds_read_b64_tr_b16 a[112:113], v2 offset:4096
    ds_read_b64_tr_b16 a[114:115], v2 offset:4608
    v_mfma_f32_16x16x32_bf16 v[84:87], a[124:127], v[96:99], 0
    s_add_u32 m0, s48, 16384
    ds_read_b64_tr_b16 a[116:117], v3 offset:4096
    v_mul_f32 v23, s58, v23
    v_mfma_f32_16x16x32_bf16 v[92:95], a[124:127], v[100:103], 0
    ds_read_b64_tr_b16 a[118:119], v3 offset:4608
    v_cvt_pk_bf16_f32 v28, v16, v17
    v_mfma_f32_16x16x32_bf16 v[32:35], a[128:131], v[104:107], v[32:35]
    s_bfe_u32 s94, s92, 0x40010
    ds_read_b64_tr_b16 a[120:121], v2 offset:6144
    v_cvt_pk_bf16_f32 v29, v18, v19
    v_mfma_f32_16x16x32_bf16 v[40:43], a[128:131], v[108:111], v[40:43]
    ds_read_b64_tr_b16 a[122:123], v2 offset:6656
    v_cvt_pk_bf16_f32 v30, v20, v21
    v_mfma_f32_16x16x32_bf16 v[48:51], a[132:135], v[104:107], v[48:51]
    s_mul_i32 s54, s94, 196608
    ds_read_b64_tr_b16 a[124:125], v3 offset:6144
    v_cvt_pk_bf16_f32 v31, v22, v23
    v_mfma_f32_16x16x32_bf16 v[56:59], a[132:135], v[108:111], v[56:59]
    ds_read_b64_tr_b16 a[126:127], v3 offset:6656
    buffer_store_dwordx4 v[28:31], v13, s[12:15], s55 offen offset:2304 sc1
    v_mfma_f32_16x16x32_bf16 v[64:67], a[136:139], v[104:107], v[64:67]
    s_add_u32 s70, s28, s54
    ds_read_b64_tr_b16 a[128:129], v4 offset:4096
    ds_read_b64_tr_b16 a[130:131], v4 offset:4608
    v_mfma_f32_16x16x32_bf16 v[72:75], a[136:139], v[108:111], v[72:75]
    s_addc_u32 s71, s29, 0
    global_load_lds_dwordx4 v10, s[70:71] offset:0
    v_accvgpr_read_b32 v16, a32
    v_mfma_f32_16x16x32_bf16 v[80:83], a[140:143], v[104:107], v[80:83]
    s_waitcnt lgkmcnt(6)
    ds_read_b64_tr_b16 a[132:133], v5 offset:4096
    v_accvgpr_read_b32 v17, a33
    v_mfma_f32_16x16x32_bf16 v[88:91], a[140:143], v[108:111], v[88:91]
    ds_read_b64_tr_b16 a[134:135], v5 offset:4608
    v_accvgpr_read_b32 v18, a34
    v_mfma_f32_16x16x32_bf16 v[36:39], a[96:99], v[104:107], v[36:39]
    ds_read_b64_tr_b16 a[136:137], v4 offset:6144
    v_accvgpr_read_b32 v19, a35
    v_mfma_f32_16x16x32_bf16 v[44:47], a[96:99], v[108:111], v[44:47]
    ds_read_b64_tr_b16 a[138:139], v4 offset:6656
    global_load_lds_dwordx4 v11, s[70:71] offset:1024
    v_mfma_f32_16x16x32_bf16 v[52:55], a[100:103], v[104:107], v[52:55]
    ds_read_b64_tr_b16 a[140:141], v5 offset:6144
    v_accvgpr_read_b32 v20, a64
    v_mfma_f32_16x16x32_bf16 v[60:63], a[100:103], v[108:111], v[60:63]
    ds_read_b64_tr_b16 a[142:143], v5 offset:6656
    v_accvgpr_read_b32 v21, a65
    v_mfma_f32_16x16x32_bf16 v[68:71], a[104:107], v[104:107], v[68:71]
    s_add_u32 s70, s32, s54
    ds_read_b64_tr_b16 a[96:97], v6 offset:4096
    ds_read_b64_tr_b16 a[98:99], v6 offset:4608
    v_mfma_f32_16x16x32_bf16 v[76:79], a[104:107], v[108:111], v[76:79]
    s_addc_u32 s71, s33, 0
    global_load_lds_dwordx4 v10, s[70:71] offset:2048
    v_accvgpr_read_b32 v22, a66
    v_mfma_f32_16x16x32_bf16 v[84:87], a[108:111], v[104:107], v[84:87]
    ds_read_b64_tr_b16 a[100:101], v7 offset:4096
    v_accvgpr_read_b32 v23, a67
    v_mfma_f32_16x16x32_bf16 v[92:95], a[108:111], v[108:111], v[92:95]
    ds_read_b64_tr_b16 a[102:103], v7 offset:4608
    v_mul_f32 v24, 0xbfb8aa3b, v16
    v_mfma_f32_16x16x32_bf16 v[32:35], a[112:115], v[112:115], v[32:35]
    ds_read_b64_tr_b16 a[104:105], v6 offset:6144
    v_mul_f32 v25, 0xbfb8aa3b, v17
    v_mfma_f32_16x16x32_bf16 v[40:43], a[112:115], v[116:119], v[40:43]
    ds_read_b64_tr_b16 a[106:107], v6 offset:6656
    global_load_lds_dwordx4 v11, s[70:71] offset:3072
    v_mfma_f32_16x16x32_bf16 v[48:51], a[116:119], v[112:115], v[48:51]
    s_waitcnt lgkmcnt(6)
    ds_read_b64_tr_b16 a[108:109], v7 offset:6144
    v_mul_f32 v26, 0xbfb8aa3b, v18
    v_mfma_f32_16x16x32_bf16 v[56:59], a[116:119], v[116:119], v[56:59]
    ds_read_b64_tr_b16 a[110:111], v7 offset:6656
    v_mul_f32 v27, 0xbfb8aa3b, v19
    v_mfma_f32_16x16x32_bf16 v[64:67], a[120:123], v[112:115], v[64:67]
    s_add_u32 m0, s48, 20480
    ds_read_b64_tr_b16 a[112:113], v8 offset:4096
    ds_read_b64_tr_b16 a[114:115], v8 offset:4608
    v_mfma_f32_16x16x32_bf16 v[72:75], a[120:123], v[116:119], v[72:75]
    v_exp_f32 v24, v24
    v_mfma_f32_16x16x32_bf16 v[80:83], a[124:127], v[112:115], v[80:83]
    s_bfe_u32 s94, s92, 0x40014
    ds_read_b64_tr_b16 a[116:117], v9 offset:4096
    ds_read_b64_tr_b16 a[118:119], v9 offset:4608
    v_mfma_f32_16x16x32_bf16 v[88:91], a[124:127], v[116:119], v[88:91]
    v_exp_f32 v25, v25
    v_mfma_f32_16x16x32_bf16 v[36:39], a[128:131], v[112:115], v[36:39]
    s_mul_i32 s54, s94, 196608
    ds_read_b64_tr_b16 a[120:121], v8 offset:6144
    ds_read_b64_tr_b16 a[122:123], v8 offset:6656
    v_mfma_f32_16x16x32_bf16 v[44:47], a[128:131], v[116:119], v[44:47]
    v_exp_f32 v26, v26
    v_mfma_f32_16x16x32_bf16 v[52:55], a[132:135], v[112:115], v[52:55]
    s_add_u32 s70, s28, s54
    ds_read_b64_tr_b16 a[124:125], v9 offset:6144
    ds_read_b64_tr_b16 a[126:127], v9 offset:6656
    v_mfma_f32_16x16x32_bf16 v[60:63], a[132:135], v[116:119], v[60:63]
    s_addc_u32 s71, s29, 0
    global_load_lds_dwordx4 v10, s[70:71] offset:0
    v_mfma_f32_16x16x32_bf16 v[68:71], a[136:139], v[112:115], v[68:71]
    s_waitcnt vmcnt(13)
    s_barrier
    v_mfma_f32_16x16x32_bf16 v[76:79], a[136:139], v[116:119], v[76:79]
    ds_read_b64_tr_b16 a[128:129], v2 offset:8192
    ds_read_b64_tr_b16 a[130:131], v2 offset:8704
    v_mfma_f32_16x16x32_bf16 v[84:87], a[140:143], v[112:115], v[84:87]
    s_waitcnt lgkmcnt(6)
    ds_read_b64_tr_b16 a[132:133], v3 offset:8192
    v_mfma_f32_16x16x32_bf16 v[92:95], a[140:143], v[116:119], v[92:95]
    ds_read_b64_tr_b16 a[134:135], v3 offset:8704
    global_load_lds_dwordx4 v11, s[70:71] offset:1024
    v_mfma_f32_16x16x32_bf16 v[32:35], a[96:99], v[120:123], v[32:35]
    ds_read_b64_tr_b16 a[136:137], v2 offset:10240
    ds_read_b64_tr_b16 a[138:139], v2 offset:10752
    v_mfma_f32_16x16x32_bf16 v[40:43], a[96:99], v[124:127], v[40:43]
    v_exp_f32 v27, v27
    v_mfma_f32_16x16x32_bf16 v[48:51], a[100:103], v[120:123], v[48:51]
    s_add_u32 s70, s32, s54
    ds_read_b64_tr_b16 a[140:141], v3 offset:10240
    ds_read_b64_tr_b16 a[142:143], v3 offset:10752
    v_mfma_f32_16x16x32_bf16 v[56:59], a[100:103], v[124:127], v[56:59]
    s_addc_u32 s71, s33, 0
    global_load_lds_dwordx4 v10, s[70:71] offset:2048
    v_mul_f32 v16, v16, v20
    v_mfma_f32_16x16x32_bf16 v[64:67], a[104:107], v[120:123], v[64:67]
    ds_read_b64_tr_b16 a[96:97], v4 offset:8192
    v_mul_f32 v17, v17, v21
    v_mfma_f32_16x16x32_bf16 v[72:75], a[104:107], v[124:127], v[72:75]
    ds_read_b64_tr_b16 a[98:99], v4 offset:8704
    v_mul_f32 v18, v18, v22
    v_mfma_f32_16x16x32_bf16 v[80:83], a[108:111], v[120:123], v[80:83]
    ds_read_b64_tr_b16 a[100:101], v5 offset:8192
    v_mul_f32 v19, v19, v23
    v_mfma_f32_16x16x32_bf16 v[88:91], a[108:111], v[124:127], v[88:91]
    ds_read_b64_tr_b16 a[102:103], v5 offset:8704
    global_load_lds_dwordx4 v11, s[70:71] offset:3072
    v_mfma_f32_16x16x32_bf16 v[36:39], a[112:115], v[120:123], v[36:39]
    s_add_u32 m0, s48, 24576
    ds_read_b64_tr_b16 a[104:105], v4 offset:10240
    v_add_f32 v24, 1.0, v24
    v_mfma_f32_16x16x32_bf16 v[44:47], a[112:115], v[124:127], v[44:47]
    ds_read_b64_tr_b16 a[106:107], v4 offset:10752
    v_add_f32 v25, 1.0, v25
    v_mfma_f32_16x16x32_bf16 v[52:55], a[116:119], v[120:123], v[52:55]
    s_waitcnt lgkmcnt(6)
    ds_read_b64_tr_b16 a[108:109], v5 offset:10240
    v_add_f32 v26, 1.0, v26
    v_mfma_f32_16x16x32_bf16 v[60:63], a[116:119], v[124:127], v[60:63]
    ds_read_b64_tr_b16 a[110:111], v5 offset:10752
    v_add_f32 v27, 1.0, v27
    v_mfma_f32_16x16x32_bf16 v[68:71], a[120:123], v[120:123], v[68:71]
    s_bfe_u32 s94, s92, 0x40018
    ds_read_b64_tr_b16 a[112:113], v6 offset:8192
    ds_read_b64_tr_b16 a[114:115], v6 offset:8704
    v_mfma_f32_16x16x32_bf16 v[76:79], a[120:123], v[124:127], v[76:79]
    v_rcp_f32 v24, v24
    v_mfma_f32_16x16x32_bf16 v[84:87], a[124:127], v[120:123], v[84:87]
    s_mul_i32 s54, s94, 196608
    ds_read_b64_tr_b16 a[116:117], v7 offset:8192
    ds_read_b64_tr_b16 a[118:119], v7 offset:8704
    v_mfma_f32_16x16x32_bf16 v[92:95], a[124:127], v[124:127], v[92:95]
    v_rcp_f32 v25, v25
    v_mfma_f32_16x16x32_bf16 v[32:35], a[128:131], v[128:131], v[32:35]
    s_add_u32 s70, s28, s54
    ds_read_b64_tr_b16 a[120:121], v6 offset:10240
    ds_read_b64_tr_b16 a[122:123], v6 offset:10752
    v_mfma_f32_16x16x32_bf16 v[40:43], a[128:131], v[132:135], v[40:43]
    s_addc_u32 s71, s29, 0
    global_load_lds_dwordx4 v10, s[70:71] offset:0
    v_mfma_f32_16x16x32_bf16 v[48:51], a[132:135], v[128:131], v[48:51]
    ds_read_b64_tr_b16 a[124:125], v7 offset:10240
    ds_read_b64_tr_b16 a[126:127], v7 offset:10752
    v_mfma_f32_16x16x32_bf16 v[56:59], a[132:135], v[132:135], v[56:59]
    v_rcp_f32 v26, v26
    v_mfma_f32_16x16x32_bf16 v[64:67], a[136:139], v[128:131], v[64:67]
    ds_read_b64_tr_b16 a[128:129], v8 offset:8192
    v_mfma_f32_16x16x32_bf16 v[72:75], a[136:139], v[132:135], v[72:75]
    ds_read_b64_tr_b16 a[130:131], v8 offset:8704
    global_load_lds_dwordx4 v11, s[70:71] offset:1024
    v_mfma_f32_16x16x32_bf16 v[80:83], a[140:143], v[128:131], v[80:83]
    s_waitcnt lgkmcnt(6)
    ds_read_b64_tr_b16 a[132:133], v9 offset:8192
    ds_read_b64_tr_b16 a[134:135], v9 offset:8704
    v_mfma_f32_16x16x32_bf16 v[88:91], a[140:143], v[132:135], v[88:91]
    v_rcp_f32 v27, v27
    v_mfma_f32_16x16x32_bf16 v[36:39], a[96:99], v[128:131], v[36:39]
    s_add_u32 s70, s32, s54
    ds_read_b64_tr_b16 a[136:137], v8 offset:10240
    ds_read_b64_tr_b16 a[138:139], v8 offset:10752
    v_mfma_f32_16x16x32_bf16 v[44:47], a[96:99], v[132:135], v[44:47]
    s_addc_u32 s71, s33, 0
    global_load_lds_dwordx4 v10, s[70:71] offset:2048
    v_mul_f32 v16, v16, v24
    v_mfma_f32_16x16x32_bf16 v[52:55], a[100:103], v[128:131], v[52:55]
    ds_read_b64_tr_b16 a[140:141], v9 offset:10240
    v_mul_f32 v17, v17, v25
    v_mfma_f32_16x16x32_bf16 v[60:63], a[100:103], v[132:135], v[60:63]
    ds_read_b64_tr_b16 a[142:143], v9 offset:10752
    v_mul_f32 v18, v18, v26
    v_mfma_f32_16x16x32_bf16 v[68:71], a[104:107], v[128:131], v[68:71]
    s_waitcnt vmcnt(14)
    s_barrier
    v_mfma_f32_16x16x32_bf16 v[76:79], a[104:107], v[132:135], v[76:79]
    ds_read_b64_tr_b16 a[96:97], v2 offset:12288
    ds_read_b64_tr_b16 a[98:99], v2 offset:12800
    v_mfma_f32_16x16x32_bf16 v[84:87], a[108:111], v[128:131], v[84:87]
    ds_read_b64_tr_b16 a[100:101], v3 offset:12288
    v_mul_f32 v19, v19, v27
    v_mfma_f32_16x16x32_bf16 v[92:95], a[108:111], v[132:135], v[92:95]
    ds_read_b64_tr_b16 a[102:103], v3 offset:12800
    global_load_lds_dwordx4 v11, s[70:71] offset:3072
    v_accvgpr_read_b32 v96, a240
    v_mfma_f32_16x16x32_bf16 v[32:35], a[112:115], v[136:139], v[32:35]
    s_add_u32 m0, s48, 0
    ds_read_b64_tr_b16 a[104:105], v2 offset:14336
    ds_read_b64_tr_b16 a[106:107], v2 offset:14848
    v_mfma_f32_16x16x32_bf16 v[40:43], a[112:115], v[140:143], v[40:43]
    s_waitcnt vmcnt(12)
    buffer_store_dword v14, v96, s[12:15], 0 offen offset:0 sc1
    v_mfma_f32_16x16x32_bf16 v[48:51], a[116:119], v[136:139], v[48:51]
    s_waitcnt lgkmcnt(6)
    ds_read_b64_tr_b16 a[108:109], v3 offset:14336
    v_cvt_pk_bf16_f32 v28, v16, v17
    v_mfma_f32_16x16x32_bf16 v[56:59], a[116:119], v[140:143], v[56:59]
    ds_read_b64_tr_b16 a[110:111], v3 offset:14848
    v_cvt_pk_bf16_f32 v29, v18, v19
    v_mfma_f32_16x16x32_bf16 v[64:67], a[120:123], v[136:139], v[64:67]
    s_bfe_u32 s94, s92, 0x4001c
    ds_read_b64_tr_b16 a[112:113], v4 offset:12288
    v_accvgpr_write_b32 a32, v28
    v_mfma_f32_16x16x32_bf16 v[72:75], a[120:123], v[140:143], v[72:75]
    ds_read_b64_tr_b16 a[114:115], v4 offset:12800
    v_accvgpr_write_b32 a33, v29
    v_mfma_f32_16x16x32_bf16 v[80:83], a[124:127], v[136:139], v[80:83]
    s_mul_i32 s54, s94, 196608
    ds_read_b64_tr_b16 a[116:117], v5 offset:12288
    v_accvgpr_read_b32 v16, a36
    v_mfma_f32_16x16x32_bf16 v[88:91], a[124:127], v[140:143], v[88:91]
    ds_read_b64_tr_b16 a[118:119], v5 offset:12800
    v_accvgpr_read_b32 v17, a37
    v_mfma_f32_16x16x32_bf16 v[36:39], a[128:131], v[136:139], v[36:39]
    s_add_u32 s70, s28, s54
    ds_read_b64_tr_b16 a[120:121], v4 offset:14336
    ds_read_b64_tr_b16 a[122:123], v4 offset:14848
    v_mfma_f32_16x16x32_bf16 v[44:47], a[128:131], v[140:143], v[44:47]
    s_addc_u32 s71, s29, 0
    global_load_lds_dwordx4 v10, s[70:71] offset:0
    v_accvgpr_read_b32 v18, a38
    v_mfma_f32_16x16x32_bf16 v[52:55], a[132:135], v[136:139], v[52:55]
    ds_read_b64_tr_b16 a[124:125], v5 offset:14336
    v_accvgpr_read_b32 v19, a39
    v_mfma_f32_16x16x32_bf16 v[60:63], a[132:135], v[140:143], v[60:63]
    ds_read_b64_tr_b16 a[126:127], v5 offset:14848
    v_accvgpr_read_b32 v20, a68
    v_mfma_f32_16x16x32_bf16 v[68:71], a[136:139], v[136:139], v[68:71]
    ds_read_b64_tr_b16 a[128:129], v6 offset:12288
    v_accvgpr_read_b32 v21, a69
    v_mfma_f32_16x16x32_bf16 v[76:79], a[136:139], v[140:143], v[76:79]
    ds_read_b64_tr_b16 a[130:131], v6 offset:12800
    global_load_lds_dwordx4 v11, s[70:71] offset:1024
    v_mfma_f32_16x16x32_bf16 v[84:87], a[140:143], v[136:139], v[84:87]
    s_waitcnt lgkmcnt(6)
    ds_read_b64_tr_b16 a[132:133], v7 offset:12288
    v_accvgpr_read_b32 v22, a70
    v_mfma_f32_16x16x32_bf16 v[92:95], a[140:143], v[140:143], v[92:95]
    ds_read_b64_tr_b16 a[134:135], v7 offset:12800
    v_accvgpr_read_b32 v23, a71
    v_mfma_f32_16x16x32_bf16 v[32:35], a[96:99], v[144:147], v[32:35]
    s_add_u32 s70, s32, s54
    ds_read_b64_tr_b16 a[136:137], v6 offset:14336
    ds_read_b64_tr_b16 a[138:139], v6 offset:14848
    v_mfma_f32_16x16x32_bf16 v[40:43], a[96:99], v[148:151], v[40:43]
    s_addc_u32 s71, s33, 0
    global_load_lds_dwordx4 v10, s[70:71] offset:2048
    v_mul_f32 v24, 0xbfb8aa3b, v16
    v_mfma_f32_16x16x32_bf16 v[48:51], a[100:103], v[144:147], v[48:51]
    ds_read_b64_tr_b16 a[140:141], v7 offset:14336
    v_mul_f32 v25, 0xbfb8aa3b, v17
    v_mfma_f32_16x16x32_bf16 v[56:59], a[100:103], v[148:151], v[56:59]
    ds_read_b64_tr_b16 a[142:143], v7 offset:14848
    v_mul_f32 v26, 0xbfb8aa3b, v18
    v_mfma_f32_16x16x32_bf16 v[64:67], a[104:107], v[144:147], v[64:67]
    ds_read_b64_tr_b16 a[96:97], v8 offset:12288
    v_mul_f32 v27, 0xbfb8aa3b, v19
    v_mfma_f32_16x16x32_bf16 v[72:75], a[104:107], v[148:151], v[72:75]
    ds_read_b64_tr_b16 a[98:99], v8 offset:12800
    global_load_lds_dwordx4 v11, s[70:71] offset:3072
    v_mfma_f32_16x16x32_bf16 v[80:83], a[108:111], v[144:147], v[80:83]
    s_add_u32 m0, s48, 4096
    ds_read_b64_tr_b16 a[100:101], v9 offset:12288
    ds_read_b64_tr_b16 a[102:103], v9 offset:12800
    v_mfma_f32_16x16x32_bf16 v[88:91], a[108:111], v[148:151], v[88:91]
    v_exp_f32 v24, v24
    v_mfma_f32_16x16x32_bf16 v[36:39], a[112:115], v[144:147], v[36:39]
    s_bfe_u32 s94, s93, 0x40000
    ds_read_b64_tr_b16 a[104:105], v8 offset:14336
    ds_read_b64_tr_b16 a[106:107], v8 offset:14848
    v_mfma_f32_16x16x32_bf16 v[44:47], a[112:115], v[148:151], v[44:47]
    v_exp_f32 v25, v25
    v_mfma_f32_16x16x32_bf16 v[52:55], a[116:119], v[144:147], v[52:55]
    s_waitcnt lgkmcnt(6)
    ds_read_b64_tr_b16 a[108:109], v9 offset:14336
    ds_read_b64_tr_b16 a[110:111], v9 offset:14848
    v_mfma_f32_16x16x32_bf16 v[60:63], a[116:119], v[148:151], v[60:63]
    v_exp_f32 v26, v26
    v_mfma_f32_16x16x32_bf16 v[68:71], a[120:123], v[144:147], v[68:71]
    s_waitcnt vmcnt(13)
    s_barrier
    v_mfma_f32_16x16x32_bf16 v[76:79], a[120:123], v[148:151], v[76:79]
    ds_read_b64_tr_b16 a[112:113], v2 offset:16384
    ds_read_b64_tr_b16 a[114:115], v2 offset:16896
    v_mfma_f32_16x16x32_bf16 v[84:87], a[124:127], v[144:147], v[84:87]
    s_mul_i32 s54, s94, 196608
    ds_read_b64_tr_b16 a[116:117], v3 offset:16384
    ds_read_b64_tr_b16 a[118:119], v3 offset:16896
    v_mfma_f32_16x16x32_bf16 v[92:95], a[124:127], v[148:151], v[92:95]
    v_exp_f32 v27, v27
    v_mfma_f32_16x16x32_bf16 v[32:35], a[128:131], v[152:155], v[32:35]
    s_add_u32 s70, s28, s54
    ds_read_b64_tr_b16 a[120:121], v2 offset:18432
    ds_read_b64_tr_b16 a[122:123], v2 offset:18944
    v_mfma_f32_16x16x32_bf16 v[40:43], a[128:131], v[156:159], v[40:43]
    s_addc_u32 s71, s29, 0
    global_load_lds_dwordx4 v10, s[70:71] offset:0
    v_mul_f32 v16, v16, v20
    v_mfma_f32_16x16x32_bf16 v[48:51], a[132:135], v[152:155], v[48:51]
    ds_read_b64_tr_b16 a[124:125], v3 offset:18432
    v_mul_f32 v17, v17, v21
    v_mfma_f32_16x16x32_bf16 v[56:59], a[132:135], v[156:159], v[56:59]
    ds_read_b64_tr_b16 a[126:127], v3 offset:18944
    v_mul_f32 v18, v18, v22
    v_mfma_f32_16x16x32_bf16 v[64:67], a[136:139], v[152:155], v[64:67]
    ds_read_b64_tr_b16 a[128:129], v4 offset:16384
    v_mul_f32 v19, v19, v23
    v_mfma_f32_16x16x32_bf16 v[72:75], a[136:139], v[156:159], v[72:75]
    ds_read_b64_tr_b16 a[130:131], v4 offset:16896
    global_load_lds_dwordx4 v11, s[70:71] offset:1024
    v_mfma_f32_16x16x32_bf16 v[80:83], a[140:143], v[152:155], v[80:83]
    s_waitcnt lgkmcnt(6)
    ds_read_b64_tr_b16 a[132:133], v5 offset:16384
    v_add_f32 v24, 1.0, v24
    v_mfma_f32_16x16x32_bf16 v[88:91], a[140:143], v[156:159], v[88:91]
    ds_read_b64_tr_b16 a[134:135], v5 offset:16896
    v_add_f32 v25, 1.0, v25
    v_mfma_f32_16x16x32_bf16 v[36:39], a[96:99], v[152:155], v[36:39]
    s_add_u32 s70, s32, s54
    ds_read_b64_tr_b16 a[136:137], v4 offset:18432
    ds_read_b64_tr_b16 a[138:139], v4 offset:18944
    v_mfma_f32_16x16x32_bf16 v[44:47], a[96:99], v[156:159], v[44:47]
    s_addc_u32 s71, s33, 0
    global_load_lds_dwordx4 v10, s[70:71] offset:2048
    v_add_f32 v26, 1.0, v26
    v_mfma_f32_16x16x32_bf16 v[52:55], a[100:103], v[152:155], v[52:55]
    ds_read_b64_tr_b16 a[140:141], v5 offset:18432
    v_add_f32 v27, 1.0, v27
    v_mfma_f32_16x16x32_bf16 v[60:63], a[100:103], v[156:159], v[60:63]
    ds_read_b64_tr_b16 a[142:143], v5 offset:18944
    v_mfma_f32_16x16x32_bf16 v[68:71], a[104:107], v[152:155], v[68:71]
    ds_read_b64_tr_b16 a[96:97], v6 offset:16384
    v_mfma_f32_16x16x32_bf16 v[76:79], a[104:107], v[156:159], v[76:79]
    ds_read_b64_tr_b16 a[98:99], v6 offset:16896
    global_load_lds_dwordx4 v11, s[70:71] offset:3072
    v_mfma_f32_16x16x32_bf16 v[84:87], a[108:111], v[152:155], v[84:87]
    s_add_u32 m0, s48, 8192
    ds_read_b64_tr_b16 a[100:101], v7 offset:16384
    ds_read_b64_tr_b16 a[102:103], v7 offset:16896
    v_mfma_f32_16x16x32_bf16 v[92:95], a[108:111], v[156:159], v[92:95]
    v_rcp_f32 v24, v24
    v_mfma_f32_16x16x32_bf16 v[32:35], a[112:115], v[160:163], v[32:35]
    s_bfe_u32 s94, s93, 0x40004
    ds_read_b64_tr_b16 a[104:105], v6 offset:18432
    s_mul_i32 s4, s61, 5
    v_mfma_f32_16x16x32_bf16 v[40:43], a[112:115], v[164:167], v[40:43]
    s_lshr_b32 s5, s4, 2
    ds_read_b64_tr_b16 a[106:107], v6 offset:18944
    s_lshl_b32 s5, s5, 10
    v_mfma_f32_16x16x32_bf16 v[48:51], a[116:119], v[160:163], v[48:51]
    s_waitcnt lgkmcnt(6)
    ds_read_b64_tr_b16 a[108:109], v7 offset:18432
    v_add_u32 v149, s5, v1
    v_mfma_f32_16x16x32_bf16 v[56:59], a[116:119], v[164:167], v[56:59]
    ds_read_b64_tr_b16 a[110:111], v7 offset:18944
    v_add_u32 v146, 81920, v149
    v_mfma_f32_16x16x32_bf16 v[64:67], a[120:123], v[160:163], v[64:67]
    s_mul_i32 s54, s94, 196608
    ds_read_b64_tr_b16 a[112:113], v8 offset:16384
    s_bfe_u32 s6, s4, 0x10001
    v_mfma_f32_16x16x32_bf16 v[72:75], a[120:123], v[164:167], v[72:75]
    s_lshl_b32 s4, s6, 10
    ds_read_b64_tr_b16 a[114:115], v8 offset:16896
    s_add_u32 s4, s4, 40960
    v_mfma_f32_16x16x32_bf16 v[80:83], a[124:127], v[160:163], v[80:83]
    s_add_u32 s70, s28, s54
    ds_read_b64_tr_b16 a[116:117], v9 offset:16384
    ds_read_b64_tr_b16 a[118:119], v9 offset:16896
    v_mfma_f32_16x16x32_bf16 v[88:91], a[124:127], v[164:167], v[88:91]
    s_addc_u32 s71, s29, 0
    global_load_lds_dwordx4 v10, s[70:71] offset:0
    v_add_u32 v144, s4, v149
    v_mfma_f32_16x16x32_bf16 v[36:39], a[128:131], v[160:163], v[36:39]
    s_mul_i32 s7, s6, 1016
    ds_read_b64_tr_b16 a[120:121], v8 offset:18432
    s_sub_u32 s4, 41984, s7
    v_mfma_f32_16x16x32_bf16 v[44:47], a[128:131], v[164:167], v[44:47]
L_pad6:
    s_cbranch_execz L_pad10
    ds_read_b64_tr_b16 a[122:123], v8 offset:18944
    v_add_u32 v145, s4, v149
    v_mfma_f32_16x16x32_bf16 v[52:55], a[132:135], v[160:163], v[52:55]
    ds_read_b64_tr_b16 a[124:125], v9 offset:18432
    v_add_u32 v155, s48, v1
    v_mfma_f32_16x16x32_bf16 v[60:63], a[132:135], v[164:167], v[60:63]
    s_sub_u32 s4, s3, 1
    ds_read_b64_tr_b16 a[126:127], v9 offset:18944
    global_load_lds_dwordx4 v11, s[70:71] offset:1024
    v_mfma_f32_16x16x32_bf16 v[68:71], a[136:139], v[160:163], v[68:71]
    s_waitcnt vmcnt(15)
    s_barrier
    v_mfma_f32_16x16x32_bf16 v[76:79], a[136:139], v[164:167], v[76:79]
    s_and_b32 s4, s4, 3
    ds_read_b64_tr_b16 a[128:129], v2 offset:20480
    ds_read_b64_tr_b16 a[130:131], v2 offset:20992
    v_mfma_f32_16x16x32_bf16 v[84:87], a[140:143], v[160:163], v[84:87]
    s_waitcnt lgkmcnt(6)
    ds_read_b64_tr_b16 a[132:133], v3 offset:20480
    s_mul_i32 s4, s4, 40960
    v_mfma_f32_16x16x32_bf16 v[92:95], a[140:143], v[164:167], v[92:95]
    ds_read_b64_tr_b16 a[134:135], v3 offset:20992
    v_add_u32 v152, s4, v1
    v_mfma_f32_16x16x32_bf16 v[32:35], a[96:99], v[168:171], v[32:35]
    s_add_u32 s70, s32, s54
    ds_read_b64_tr_b16 a[136:137], v2 offset:22528
    ds_read_b64_tr_b16 a[138:139], v2 offset:23040
    v_mfma_f32_16x16x32_bf16 v[40:43], a[96:99], v[172:175], v[40:43]
    s_addc_u32 s71, s33, 0
    global_load_lds_dwordx4 v10, s[70:71] offset:2048
    s_sub_u32 s4, s3, 2
    v_mfma_f32_16x16x32_bf16 v[48:51], a[100:103], v[168:171], v[48:51]
    s_and_b32 s4, s4, 3
    ds_read_b64_tr_b16 a[140:141], v3 offset:22528
    s_mul_i32 s4, s4, 40960
    v_mfma_f32_16x16x32_bf16 v[56:59], a[100:103], v[172:175], v[56:59]
    ds_read_b64_tr_b16 a[142:143], v3 offset:23040
    v_add_u32 v153, s4, v1
    v_mfma_f32_16x16x32_bf16 v[64:67], a[104:107], v[168:171], v[64:67]
    s_sub_u32 s4, s3, 3
    ds_read_b64_tr_b16 a[96:97], v4 offset:20480
    s_and_b32 s4, s4, 3
    v_mfma_f32_16x16x32_bf16 v[72:75], a[104:107], v[172:175], v[72:75]
    s_mul_i32 s4, s4, 40960
    ds_read_b64_tr_b16 a[98:99], v4 offset:20992
    global_load_lds_dwordx4 v11, s[70:71] offset:3072
    v_mfma_f32_16x16x32_bf16 v[80:83], a[108:111], v[168:171], v[80:83]
    ds_read_b64_tr_b16 a[100:101], v5 offset:20480
    v_add_u32 v154, s4, v1
    v_mfma_f32_16x16x32_bf16 v[88:91], a[108:111], v[172:175], v[88:91]
    ds_read_b64_tr_b16 a[102:103], v5 offset:20992
    v_lshrrev_b32 v136, 5, v0
    v_mfma_f32_16x16x32_bf16 v[36:39], a[112:115], v[168:171], v[36:39]
    s_and_b32 s4, s61, 1
    ds_read_b64_tr_b16 a[104:105], v4 offset:22528
    v_xor_b32 v137, s4, v136
    v_mfma_f32_16x16x32_bf16 v[44:47], a[112:115], v[172:175], v[44:47]
    ds_read_b64_tr_b16 a[106:107], v4 offset:23040
    v_sub_u32 v138, 28672, v1
    v_mfma_f32_16x16x32_bf16 v[52:55], a[116:119], v[168:171], v[52:55]
    s_waitcnt lgkmcnt(6)
    ds_read_b64_tr_b16 a[108:109], v5 offset:22528
    s_and_b32 s5, s61, 3
    v_mfma_f32_16x16x32_bf16 v[60:63], a[116:119], v[172:175], v[60:63]
    s_lshl_b32 s4, s5, 1
    ds_read_b64_tr_b16 a[110:111], v5 offset:23040
    s_lshr_b32 s4, 0x92, s4
    v_mfma_f32_16x16x32_bf16 v[68:71], a[120:123], v[168:171], v[68:71]
    s_and_b32 s4, s4, 3
    ds_read_b64_tr_b16 a[112:113], v6 offset:20480
    s_add_u32 s4, s4, 1
    v_mfma_f32_16x16x32_bf16 v[76:79], a[120:123], v[172:175], v[76:79]
    ds_read_b64_tr_b16 a[114:115], v6 offset:20992
    v_mul_u32_u24 v137, s4, v137
    v_mfma_f32_16x16x32_bf16 v[84:87], a[124:127], v[168:171], v[84:87]
    s_lshl_b32 s4, s6, 11
    ds_read_b64_tr_b16 a[116:117], v7 offset:20480
    s_add_u32 s4, s4, 12288
    v_mfma_f32_16x16x32_bf16 v[92:95], a[124:127], v[172:175], v[92:95]
    s_mul_i32 s7, s6, 2040
    ds_read_b64_tr_b16 a[118:119], v7 offset:20992
    s_sub_u32 s7, 14336, s7
    v_mfma_f32_16x16x32_bf16 v[32:35], a[128:131], v[176:179], v[32:35]
    ds_read_b64_tr_b16 a[120:121], v6 offset:22528
    v_cmp_eq_u32 vcc, 1, v137
    v_mfma_f32_16x16x32_bf16 v[40:43], a[128:131], v[180:183], v[40:43]
    ds_read_b64_tr_b16 a[122:123], v6 offset:23040
    v_mov_b32 v139, s4
    v_mfma_f32_16x16x32_bf16 v[48:51], a[132:135], v[176:179], v[48:51]
    ds_read_b64_tr_b16 a[124:125], v7 offset:22528
    v_add_u32 v139, 0, v139
    v_mfma_f32_16x16x32_bf16 v[56:59], a[132:135], v[180:183], v[56:59]
    ds_read_b64_tr_b16 a[126:127], v7 offset:23040
    v_cndmask_b32 v139, v139, v138, vcc
    v_mfma_f32_16x16x32_bf16 v[64:67], a[136:139], v[176:179], v[64:67]
    ds_read_b64_tr_b16 a[128:129], v8 offset:20480
    v_add_u32 v112, v139, v154
    v_mfma_f32_16x16x32_bf16 v[72:75], a[136:139], v[180:183], v[72:75]
    ds_read_b64_tr_b16 a[130:131], v8 offset:20992
    v_add_u32 v115, v139, v153
    v_mfma_f32_16x16x32_bf16 v[80:83], a[140:143], v[176:179], v[80:83]
    s_waitcnt lgkmcnt(6)
    ds_read_b64_tr_b16 a[132:133], v9 offset:20480
    v_add_u32 v118, v139, v152
    v_mfma_f32_16x16x32_bf16 v[88:91], a[140:143], v[180:183], v[88:91]
    ds_read_b64_tr_b16 a[134:135], v9 offset:20992
    v_add_u32 v121, v139, v155
    v_mfma_f32_16x16x32_bf16 v[36:39], a[96:99], v[176:179], v[36:39]
    ds_read_b64_tr_b16 a[136:137], v8 offset:22528
    v_cmp_eq_u32 vcc, 2, v137
    v_mfma_f32_16x16x32_bf16 v[44:47], a[96:99], v[180:183], v[44:47]
    ds_read_b64_tr_b16 a[138:139], v8 offset:23040
    v_mov_b32 v139, s4
    v_mfma_f32_16x16x32_bf16 v[52:55], a[100:103], v[176:179], v[52:55]
    ds_read_b64_tr_b16 a[140:141], v9 offset:22528
    v_add_u32 v139, 8, v139
    v_mfma_f32_16x16x32_bf16 v[60:63], a[100:103], v[180:183], v[60:63]
    ds_read_b64_tr_b16 a[142:143], v9 offset:23040
    v_cndmask_b32 v139, v139, v138, vcc
    v_mfma_f32_16x16x32_bf16 v[68:71], a[104:107], v[176:179], v[68:71]
    s_waitcnt vmcnt(13)
    s_barrier
    v_mfma_f32_16x16x32_bf16 v[76:79], a[104:107], v[180:183], v[76:79]
    ds_read_b64_tr_b16 a[96:97], v2 offset:24576
    ds_read_b64_tr_b16 a[98:99], v2 offset:25088
    v_mfma_f32_16x16x32_bf16 v[84:87], a[108:111], v[176:179], v[84:87]
    ds_read_b64_tr_b16 a[100:101], v3 offset:24576
    v_add_u32 v113, v139, v154
    v_mfma_f32_16x16x32_bf16 v[92:95], a[108:111], v[180:183], v[92:95]
    ds_read_b64_tr_b16 a[102:103], v3 offset:25088
    v_add_u32 v116, v139, v153
    v_mfma_f32_16x16x32_bf16 v[32:35], a[112:115], v[184:187], v[32:35]
    ds_read_b64_tr_b16 a[104:105], v2 offset:26624
    v_add_u32 v119, v139, v152
    v_mfma_f32_16x16x32_bf16 v[40:43], a[112:115], v[188:191], v[40:43]
    ds_read_b64_tr_b16 a[106:107], v2 offset:27136
    v_add_u32 v122, v139, v155
    v_mfma_f32_16x16x32_bf16 v[48:51], a[116:119], v[184:187], v[48:51]
    s_waitcnt lgkmcnt(6)
    ds_read_b64_tr_b16 a[108:109], v3 offset:26624
    v_cmp_eq_u32 vcc, 3, v137
    v_mfma_f32_16x16x32_bf16 v[56:59], a[116:119], v[188:191], v[56:59]
    ds_read_b64_tr_b16 a[110:111], v3 offset:27136
    v_mov_b32 v139, s7
    v_mfma_f32_16x16x32_bf16 v[64:67], a[120:123], v[184:187], v[64:67]
    ds_read_b64_tr_b16 a[112:113], v4 offset:24576
    v_add_u32 v139, 0, v139
    v_mfma_f32_16x16x32_bf16 v[72:75], a[120:123], v[188:191], v[72:75]
    ds_read_b64_tr_b16 a[114:115], v4 offset:25088
    v_cndmask_b32 v139, v139, v138, vcc
    v_mfma_f32_16x16x32_bf16 v[80:83], a[124:127], v[184:187], v[80:83]
    ds_read_b64_tr_b16 a[116:117], v5 offset:24576
    v_add_u32 v114, v139, v154
    v_mfma_f32_16x16x32_bf16 v[88:91], a[124:127], v[188:191], v[88:91]
    ds_read_b64_tr_b16 a[118:119], v5 offset:25088
    v_add_u32 v117, v139, v153
    v_mfma_f32_16x16x32_bf16 v[36:39], a[128:131], v[184:187], v[36:39]
    ds_read_b64_tr_b16 a[120:121], v4 offset:26624
    v_add_u32 v120, v139, v152
    v_mfma_f32_16x16x32_bf16 v[44:47], a[128:131], v[188:191], v[44:47]
    ds_read_b64_tr_b16 a[122:123], v4 offset:27136
    v_add_u32 v123, v139, v155
    v_mfma_f32_16x16x32_bf16 v[52:55], a[132:135], v[184:187], v[52:55]
    ds_read_b64_tr_b16 a[124:125], v5 offset:26624
    v_bfe_u32 v137, v0, 4, 1
    v_mfma_f32_16x16x32_bf16 v[60:63], a[132:135], v[188:191], v[60:63]
    ds_read_b64_tr_b16 a[126:127], v5 offset:27136
    v_and_b32 v138, 3, v0
    v_mfma_f32_16x16x32_bf16 v[68:71], a[136:139], v[184:187], v[68:71]
    ds_read_b64_tr_b16 a[128:129], v6 offset:24576
    v_lshl_add_u32 v137, v137, 2, v138
    v_mfma_f32_16x16x32_bf16 v[76:79], a[136:139], v[188:191], v[76:79]
    ds_read_b64_tr_b16 a[130:131], v6 offset:25088
    v_add_u32 v138, s5, v137
    v_mfma_f32_16x16x32_bf16 v[84:87], a[140:143], v[184:187], v[84:87]
    s_waitcnt lgkmcnt(6)
    ds_read_b64_tr_b16 a[132:133], v7 offset:24576
    v_lshrrev_b32 v139, 2, v138
    v_mfma_f32_16x16x32_bf16 v[92:95], a[140:143], v[188:191], v[92:95]
    ds_read_b64_tr_b16 a[134:135], v7 offset:25088
    v_lshlrev_b32 v139, 10, v139
    v_mfma_f32_16x16x32_bf16 v[32:35], a[96:99], v[192:195], v[32:35]
    ds_read_b64_tr_b16 a[136:137], v6 offset:26624
    v_and_b32 v140, 1, v138
    v_mfma_f32_16x16x32_bf16 v[40:43], a[96:99], v[196:199], v[40:43]
    ds_read_b64_tr_b16 a[138:139], v6 offset:27136
    v_lshl_add_u32 v139, v140, 9, v139
    v_mfma_f32_16x16x32_bf16 v[48:51], a[100:103], v[192:195], v[48:51]
    ds_read_b64_tr_b16 a[140:141], v7 offset:26624
    v_bfe_u32 v140, v138, 1, 1
    v_mfma_f32_16x16x32_bf16 v[56:59], a[100:103], v[196:199], v[56:59]
    ds_read_b64_tr_b16 a[142:143], v7 offset:27136
    v_lshl_add_u32 v139, v140, 3, v139
    v_mfma_f32_16x16x32_bf16 v[64:67], a[104:107], v[192:195], v[64:67]
    ds_read_b64_tr_b16 a[96:97], v8 offset:24576
    v_add_u32 v139, 35840, v139
    v_mfma_f32_16x16x32_bf16 v[72:75], a[104:107], v[196:199], v[72:75]
    ds_read_b64_tr_b16 a[98:99], v8 offset:25088
    v_add_u32 v140, 2048, v139
    v_mfma_f32_16x16x32_bf16 v[80:83], a[108:111], v[192:195], v[80:83]
    ds_read_b64_tr_b16 a[100:101], v9 offset:24576
    v_min_u32 v141, 6, v137
    v_mfma_f32_16x16x32_bf16 v[88:91], a[108:111], v[196:199], v[88:91]
    ds_read_b64_tr_b16 a[102:103], v9 offset:25088
    v_lshlrev_b32 v141, 3, v141
    v_mfma_f32_16x16x32_bf16 v[36:39], a[112:115], v[192:195], v[36:39]
    ds_read_b64_tr_b16 a[104:105], v8 offset:26624
    v_add_u32 v141, 39896, v141
    v_mfma_f32_16x16x32_bf16 v[44:47], a[112:115], v[196:199], v[44:47]
    ds_read_b64_tr_b16 a[106:107], v8 offset:27136
    global_load_dword a241, v1, s[98:99] offset:0
    v_mfma_f32_16x16x32_bf16 v[52:55], a[116:119], v[192:195], v[52:55]
    s_waitcnt lgkmcnt(6)
    ds_read_b64_tr_b16 a[108:109], v9 offset:26624
    v_cmp_gt_u32 vcc, 5, v137
    v_mfma_f32_16x16x32_bf16 v[60:63], a[116:119], v[196:199], v[60:63]
    ds_read_b64_tr_b16 a[110:111], v9 offset:27136
    v_bfe_u32 v142, v0, 2, 2
    v_mfma_f32_16x16x32_bf16 v[68:71], a[120:123], v[192:195], v[68:71]
    s_waitcnt vmcnt(9)
    s_barrier
    v_mfma_f32_16x16x32_bf16 v[76:79], a[120:123], v[196:199], v[76:79]
    ds_read_b64_tr_b16 a[112:113], v2 offset:0
    ds_read_b64_tr_b16 a[114:115], v2 offset:512
    v_mfma_f32_16x16x32_bf16 v[84:87], a[124:127], v[192:195], v[84:87]
    ds_read_b64_tr_b16 a[116:117], v3 offset:0
    v_lshl_add_u32 v142, v136, 3, v142
    v_mfma_f32_16x16x32_bf16 v[92:95], a[124:127], v[196:199], v[92:95]
    ds_read_b64_tr_b16 a[118:119], v3 offset:512
    v_lshlrev_b32 v142, 4, v142
    v_mfma_f32_16x16x32_bf16 v[32:35], a[128:131], v[200:203], v[32:35]
    ds_read_b64_tr_b16 a[120:121], v2 offset:2048
    v_add_u32 v142, s48, v142
    v_mfma_f32_16x16x32_bf16 v[40:43], a[128:131], v[204:207], v[40:43]
    ds_read_b64_tr_b16 a[122:123], v2 offset:2560
    v_cndmask_b32 v139, v141, v139, vcc
    v_mfma_f32_16x16x32_bf16 v[48:51], a[132:135], v[200:203], v[48:51]
    ds_read_b64_tr_b16 a[124:125], v3 offset:2048
    v_cndmask_b32 v140, v141, v140, vcc
    v_mfma_f32_16x16x32_bf16 v[56:59], a[132:135], v[204:207], v[56:59]
    ds_read_b64_tr_b16 a[126:127], v3 offset:2560
    v_add_u32 v147, v139, v142
    v_mfma_f32_16x16x32_bf16 v[64:67], a[136:139], v[200:203], v[64:67]
    ds_read_b64_tr_b16 a[128:129], v4 offset:0
    v_add_u32 v148, v140, v142
    v_mfma_f32_16x16x32_bf16 v[72:75], a[136:139], v[204:207], v[72:75]
    ds_read_b64_tr_b16 a[130:131], v4 offset:512
    v_mov_b32 v128, 0x3f80
    v_mfma_f32_16x16x32_bf16 v[80:83], a[140:143], v[200:203], v[80:83]
    s_waitcnt lgkmcnt(6)
    ds_read_b64_tr_b16 a[132:133], v5 offset:0
    v_mov_b32 v129, 0
    v_mfma_f32_16x16x32_bf16 v[88:91], a[140:143], v[204:207], v[88:91]
    ds_read_b64_tr_b16 a[134:135], v5 offset:512
    v_mov_b32 v130, 0
    v_mfma_f32_16x16x32_bf16 v[36:39], a[96:99], v[200:203], v[36:39]
    ds_read_b64_tr_b16 a[136:137], v4 offset:2048
    v_mov_b32 v131, 0
    v_mfma_f32_16x16x32_bf16 v[44:47], a[96:99], v[204:207], v[44:47]
    ds_read_b64_tr_b16 a[138:139], v4 offset:2560
    v_add_u32 v143, v155, v1
    v_mfma_f32_16x16x32_bf16 v[52:55], a[100:103], v[200:203], v[52:55]
    ds_read_b64_tr_b16 a[140:141], v5 offset:2048
    v_lshlrev_b32 v156, 2, v0
    v_mfma_f32_16x16x32_bf16 v[60:63], a[100:103], v[204:207], v[60:63]
    ds_read_b64_tr_b16 a[142:143], v5 offset:2560
    v_mov_b32 v150, 0xdddd
    v_mfma_f32_16x16x32_bf16 v[68:71], a[104:107], v[200:203], v[68:71]
    s_mul_i32 s4, s61, 5
    ds_read_b64_tr_b16 a[96:97], v6 offset:0
    s_lshr_b32 s4, s4, 2
    v_mfma_f32_16x16x32_bf16 v[76:79], a[104:107], v[204:207], v[76:79]
    ds_read_b64_tr_b16 a[98:99], v6 offset:512
    v_bfe_u32 v137, v0, 4, 1
    v_mfma_f32_16x16x32_bf16 v[84:87], a[108:111], v[200:203], v[84:87]
    ds_read_b64_tr_b16 a[100:101], v7 offset:0
    v_add_u32 v137, s4, v137
    v_mfma_f32_16x16x32_bf16 v[92:95], a[108:111], v[204:207], v[92:95]
    ds_read_b64_tr_b16 a[102:103], v7 offset:512
    v_lshrrev_b32 v137, 2, v137
    v_mfma_f32_16x16x32_bf16 v[32:35], a[112:115], v[208:211], v[32:35]
    ds_read_b64_tr_b16 a[104:105], v6 offset:2048
    v_lshlrev_b32 v137, 11, v137
    v_mfma_f32_16x16x32_bf16 v[40:43], a[112:115], v[212:215], v[40:43]
    ds_read_b64_tr_b16 a[106:107], v6 offset:2560
    v_and_b32 v138, 1, v0
    v_mfma_f32_16x16x32_bf16 v[48:51], a[116:119], v[208:211], v[48:51]
    s_waitcnt lgkmcnt(6)
    ds_read_b64_tr_b16 a[108:109], v7 offset:2048
    v_lshl_add_u32 v138, v138, 2, v137
    v_mfma_f32_16x16x32_bf16 v[56:59], a[116:119], v[212:215], v[56:59]
    s_lshl_b32 s4, s62, 2
    ds_read_b64_tr_b16 a[110:111], v7 offset:2560
    s_add_u32 s4, s4, s3
    v_mfma_f32_16x16x32_bf16 v[64:67], a[120:123], v[208:211], v[64:67]
    s_mul_i32 s65, s4, 247808
    ds_read_b64_tr_b16 a[112:113], v8 offset:0
    s_and_b32 s6, s4, 1
    v_mfma_f32_16x16x32_bf16 v[72:75], a[120:123], v[212:215], v[72:75]
    s_lshl_b32 s6, s6, 3
    ds_read_b64_tr_b16 a[114:115], v8 offset:512
    s_lshr_b32 s4, s4, 1
    v_mfma_f32_16x16x32_bf16 v[80:83], a[124:127], v[208:211], v[80:83]
    s_lshl_b32 s4, s4, 7
    ds_read_b64_tr_b16 a[116:117], v9 offset:0
    s_add_u32 s4, s4, s6
    v_mfma_f32_16x16x32_bf16 v[88:91], a[124:127], v[212:215], v[88:91]
    s_add_u32 s4, s4, 19712000
    ds_read_b64_tr_b16 a[118:119], v9 offset:512
    v_add_u32 v127, s4, v138
    v_mfma_f32_16x16x32_bf16 v[36:39], a[128:131], v[208:211], v[36:39]
    ds_read_b64_tr_b16 a[120:121], v8 offset:2048
    v_and_b32 v138, 3, v0
    v_mfma_f32_16x16x32_bf16 v[44:47], a[128:131], v[212:215], v[44:47]
    ds_read_b64_tr_b16 a[122:123], v8 offset:2560
    v_lshl_add_u32 v137, v138, 2, v137
    v_mfma_f32_16x16x32_bf16 v[52:55], a[132:135], v[208:211], v[52:55]
    ds_read_b64_tr_b16 a[124:125], v9 offset:2048
    v_bfe_u32 v138, v0, 2, 2
    v_mfma_f32_16x16x32_bf16 v[60:63], a[132:135], v[212:215], v[60:63]
    ds_read_b64_tr_b16 a[126:127], v9 offset:2560
    v_lshl_add_u32 v138, v138, 7, v137
    v_mfma_f32_16x16x32_bf16 v[68:71], a[136:139], v[208:211], v[68:71]
    s_waitcnt vmcnt(5)
    s_barrier
    v_mfma_f32_16x16x32_bf16 v[76:79], a[136:139], v[212:215], v[76:79]
    ds_read_b64_tr_b16 a[128:129], v2 offset:4096
    ds_read_b64_tr_b16 a[130:131], v2 offset:4608
    v_mfma_f32_16x16x32_bf16 v[84:87], a[140:143], v[208:211], v[84:87]
    s_waitcnt lgkmcnt(6)
    ds_read_b64_tr_b16 a[132:133], v3 offset:4096
    v_mul_u32_u24 v137, 20480, v136
    v_mfma_f32_16x16x32_bf16 v[92:95], a[140:143], v[212:215], v[92:95]
    s_lshl_b32 s4, s3, 9
    ds_read_b64_tr_b16 a[134:135], v3 offset:4608
    s_add_u32 s4, s4, 19732480
    v_mfma_f32_16x16x32_bf16 v[32:35], a[96:99], v[216:219], v[32:35]
    ds_read_b64_tr_b16 a[136:137], v2 offset:6144
    v_add3_u32 v126, v137, v138, s4
    v_mfma_f32_16x16x32_bf16 v[40:43], a[96:99], v[220:223], v[40:43]
    s_mul_i32 s4, s3, 1982464
    ds_read_b64_tr_b16 a[138:139], v2 offset:6656
    s_add_u32 s16, s12, s4
    s_addc_u32 s17, s13, 0
    v_mfma_f32_16x16x32_bf16 v[48:51], a[100:103], v[216:219], v[48:51]
    ds_read_b64_tr_b16 a[140:141], v3 offset:6144
    buffer_load_dword v157, v156, s[40:43], 0 offen offset:0 sc1
    v_mfma_f32_16x16x32_bf16 v[56:59], a[100:103], v[220:223], v[56:59]
    ds_read_b64_tr_b16 a[142:143], v3 offset:6656
    v_mfma_f32_16x16x32_bf16 v[64:67], a[104:107], v[216:219], v[64:67]
    ds_read_b64_tr_b16 a[96:97], v4 offset:4096
    ds_read_b64_tr_b16 a[98:99], v4 offset:4608
    v_mfma_f32_16x16x32_bf16 v[72:75], a[104:107], v[220:223], v[72:75]
    v_rcp_f32 v25, v25
    v_mfma_f32_16x16x32_bf16 v[80:83], a[108:111], v[216:219], v[80:83]
    ds_read_b64_tr_b16 a[100:101], v5 offset:4096
    ds_read_b64_tr_b16 a[102:103], v5 offset:4608
    v_mfma_f32_16x16x32_bf16 v[88:91], a[108:111], v[220:223], v[88:91]
    v_rcp_f32 v26, v26
    v_mfma_f32_16x16x32_bf16 v[36:39], a[112:115], v[216:219], v[36:39]
    ds_read_b64_tr_b16 a[104:105], v4 offset:6144
    ds_read_b64_tr_b16 a[106:107], v4 offset:6656
    v_mfma_f32_16x16x32_bf16 v[44:47], a[112:115], v[220:223], v[44:47]
    v_rcp_f32 v27, v27
    v_mfma_f32_16x16x32_bf16 v[52:55], a[116:119], v[216:219], v[52:55]
    s_waitcnt lgkmcnt(6)
    ds_read_b64_tr_b16 a[108:109], v5 offset:6144
    v_mul_f32 v16, v16, v24
    v_mfma_f32_16x16x32_bf16 v[60:63], a[116:119], v[220:223], v[60:63]
    ds_read_b64_tr_b16 a[110:111], v5 offset:6656
    v_mul_f32 v17, v17, v25
    v_mfma_f32_16x16x32_bf16 v[68:71], a[120:123], v[216:219], v[68:71]
    ds_read_b64_tr_b16 a[112:113], v6 offset:4096
    v_mul_f32 v18, v18, v26
    v_mfma_f32_16x16x32_bf16 v[76:79], a[120:123], v[220:223], v[76:79]
    ds_read_b64_tr_b16 a[114:115], v6 offset:4608
    v_mul_f32 v19, v19, v27
    v_mfma_f32_16x16x32_bf16 v[84:87], a[124:127], v[216:219], v[84:87]
    ds_read_b64_tr_b16 a[116:117], v7 offset:4096
    v_cvt_pk_bf16_f32 v28, v16, v17
    v_mfma_f32_16x16x32_bf16 v[92:95], a[124:127], v[220:223], v[92:95]
    ds_read_b64_tr_b16 a[118:119], v7 offset:4608
    v_cvt_pk_bf16_f32 v29, v18, v19
    v_mfma_f32_16x16x32_bf16 v[32:35], a[128:131], v[224:227], v[32:35]
    ds_read_b64_tr_b16 a[120:121], v6 offset:6144
    v_accvgpr_write_b32 a34, v28
    v_mfma_f32_16x16x32_bf16 v[40:43], a[128:131], v[228:231], v[40:43]
    ds_read_b64_tr_b16 a[122:123], v6 offset:6656
    v_accvgpr_write_b32 a35, v29
    v_mfma_f32_16x16x32_bf16 v[48:51], a[132:135], v[224:227], v[48:51]
    ds_read_b64_tr_b16 a[124:125], v7 offset:6144
    v_accvgpr_read_b32 v16, a40
    v_mfma_f32_16x16x32_bf16 v[56:59], a[132:135], v[228:231], v[56:59]
    ds_read_b64_tr_b16 a[126:127], v7 offset:6656
    v_accvgpr_read_b32 v17, a41
    s_waitcnt vmcnt(0)
    v_bfe_u32 v157, v157, 0, 8
    v_cmp_gt_u32 vcc, 4, v157
    s_cbranch_vccnz L_ps3
L_pd3:
    buffer_load_dword v157, v126, s[12:15], 0 offen offset:0 sc1
    buffer_load_dword v158, v127, s[12:15], 0 offen offset:0 sc1
    v_mfma_f32_16x16x32_bf16 v[64:67], a[136:139], v[224:227], v[64:67]
    ds_read_b64_tr_b16 a[128:129], v8 offset:4096
    v_accvgpr_read_b32 v18, a42
    v_mfma_f32_16x16x32_bf16 v[72:75], a[136:139], v[228:231], v[72:75]
    ds_read_b64_tr_b16 a[130:131], v8 offset:4608
    v_accvgpr_read_b32 v19, a43
    v_mfma_f32_16x16x32_bf16 v[80:83], a[140:143], v[224:227], v[80:83]
    s_waitcnt lgkmcnt(6)
    ds_read_b64_tr_b16 a[132:133], v9 offset:4096
    v_accvgpr_read_b32 v20, a72
    v_mfma_f32_16x16x32_bf16 v[88:91], a[140:143], v[228:231], v[88:91]
    ds_read_b64_tr_b16 a[134:135], v9 offset:4608
    v_accvgpr_read_b32 v21, a73
    v_mfma_f32_16x16x32_bf16 v[36:39], a[96:99], v[224:227], v[36:39]
    ds_read_b64_tr_b16 a[136:137], v8 offset:6144
    v_accvgpr_read_b32 v22, a74
    v_mfma_f32_16x16x32_bf16 v[44:47], a[96:99], v[228:231], v[44:47]
    ds_read_b64_tr_b16 a[138:139], v8 offset:6656
    v_accvgpr_read_b32 v23, a75
    v_mfma_f32_16x16x32_bf16 v[52:55], a[100:103], v[224:227], v[52:55]
    ds_read_b64_tr_b16 a[140:141], v9 offset:6144
    v_mul_f32 v24, 0xbfb8aa3b, v16
    v_mfma_f32_16x16x32_bf16 v[60:63], a[100:103], v[228:231], v[60:63]
    ds_read_b64_tr_b16 a[142:143], v9 offset:6656
    v_mul_f32 v25, 0xbfb8aa3b, v17
    v_mfma_f32_16x16x32_bf16 v[68:71], a[104:107], v[224:227], v[68:71]
    s_barrier
    v_mfma_f32_16x16x32_bf16 v[76:79], a[104:107], v[228:231], v[76:79]
    ds_read_b64_tr_b16 a[96:97], v2 offset:8192
    ds_read_b64_tr_b16 a[98:99], v2 offset:8704
    v_mfma_f32_16x16x32_bf16 v[84:87], a[108:111], v[224:227], v[84:87]
    ds_read_b64_tr_b16 a[100:101], v3 offset:8192
    v_mul_f32 v26, 0xbfb8aa3b, v18
    v_mfma_f32_16x16x32_bf16 v[92:95], a[108:111], v[228:231], v[92:95]
    ds_read_b64_tr_b16 a[102:103], v3 offset:8704
    v_mul_f32 v27, 0xbfb8aa3b, v19
    v_mfma_f32_16x16x32_bf16 v[32:35], a[112:115], v[232:235], v[32:35]
    ds_read_b64_tr_b16 a[104:105], v2 offset:10240
    ds_read_b64_tr_b16 a[106:107], v2 offset:10752
    v_mfma_f32_16x16x32_bf16 v[40:43], a[112:115], v[236:239], v[40:43]
    v_exp_f32 v24, v24
    v_mfma_f32_16x16x32_bf16 v[48:51], a[116:119], v[232:235], v[48:51]
    s_waitcnt lgkmcnt(6)
    ds_read_b64_tr_b16 a[108:109], v3 offset:10240
    ds_read_b64_tr_b16 a[110:111], v3 offset:10752
    v_mfma_f32_16x16x32_bf16 v[56:59], a[116:119], v[236:239], v[56:59]
    v_exp_f32 v25, v25
    v_mfma_f32_16x16x32_bf16 v[64:67], a[120:123], v[232:235], v[64:67]
    ds_read_b64_tr_b16 a[112:113], v4 offset:8192
    ds_read_b64_tr_b16 a[114:115], v4 offset:8704
    v_mfma_f32_16x16x32_bf16 v[72:75], a[120:123], v[236:239], v[72:75]
    v_exp_f32 v26, v26
    v_mfma_f32_16x16x32_bf16 v[80:83], a[124:127], v[232:235], v[80:83]
    ds_read_b64_tr_b16 a[116:117], v5 offset:8192
    ds_read_b64_tr_b16 a[118:119], v5 offset:8704
    v_mfma_f32_16x16x32_bf16 v[88:91], a[124:127], v[236:239], v[88:91]
    v_exp_f32 v27, v27
    v_mfma_f32_16x16x32_bf16 v[36:39], a[128:131], v[232:235], v[36:39]
    ds_read_b64_tr_b16 a[120:121], v4 offset:10240
    v_mul_f32 v16, v16, v20
    v_mfma_f32_16x16x32_bf16 v[44:47], a[128:131], v[236:239], v[44:47]
    ds_read_b64_tr_b16 a[122:123], v4 offset:10752
    v_mul_f32 v17, v17, v21
    v_mfma_f32_16x16x32_bf16 v[52:55], a[132:135], v[232:235], v[52:55]
    ds_read_b64_tr_b16 a[124:125], v5 offset:10240
    v_mul_f32 v18, v18, v22
    v_mfma_f32_16x16x32_bf16 v[60:63], a[132:135], v[236:239], v[60:63]
    ds_read_b64_tr_b16 a[126:127], v5 offset:10752
    v_mul_f32 v19, v19, v23
    v_mfma_f32_16x16x32_bf16 v[68:71], a[136:139], v[232:235], v[68:71]
    ds_read_b64_tr_b16 a[128:129], v6 offset:8192
    v_add_f32 v24, 1.0, v24
    v_mfma_f32_16x16x32_bf16 v[76:79], a[136:139], v[236:239], v[76:79]
    ds_read_b64_tr_b16 a[130:131], v6 offset:8704
    v_add_f32 v25, 1.0, v25
    v_mfma_f32_16x16x32_bf16 v[84:87], a[140:143], v[232:235], v[84:87]
    s_waitcnt lgkmcnt(6)
    ds_read_b64_tr_b16 a[132:133], v7 offset:8192
    v_add_f32 v26, 1.0, v26
    v_mfma_f32_16x16x32_bf16 v[92:95], a[140:143], v[236:239], v[92:95]
    ds_read_b64_tr_b16 a[134:135], v7 offset:8704
    v_add_f32 v27, 1.0, v27
    v_mfma_f32_16x16x32_bf16 v[32:35], a[96:99], v[240:243], v[32:35]
    ds_read_b64_tr_b16 a[136:137], v6 offset:10240
    ds_read_b64_tr_b16 a[138:139], v6 offset:10752
    v_mfma_f32_16x16x32_bf16 v[40:43], a[96:99], v[244:247], v[40:43]
    v_rcp_f32 v24, v24
    v_mfma_f32_16x16x32_bf16 v[48:51], a[100:103], v[240:243], v[48:51]
    ds_read_b64_tr_b16 a[140:141], v7 offset:10240
    ds_read_b64_tr_b16 a[142:143], v7 offset:10752
    v_mfma_f32_16x16x32_bf16 v[56:59], a[100:103], v[244:247], v[56:59]
    v_rcp_f32 v25, v25
    s_waitcnt vmcnt(0)
    v_min_u32 v157, v157, v158
    v_cmp_gt_u32 vcc, 1, v157
    s_cbranch_vccnz L_ps4
L_pd4:
    v_mfma_f32_16x16x32_bf16 v[64:67], a[104:107], v[240:243], v[64:67]
    ds_read_b64_tr_b16 a[96:97], v8 offset:8192
    v_mfma_f32_16x16x32_bf16 v[72:75], a[104:107], v[244:247], v[72:75]
    ds_read_b64_tr_b16 a[98:99], v8 offset:8704
    s_add_u32 m0, s48, 12288
    s_add_u32 s4, s65, 0
    buffer_load_dwordx4 v149, s[12:15], s4 offen offset:0 sc1 lds
    v_mfma_f32_16x16x32_bf16 v[80:83], a[108:111], v[240:243], v[80:83]
    ds_read_b64_tr_b16 a[100:101], v9 offset:8192
    ds_read_b64_tr_b16 a[102:103], v9 offset:8704
    v_mfma_f32_16x16x32_bf16 v[88:91], a[108:111], v[244:247], v[88:91]
    v_rcp_f32 v26, v26
    v_mfma_f32_16x16x32_bf16 v[36:39], a[112:115], v[240:243], v[36:39]
    ds_read_b64_tr_b16 a[104:105], v8 offset:10240
    v_mfma_f32_16x16x32_bf16 v[44:47], a[112:115], v[244:247], v[44:47]
    ds_read_b64_tr_b16 a[106:107], v8 offset:10752
    s_add_u32 m0, s48, 14336
    s_add_u32 s4, s65, 1024
    buffer_load_dwordx4 v149, s[12:15], s4 offen offset:0 sc1 lds
    v_mfma_f32_16x16x32_bf16 v[52:55], a[116:119], v[240:243], v[52:55]
    s_waitcnt lgkmcnt(6)
    ds_read_b64_tr_b16 a[108:109], v9 offset:10240
    ds_read_b64_tr_b16 a[110:111], v9 offset:10752
    v_mfma_f32_16x16x32_bf16 v[60:63], a[116:119], v[244:247], v[60:63]
    v_rcp_f32 v27, v27
    v_mfma_f32_16x16x32_bf16 v[68:71], a[120:123], v[240:243], v[68:71]
    v_mul_f32 v16, v16, v24
    v_mul_f32 v17, v17, v25
    v_mfma_f32_16x16x32_bf16 v[76:79], a[120:123], v[244:247], v[76:79]
    s_add_u32 m0, s48, 13312
    s_add_u32 s4, s65, 123904
    buffer_load_dwordx4 v149, s[12:15], s4 offen offset:0 sc1 lds
    v_mfma_f32_16x16x32_bf16 v[84:87], a[124:127], v[240:243], v[84:87]
    v_mul_f32 v18, v18, v26
    v_mul_f32 v19, v19, v27
    v_mfma_f32_16x16x32_bf16 v[92:95], a[124:127], v[244:247], v[92:95]
    v_cvt_pk_bf16_f32 v28, v16, v17
    v_cvt_pk_bf16_f32 v29, v18, v19
    v_mfma_f32_16x16x32_bf16 v[32:35], a[128:131], v[248:251], v[32:35]
    v_accvgpr_write_b32 a36, v28
    v_accvgpr_write_b32 a37, v29
    v_mfma_f32_16x16x32_bf16 v[40:43], a[128:131], v[252:255], v[40:43]
    ds_write_b128 v155, v[128:131] offset:39936
    s_add_u32 m0, s48, 15360
    s_add_u32 s4, s65, 124928
    buffer_load_dwordx4 v149, s[12:15], s4 offen offset:0 sc1 lds
    v_mfma_f32_16x16x32_bf16 v[48:51], a[132:135], v[248:251], v[48:51]
    v_accvgpr_read_b32 v16, a44
    v_accvgpr_read_b32 v17, a45
    v_mfma_f32_16x16x32_bf16 v[56:59], a[132:135], v[252:255], v[56:59]
    v_accvgpr_read_b32 v18, a46
    v_accvgpr_read_b32 v19, a47
    v_mfma_f32_16x16x32_bf16 v[64:67], a[136:139], v[248:251], v[64:67]
    v_accvgpr_read_b32 v20, a76
    v_accvgpr_read_b32 v21, a77
    v_mfma_f32_16x16x32_bf16 v[72:75], a[136:139], v[252:255], v[72:75]
    s_add_u32 m0, s48, 35840
    global_load_dwordx4 a[192:195], v144, s[16:17] offset:0 sc1
    v_mfma_f32_16x16x32_bf16 v[80:83], a[140:143], v[248:251], v[80:83]
    s_waitcnt lgkmcnt(1)
    v_accvgpr_read_b32 v22, a78
    v_accvgpr_read_b32 v23, a79
    v_mfma_f32_16x16x32_bf16 v[88:91], a[140:143], v[252:255], v[88:91]
    ds_write_b64 v143, v[130:131] offset:28672
    v_mul_f32 v24, 0xbfb8aa3b, v16
    v_mfma_f32_16x16x32_bf16 v[36:39], a[96:99], v[248:251], v[36:39]
    v_mul_f32 v25, 0xbfb8aa3b, v17
    v_mul_f32 v26, 0xbfb8aa3b, v18
    v_mfma_f32_16x16x32_bf16 v[44:47], a[96:99], v[252:255], v[44:47]
    global_load_dwordx2 a[196:197], v145, s[16:17] offset:0 sc1
    v_mul_f32 v27, 0xbfb8aa3b, v19
    v_mfma_f32_16x16x32_bf16 v[52:55], a[100:103], v[248:251], v[52:55]
    v_exp_f32 v24, v24
    v_mfma_f32_16x16x32_bf16 v[60:63], a[100:103], v[252:255], v[60:63]
    v_exp_f32 v25, v25
    v_mfma_f32_16x16x32_bf16 v[68:71], a[104:107], v[248:251], v[68:71]
    v_exp_f32 v26, v26
    v_mfma_f32_16x16x32_bf16 v[76:79], a[104:107], v[252:255], v[76:79]
    global_load_lds_dwordx4 v146, s[16:17] offset:0 sc1
    v_mfma_f32_16x16x32_bf16 v[84:87], a[108:111], v[248:251], v[84:87]
    v_exp_f32 v27, v27
    v_mfma_f32_16x16x32_bf16 v[92:95], a[108:111], v[252:255], v[92:95]
    v_mul_f32 v16, v16, v20
    v_mul_f32 v17, v17, v21
    global_load_lds_dwordx4 v146, s[16:17] offset:1024 sc1
    s_add_u32 m0, s48, 37888
    s_add_u32 s16, s16, 123904
    s_addc_u32 s17, s17, 0
    global_load_lds_dwordx4 v146, s[16:17] offset:0 sc1
    global_load_lds_dwordx4 v146, s[16:17] offset:1024 sc1
    global_load_dwordx4 a[198:201], v144, s[16:17] offset:0 sc1
L_pad7:
    s_cbranch_execz L_pad11
    global_load_dwordx2 a[202:203], v145, s[16:17] offset:0 sc1
    s_add_u32 s16, s16, 123904
    s_addc_u32 s17, s17, 0
    v_mul_f32 v18, v18, v22
    v_mul_f32 v19, v19, v23
    v_add_f32 v24, 1.0, v24
    v_add_f32 v25, 1.0, v25
    v_add_f32 v26, 1.0, v26
    v_add_f32 v27, 1.0, v27
    v_rcp_f32 v24, v24
    v_rcp_f32 v25, v25
    v_rcp_f32 v26, v26
    v_rcp_f32 v27, v27
    v_mul_f32 v16, v16, v24
    v_mul_f32 v17, v17, v25
    v_mul_f32 v18, v18, v26
    v_mul_f32 v19, v19, v27
    v_cvt_pk_bf16_f32 v28, v16, v17
    v_cvt_pk_bf16_f32 v29, v18, v19
    v_accvgpr_write_b32 a38, v28
    v_accvgpr_write_b32 a39, v29
    ds_read_b64_tr_b16 a[220:221], v12 offset:0
    ds_read_b64_tr_b16 a[222:223], v12 offset:1280
    ds_read_b64_tr_b16 a[224:225], v12 offset:8
    ds_read_b64_tr_b16 a[226:227], v12 offset:1288
    ds_read_b64_tr_b16 a[228:229], v12 offset:16
    ds_read_b64_tr_b16 a[230:231], v12 offset:1296
    ds_read_b64_tr_b16 a[232:233], v12 offset:24
    ds_read_b64_tr_b16 a[234:235], v12 offset:1304
    ds_read_b64_tr_b16 a[236:237], v12 offset:32
    ds_read_b64_tr_b16 a[238:239], v12 offset:1312
    s_mov_b32 s6, 0xbfb8aa3b
    s_mov_b32 s7, 0xbfb8aa3b
    v_accvgpr_read_b32 v192, a48
    v_accvgpr_read_b32 v193, a49
    v_accvgpr_read_b32 v194, a50
    v_accvgpr_read_b32 v195, a51
    v_accvgpr_read_b32 v196, a52
    v_accvgpr_read_b32 v197, a53
    v_accvgpr_read_b32 v198, a54
    v_accvgpr_read_b32 v199, a55
    v_accvgpr_read_b32 v200, a80
    v_accvgpr_read_b32 v201, a81
    v_accvgpr_read_b32 v202, a82
    v_accvgpr_read_b32 v203, a83
    v_accvgpr_read_b32 v204, a84
    v_accvgpr_read_b32 v205, a85
    v_accvgpr_read_b32 v206, a86
    v_accvgpr_read_b32 v207, a87
    buffer_store_dwordx4 a[32:35], v13, s[12:15], s56 offen offset:0 sc1
    v_pk_mul_f32 v[208:209], v[192:193], s[6:7]
    v_pk_mul_f32 v[210:211], v[194:195], s[6:7]
    v_pk_mul_f32 v[212:213], v[196:197], s[6:7]
    v_pk_mul_f32 v[214:215], v[198:199], s[6:7]
    v_pk_mul_f32 v[192:193], v[192:193], v[200:201]
    v_pk_mul_f32 v[194:195], v[194:195], v[202:203]
    v_pk_mul_f32 v[196:197], v[196:197], v[204:205]
    v_pk_mul_f32 v[198:199], v[198:199], v[206:207]
    v_exp_f32 v208, v208
    v_exp_f32 v209, v209
    v_exp_f32 v210, v210
    v_exp_f32 v211, v211
    v_exp_f32 v212, v212
    v_exp_f32 v213, v213
    v_exp_f32 v214, v214
    v_exp_f32 v215, v215
    buffer_store_dwordx4 a[36:39], v13, s[12:15], s56 offen offset:256 sc1
    v_pk_add_f32 v[208:209], v[208:209], 1.0 op_sel_hi:[1,0]
    v_pk_add_f32 v[210:211], v[210:211], 1.0 op_sel_hi:[1,0]
    v_pk_add_f32 v[212:213], v[212:213], 1.0 op_sel_hi:[1,0]
    v_pk_add_f32 v[214:215], v[214:215], 1.0 op_sel_hi:[1,0]
    v_rcp_f32 v208, v208
    v_rcp_f32 v209, v209
    v_rcp_f32 v210, v210
    v_rcp_f32 v211, v211
    v_rcp_f32 v212, v212
    v_rcp_f32 v213, v213
    v_rcp_f32 v214, v214
    v_rcp_f32 v215, v215
    v_pk_mul_f32 v[192:193], v[192:193], v[208:209]
    v_pk_mul_f32 v[194:195], v[194:195], v[210:211]
    v_pk_mul_f32 v[196:197], v[196:197], v[212:213]
    v_pk_mul_f32 v[198:199], v[198:199], v[214:215]
    v_cvt_pk_bf16_f32 v224, v192, v193
    v_cvt_pk_bf16_f32 v225, v194, v195
    v_cvt_pk_bf16_f32 v226, v196, v197
    v_cvt_pk_bf16_f32 v227, v198, v199
    v_accvgpr_read_b32 v192, a56
    v_accvgpr_read_b32 v193, a57
    v_accvgpr_read_b32 v194, a58
    v_accvgpr_read_b32 v195, a59
    v_accvgpr_read_b32 v196, a60
    v_accvgpr_read_b32 v197, a61
    v_accvgpr_read_b32 v198, a62
    v_accvgpr_read_b32 v199, a63
    v_accvgpr_read_b32 v200, a88
    v_accvgpr_read_b32 v201, a89
    v_accvgpr_read_b32 v202, a90
    v_accvgpr_read_b32 v203, a91
    v_accvgpr_read_b32 v204, a92
    v_accvgpr_read_b32 v205, a93
    v_accvgpr_read_b32 v206, a94
    v_accvgpr_read_b32 v207, a95
    buffer_store_dwordx4 v[224:227], v13, s[12:15], s56 offen offset:2048 sc1
    v_pk_mul_f32 v[208:209], v[192:193], s[6:7]
    v_pk_mul_f32 v[210:211], v[194:195], s[6:7]
    v_pk_mul_f32 v[212:213], v[196:197], s[6:7]
    v_pk_mul_f32 v[214:215], v[198:199], s[6:7]
    v_pk_mul_f32 v[192:193], v[192:193], v[200:201]
    v_pk_mul_f32 v[194:195], v[194:195], v[202:203]
    v_pk_mul_f32 v[196:197], v[196:197], v[204:205]
    v_pk_mul_f32 v[198:199], v[198:199], v[206:207]
    v_exp_f32 v208, v208
    v_exp_f32 v209, v209
    v_exp_f32 v210, v210
    v_exp_f32 v211, v211
    v_exp_f32 v212, v212
    v_exp_f32 v213, v213
    v_exp_f32 v214, v214
    v_exp_f32 v215, v215
    v_pk_add_f32 v[208:209], v[208:209], 1.0 op_sel_hi:[1,0]
    v_pk_add_f32 v[210:211], v[210:211], 1.0 op_sel_hi:[1,0]
    v_pk_add_f32 v[212:213], v[212:213], 1.0 op_sel_hi:[1,0]
    v_pk_add_f32 v[214:215], v[214:215], 1.0 op_sel_hi:[1,0]
    v_rcp_f32 v208, v208
    v_rcp_f32 v209, v209
    v_rcp_f32 v210, v210
    v_rcp_f32 v211, v211
    v_rcp_f32 v212, v212
    v_rcp_f32 v213, v213
    v_rcp_f32 v214, v214
    v_rcp_f32 v215, v215
    v_pk_mul_f32 v[192:193], v[192:193], v[208:209]
    v_pk_mul_f32 v[194:195], v[194:195], v[210:211]
    v_pk_mul_f32 v[196:197], v[196:197], v[212:213]
    v_pk_mul_f32 v[198:199], v[198:199], v[214:215]
    v_cvt_pk_bf16_f32 v228, v192, v193
    v_cvt_pk_bf16_f32 v229, v194, v195
    v_cvt_pk_bf16_f32 v230, v196, v197
    v_cvt_pk_bf16_f32 v231, v198, v199
    buffer_store_dwordx4 v[228:231], v13, s[12:15], s56 offen offset:2304 sc1
L_passb_end:
L_pad8:
    s_cbranch_execz L_pad12
    s_mov_b32 s6, 0xbfb8aa3b
    s_mov_b32 s7, 0xbfb8aa3b
    s_nop 5
    v_pk_mul_f32 v[16:17], v[32:33], s[6:7]
    v_pk_mul_f32 v[18:19], v[34:35], s[6:7]
    v_pk_mul_f32 v[20:21], v[36:37], s[6:7]
    v_pk_mul_f32 v[22:23], v[38:39], s[6:7]
    v_pk_mul_f32 v[32:33], v[32:33], v[64:65]
    v_pk_mul_f32 v[34:35], v[34:35], v[66:67]
    v_pk_mul_f32 v[36:37], v[36:37], v[68:69]
    v_pk_mul_f32 v[38:39], v[38:39], v[70:71]
    v_mfma_f32_32x32x8_bf16 a[0:15], v[130:131], v[130:131], 0
    v_exp_f32 v16, v16
    v_exp_f32 v17, v17
    v_exp_f32 v18, v18
    v_exp_f32 v19, v19
    v_exp_f32 v20, v20
    v_exp_f32 v21, v21
    v_exp_f32 v22, v22
    v_exp_f32 v23, v23
    v_add_f32 v16, 1.0, v16
    v_add_f32 v17, 1.0, v17
    v_add_f32 v18, 1.0, v18
    v_add_f32 v19, 1.0, v19
    v_pk_add_f32 v[20:21], v[20:21], 1.0 op_sel_hi:[1,0]
    v_pk_add_f32 v[22:23], v[22:23], 1.0 op_sel_hi:[1,0]
    v_mfma_f32_32x32x8_bf16 a[16:31], v[130:131], v[130:131], 0
    v_rcp_f32 v16, v16
    v_rcp_f32 v17, v17
    v_rcp_f32 v18, v18
    v_rcp_f32 v19, v19
    v_rcp_f32 v20, v20
    v_rcp_f32 v21, v21
    v_rcp_f32 v22, v22
    v_rcp_f32 v23, v23
    v_mul_f32 v32, v32, v16
    v_mul_f32 v33, v33, v17
    v_mul_f32 v34, v34, v18
    v_mul_f32 v35, v35, v19
    v_pk_mul_f32 v[36:37], v[36:37], v[20:21]
    v_pk_mul_f32 v[38:39], v[38:39], v[22:23]
    v_cvt_pk_bf16_f32 v64, v32, v33
    v_cvt_pk_bf16_f32 v65, v34, v35
    v_cvt_pk_bf16_f32 v66, v36, v37
    v_cvt_pk_bf16_f32 v67, v38, v39
    v_pk_mul_f32 v[16:17], v[40:41], s[6:7]
    v_pk_mul_f32 v[18:19], v[42:43], s[6:7]
    v_pk_mul_f32 v[20:21], v[44:45], s[6:7]
    v_pk_mul_f32 v[22:23], v[46:47], s[6:7]
    v_pk_mul_f32 v[40:41], v[40:41], v[72:73]
    v_pk_mul_f32 v[42:43], v[42:43], v[74:75]
    v_pk_mul_f32 v[44:45], v[44:45], v[76:77]
    v_pk_mul_f32 v[46:47], v[46:47], v[78:79]
    v_mfma_f32_32x32x8_bf16 a[48:63], v[130:131], v[130:131], 0
    v_exp_f32 v16, v16
    v_exp_f32 v17, v17
    v_exp_f32 v18, v18
    v_exp_f32 v19, v19
    v_exp_f32 v20, v20
    v_exp_f32 v21, v21
    v_exp_f32 v22, v22
    v_exp_f32 v23, v23
    v_add_f32 v16, 1.0, v16
    v_add_f32 v17, 1.0, v17
    v_add_f32 v18, 1.0, v18
    v_add_f32 v19, 1.0, v19
    v_pk_add_f32 v[20:21], v[20:21], 1.0 op_sel_hi:[1,0]
    v_pk_add_f32 v[22:23], v[22:23], 1.0 op_sel_hi:[1,0]
    v_mfma_f32_32x32x8_bf16 a[64:79], v[130:131], v[130:131], 0
    v_rcp_f32 v16, v16
    v_rcp_f32 v17, v17
    v_rcp_f32 v18, v18
    v_rcp_f32 v19, v19
    v_rcp_f32 v20, v20
    v_rcp_f32 v21, v21
    v_rcp_f32 v22, v22
    v_rcp_f32 v23, v23
    v_mul_f32 v40, v40, v16
    v_mul_f32 v41, v41, v17
    v_mul_f32 v42, v42, v18
    v_mul_f32 v43, v43, v19
    v_pk_mul_f32 v[44:45], v[44:45], v[20:21]
    v_pk_mul_f32 v[46:47], v[46:47], v[22:23]
    v_cvt_pk_bf16_f32 v68, v40, v41
    v_cvt_pk_bf16_f32 v69, v42, v43
    v_cvt_pk_bf16_f32 v70, v44, v45
    v_cvt_pk_bf16_f32 v71, v46, v47
    s_waitcnt vmcnt(8)
    s_waitcnt lgkmcnt(0)
    s_barrier
    ds_read_b64 a[144:145], v112 offset:0
    ds_read_b64 a[146:147], v113 offset:0
    ds_read_b64 a[148:149], v114 offset:0
    s_waitcnt vmcnt(4)
    ds_read_b64_tr_b16 a[204:205], v147 offset:0
    ds_read_b64_tr_b16 a[206:207], v147 offset:64
    ds_read_b64_tr_b16 a[208:209], v147 offset:256
    ds_read_b64_tr_b16 a[210:211], v147 offset:320
    v_pk_mul_f32 v[16:17], v[48:49], s[6:7]
    v_pk_mul_f32 v[18:19], v[50:51], s[6:7]
    v_pk_mul_f32 v[20:21], v[52:53], s[6:7]
    v_pk_mul_f32 v[22:23], v[54:55], s[6:7]
    v_pk_mul_f32 v[48:49], v[48:49], v[80:81]
    v_pk_mul_f32 v[50:51], v[50:51], v[82:83]
    v_pk_mul_f32 v[52:53], v[52:53], v[84:85]
    v_pk_mul_f32 v[54:55], v[54:55], v[86:87]
    v_mfma_f32_32x32x8_bf16 a[80:95], v[130:131], v[130:131], 0
    ds_read_b64 a[150:151], v112 offset:1024
    ds_read_b64 a[152:153], v113 offset:1024
    ds_read_b64 a[154:155], v114 offset:1024
    ds_read_b64 a[156:157], v115 offset:0
    ds_read_b64 a[158:159], v116 offset:0
    ds_read_b64 a[160:161], v117 offset:0
    v_exp_f32 v16, v16
    v_exp_f32 v17, v17
    v_exp_f32 v18, v18
    v_exp_f32 v19, v19
    v_exp_f32 v20, v20
    v_exp_f32 v21, v21
    v_exp_f32 v22, v22
    v_exp_f32 v23, v23
    v_add_f32 v16, 1.0, v16
    v_add_f32 v17, 1.0, v17
    v_add_f32 v18, 1.0, v18
    v_add_f32 v19, 1.0, v19
    v_pk_add_f32 v[20:21], v[20:21], 1.0 op_sel_hi:[1,0]
    v_pk_add_f32 v[22:23], v[22:23], 1.0 op_sel_hi:[1,0]
    v_mfma_f32_32x32x8_bf16 v[160:175], v[130:131], v[130:131], 0
    ds_read_b64 a[162:163], v115 offset:1024
    ds_read_b64 a[164:165], v116 offset:1024
    ds_read_b64 a[166:167], v117 offset:1024
    ds_read_b64 a[168:169], v118 offset:0
    ds_read_b64 a[170:171], v119 offset:0
    ds_read_b64 a[172:173], v120 offset:0
    v_rcp_f32 v16, v16
    v_rcp_f32 v17, v17
    v_rcp_f32 v18, v18
    v_rcp_f32 v19, v19
    v_rcp_f32 v20, v20
    v_rcp_f32 v21, v21
    v_rcp_f32 v22, v22
    v_rcp_f32 v23, v23
    v_mul_f32 v48, v48, v16
    v_mul_f32 v49, v49, v17
    v_mul_f32 v50, v50, v18
    v_mul_f32 v51, v51, v19
    v_pk_mul_f32 v[52:53], v[52:53], v[20:21]
    v_pk_mul_f32 v[54:55], v[54:55], v[22:23]
    v_cvt_pk_bf16_f32 v80, v48, v49
    v_cvt_pk_bf16_f32 v81, v50, v51
    v_cvt_pk_bf16_f32 v82, v52, v53
    v_cvt_pk_bf16_f32 v83, v54, v55
    v_pk_mul_f32 v[16:17], v[56:57], s[6:7]
    v_pk_mul_f32 v[18:19], v[58:59], s[6:7]
    v_pk_mul_f32 v[20:21], v[60:61], s[6:7]
    v_pk_mul_f32 v[22:23], v[62:63], s[6:7]
    v_pk_mul_f32 v[56:57], v[56:57], v[88:89]
    v_pk_mul_f32 v[58:59], v[58:59], v[90:91]
    v_pk_mul_f32 v[60:61], v[60:61], v[92:93]
    v_pk_mul_f32 v[62:63], v[62:63], v[94:95]
    v_mfma_f32_32x32x8_bf16 v[176:191], v[130:131], v[130:131], 0
    ds_read_b64 a[174:175], v118 offset:1024
    ds_read_b64 a[176:177], v119 offset:1024
    ds_read_b64 a[178:179], v120 offset:1024
    ds_read_b64 a[180:181], v121 offset:0
    ds_read_b64 a[182:183], v122 offset:0
    ds_read_b64 a[184:185], v123 offset:0
    v_exp_f32 v16, v16
    v_exp_f32 v17, v17
    v_exp_f32 v18, v18
    v_exp_f32 v19, v19
    v_exp_f32 v20, v20
    v_exp_f32 v21, v21
    v_exp_f32 v22, v22
    v_exp_f32 v23, v23
    v_add_f32 v16, 1.0, v16
    v_add_f32 v17, 1.0, v17
    v_add_f32 v18, 1.0, v18
    v_add_f32 v19, 1.0, v19
    v_pk_add_f32 v[20:21], v[20:21], 1.0 op_sel_hi:[1,0]
    v_pk_add_f32 v[22:23], v[22:23], 1.0 op_sel_hi:[1,0]
    v_mfma_f32_32x32x8_bf16 a[32:47], v[130:131], v[130:131], 0
    ds_read_b64 a[186:187], v121 offset:1024
    ds_read_b64 a[188:189], v122 offset:1024
    ds_read_b64 a[190:191], v123 offset:1024
    v_rcp_f32 v16, v16
    v_rcp_f32 v17, v17
    v_rcp_f32 v18, v18
    v_rcp_f32 v19, v19
    v_rcp_f32 v20, v20
    v_rcp_f32 v21, v21
    v_rcp_f32 v22, v22
    v_rcp_f32 v23, v23
    v_mul_f32 v56, v56, v16
    v_mul_f32 v57, v57, v17
    v_mul_f32 v58, v58, v18
    v_mul_f32 v59, v59, v19
    v_pk_mul_f32 v[60:61], v[60:61], v[20:21]
    v_pk_mul_f32 v[62:63], v[62:63], v[22:23]
    s_waitcnt lgkmcnt(15)
    v_mfma_f32_32x32x16_bf16 v[96:111], a[192:195], a[144:147], 0
    s_add_u32 m0, s48, 35840
    v_cvt_pk_bf16_f32 v84, v56, v57
    v_cvt_pk_bf16_f32 v85, v58, v59
    v_cvt_pk_bf16_f32 v86, v60, v61
    v_cvt_pk_bf16_f32 v87, v62, v63
    v_mfma_f32_32x32x8_bf16 v[96:111], a[196:197], a[148:149], v[96:111]
    global_load_lds_dwordx4 v146, s[16:17] offset:0 sc1
    global_load_lds_dwordx4 v146, s[16:17] offset:1024 sc1
    v_add_u32 v146, 123904, v146
    s_nop 6
    v_mov_b32 v14, 0x100
    v_mfma_f32_32x32x16_bf16 v[112:127], a[192:195], a[150:153], 0
    s_lshl_b32 s4, s62, 3
    v_exp_f32 v96, v96
    v_exp_f32 v97, v97
    v_exp_f32 v98, v98
    v_exp_f32 v99, v99
    v_mfma_f32_32x32x8_bf16 v[112:127], a[196:197], a[154:155], v[112:127]
    v_exp_f32 v100, v100
    v_exp_f32 v101, v101
    v_exp_f32 v102, v102
    v_exp_f32 v103, v103
    s_lshl_b32 s5, s3, 1
    v_exp_f32 v104, v104
    v_exp_f32 v105, v105
    v_exp_f32 v106, v106
    v_exp_f32 v107, v107
    v_smfmac_f32_32x32x32_bf16 a[0:15], a[204:207], v[96:103], v150
    s_add_u32 s4, s4, s5
    v_exp_f32 v108, v108
    v_exp_f32 v109, v109
    v_exp_f32 v110, v110
    v_exp_f32 v111, v111
    v_mfma_f32_32x32x16_bf16 v[128:143], a[192:195], a[156:159], 0
    s_waitcnt lgkmcnt(0)
    v_exp_f32 v112, v112
    v_exp_f32 v113, v113
    v_exp_f32 v114, v114
    v_exp_f32 v115, v115
    v_mfma_f32_32x32x8_bf16 v[128:143], a[196:197], a[160:161], v[128:143]
    v_exp_f32 v116, v116
    v_exp_f32 v117, v117
    v_exp_f32 v118, v118
    v_exp_f32 v119, v119
    v_smfmac_f32_32x32x32_bf16 a[0:15], a[208:211], v[104:111], v150
    s_lshl_b32 s4, s4, 5
    buffer_store_dwordx4 v[64:67], v13, s[12:15], s57 offen offset:0 sc1
    v_exp_f32 v120, v120
    v_exp_f32 v121, v121
    v_exp_f32 v122, v122
    v_exp_f32 v123, v123
    v_smfmac_f32_32x32x32_bf16 a[16:31], a[204:207], v[112:119], v150
    s_add_u32 s4, s4, s61
    v_exp_f32 v124, v124
    v_exp_f32 v125, v125
    v_exp_f32 v126, v126
    v_exp_f32 v127, v127
    v_mfma_f32_32x32x16_bf16 v[96:111], a[192:195], a[162:165], 0
    s_lshl_b32 s67, s4, 10
    v_exp_f32 v128, v128
    v_exp_f32 v129, v129
    v_exp_f32 v130, v130
    v_exp_f32 v131, v131
    v_mfma_f32_32x32x8_bf16 v[96:111], a[196:197], a[166:167], v[96:111]
    v_exp_f32 v132, v132
    v_exp_f32 v133, v133
    v_exp_f32 v134, v134
    v_exp_f32 v135, v135
    v_smfmac_f32_32x32x32_bf16 a[16:31], a[208:211], v[120:127], v150
    s_add_u32 s67, s67, 14286848
    buffer_store_dwordx4 v[68:71], v13, s[12:15], s57 offen offset:256 sc1
    v_exp_f32 v136, v136
    v_exp_f32 v137, v137
    v_exp_f32 v138, v138
    v_exp_f32 v139, v139
    v_smfmac_f32_32x32x32_bf16 a[32:47], a[204:207], v[128:135], v150
    s_lshl_b32 s68, s4, 8
    v_exp_f32 v140, v140
    v_exp_f32 v141, v141
    v_exp_f32 v142, v142
    v_exp_f32 v143, v143
    v_mfma_f32_32x32x16_bf16 v[112:127], a[192:195], a[168:171], 0
    s_waitcnt vmcnt(6)
    ds_read_b64_tr_b16 a[212:213], v148 offset:0
    ds_read_b64_tr_b16 a[214:215], v148 offset:64
    ds_read_b64_tr_b16 a[216:217], v148 offset:256
    ds_read_b64_tr_b16 a[218:219], v148 offset:320
    v_exp_f32 v96, v96
    v_exp_f32 v97, v97
    v_exp_f32 v98, v98
    v_exp_f32 v99, v99
    v_mfma_f32_32x32x8_bf16 v[112:127], a[196:197], a[172:173], v[112:127]
    v_exp_f32 v100, v100
    v_exp_f32 v101, v101
    v_exp_f32 v102, v102
    v_exp_f32 v103, v103
    v_smfmac_f32_32x32x32_bf16 a[32:47], a[208:211], v[136:143], v150
    s_add_u32 s68, s68, 16385024
    buffer_store_dwordx4 v[80:83], v13, s[12:15], s57 offen offset:2048 sc1
    v_exp_f32 v104, v104
    v_exp_f32 v105, v105
    v_exp_f32 v106, v106
    v_exp_f32 v107, v107
    v_smfmac_f32_32x32x32_bf16 a[48:63], a[204:207], v[96:103], v150
    s_add_u32 s22, s67, 32768
    v_lshrrev_b32 v149, 5, v0
    v_mul_u32_u24 v149, 7936, v149
    v_lshl_add_u32 v149, v0, 3, v149
    v_mov_b32 v76, -1
    v_mov_b32 v77, -1
    v_mov_b32 v78, -1
    v_mov_b32 v79, -1
    v_exp_f32 v108, v108
    v_exp_f32 v109, v109
    v_exp_f32 v110, v110
    v_exp_f32 v111, v111
    v_mfma_f32_32x32x16_bf16 v[128:143], a[192:195], a[174:177], 0
    s_waitcnt lgkmcnt(0)
    v_exp_f32 v112, v112
    v_exp_f32 v113, v113
    v_exp_f32 v114, v114
    v_exp_f32 v115, v115
    v_mfma_f32_32x32x8_bf16 v[128:143], a[196:197], a[178:179], v[128:143]
    v_exp_f32 v116, v116
    v_exp_f32 v117, v117
    v_exp_f32 v118, v118
    v_exp_f32 v119, v119
    v_smfmac_f32_32x32x32_bf16 a[48:63], a[208:211], v[104:111], v150
    buffer_store_dwordx4 v[84:87], v13, s[12:15], s57 offen offset:2304 sc1
    v_exp_f32 v120, v120
    v_exp_f32 v121, v121
    v_exp_f32 v122, v122
    v_exp_f32 v123, v123
    v_smfmac_f32_32x32x32_bf16 a[64:79], a[204:207], v[112:119], v150
    s_add_u32 m0, s48, 37888
    v_exp_f32 v124, v124
    v_exp_f32 v125, v125
    v_exp_f32 v126, v126
    v_exp_f32 v127, v127
    v_mfma_f32_32x32x16_bf16 v[96:111], a[192:195], a[180:183], 0
    global_load_lds_dwordx4 v146, s[16:17] offset:0 sc1
    global_load_lds_dwordx4 v146, s[16:17] offset:1024 sc1
    v_exp_f32 v128, v128
    v_exp_f32 v129, v129
    v_exp_f32 v130, v130
    v_exp_f32 v131, v131
    v_mfma_f32_32x32x8_bf16 v[96:111], a[196:197], a[184:185], v[96:111]
    v_exp_f32 v132, v132
    v_exp_f32 v133, v133
    v_exp_f32 v134, v134
    v_exp_f32 v135, v135
    v_smfmac_f32_32x32x32_bf16 a[64:79], a[208:211], v[120:127], v150
    buffer_store_dwordx4 a[220:223], v1, s[12:15], s59 offen offset:0 sc1
    v_exp_f32 v136, v136
    v_exp_f32 v137, v137
    v_exp_f32 v138, v138
    v_exp_f32 v139, v139
    v_smfmac_f32_32x32x32_bf16 a[80:95], a[204:207], v[128:135], v150
    buffer_store_dwordx4 v[76:79], v1, s[12:15], s67 offen offset:0 sc1
    v_exp_f32 v140, v140
    v_exp_f32 v141, v141
    v_exp_f32 v142, v142
    v_exp_f32 v143, v143
    v_mfma_f32_32x32x16_bf16 v[112:127], a[192:195], a[186:189], 0
    buffer_store_dwordx4 v[76:79], v1, s[12:15], s22 offen offset:0 sc1
    v_exp_f32 v96, v96
    v_exp_f32 v97, v97
    v_exp_f32 v98, v98
    v_exp_f32 v99, v99
    v_mfma_f32_32x32x8_bf16 v[112:127], a[196:197], a[190:191], v[112:127]
    v_exp_f32 v100, v100
    v_exp_f32 v101, v101
    v_exp_f32 v102, v102
    v_exp_f32 v103, v103
    v_smfmac_f32_32x32x32_bf16 a[80:95], a[208:211], v[136:143], v150
    buffer_store_dwordx4 a[224:227], v1, s[12:15], s59 offen offset:1024 sc1
    v_exp_f32 v104, v104
    v_exp_f32 v105, v105
    v_exp_f32 v106, v106
    v_exp_f32 v107, v107
    v_smfmac_f32_32x32x32_bf16 v[160:175], a[204:207], v[96:103], v150
    s_waitcnt vmcnt(12)
    global_load_dwordx4 a[192:195], v144, s[16:17] offset:0 sc1
    global_load_dwordx2 a[196:197], v145, s[16:17] offset:0 sc1
    v_exp_f32 v108, v108
    v_exp_f32 v109, v109
    v_exp_f32 v110, v110
    v_exp_f32 v111, v111
    v_mfma_f32_32x32x16_bf16 v[128:143], a[198:201], a[144:147], 0
    s_add_u32 s16, s16, 123904
    s_addc_u32 s17, s17, 0
    v_exp_f32 v112, v112
    v_exp_f32 v113, v113
    v_exp_f32 v114, v114
    v_exp_f32 v115, v115
    v_mfma_f32_32x32x8_bf16 v[128:143], a[202:203], a[148:149], v[128:143]
    v_exp_f32 v116, v116
    v_exp_f32 v117, v117
    v_exp_f32 v118, v118
    v_exp_f32 v119, v119
    v_smfmac_f32_32x32x32_bf16 v[160:175], a[208:211], v[104:111], v150
    buffer_store_dwordx4 a[228:231], v1, s[12:15], s59 offen offset:2048 sc1
    v_exp_f32 v120, v120
    v_exp_f32 v121, v121
    v_exp_f32 v122, v122
    v_exp_f32 v123, v123
    v_smfmac_f32_32x32x32_bf16 v[176:191], a[204:207], v[112:119], v150
    buffer_store_dwordx2 v[76:77], v149, s[12:15], s68 offen offset:0 sc1
    v_and_b32 v72, 15, v0
    v_lshrrev_b32 v73, 4, v0
    v_lshlrev_b32 v74, 9, v73
    v_lshl_add_u32 v6, v72, 3, v74
    v_lshl_add_u32 v74, v72, 4, v74
    v_mul_u32_u24 v11, 1280, v72
    v_mad_u32_u24 v11, v73, 40, v11
    v_exp_f32 v124, v124
    v_exp_f32 v125, v125
    v_exp_f32 v126, v126
    v_exp_f32 v127, v127
    v_mfma_f32_32x32x16_bf16 v[96:111], a[198:201], a[150:153], 0
    s_add_u32 s4, s3, 1
    v_exp_f32 v128, v128
    v_exp_f32 v129, v129
    v_exp_f32 v130, v130
    v_exp_f32 v131, v131
    v_mfma_f32_32x32x8_bf16 v[96:111], a[202:203], a[154:155], v[96:111]
    v_exp_f32 v132, v132
    v_exp_f32 v133, v133
    v_exp_f32 v134, v134
    v_exp_f32 v135, v135
    v_smfmac_f32_32x32x32_bf16 v[176:191], a[208:211], v[120:127], v150
    s_and_b32 s5, s4, 1
    buffer_store_dwordx4 a[232:235], v1, s[12:15], s59 offen offset:3072 sc1
    v_exp_f32 v136, v136
    v_exp_f32 v137, v137
    v_exp_f32 v138, v138
    v_exp_f32 v139, v139
    v_smfmac_f32_32x32x32_bf16 a[0:15], a[212:215], v[128:135], v150
    s_lshl_b32 s5, s5, 8
    v_exp_f32 v140, v140
    v_exp_f32 v141, v141
    v_exp_f32 v142, v142
    v_exp_f32 v143, v143
    v_mfma_f32_32x32x16_bf16 v[112:127], a[198:201], a[156:159], 0
    s_bfe_u32 s4, s4, 0x10001
    v_exp_f32 v96, v96
    v_exp_f32 v97, v97
    v_exp_f32 v98, v98
    v_exp_f32 v99, v99
    v_mfma_f32_32x32x8_bf16 v[112:127], a[202:203], a[160:161], v[112:127]
    v_exp_f32 v100, v100
    v_exp_f32 v101, v101
    v_exp_f32 v102, v102
    v_exp_f32 v103, v103
    v_smfmac_f32_32x32x32_bf16 a[0:15], a[216:219], v[136:143], v150
    s_mul_i32 s4, s4, 99328
    s_add_u32 s59, s59, 4096
    buffer_store_dwordx4 a[236:239], v1, s[12:15], s59 offen offset:0 sc1
    v_exp_f32 v104, v104
    v_exp_f32 v105, v105
    v_exp_f32 v106, v106
    v_exp_f32 v107, v107
    v_smfmac_f32_32x32x32_bf16 a[16:31], a[212:215], v[96:103], v150
    s_add_u32 s4, s4, s5
    v_add_u32 v2, s4, v74
    v_add_u32 v7, 15360, v1
    v_exp_f32 v108, v108
    v_exp_f32 v109, v109
    v_exp_f32 v110, v110
    v_exp_f32 v111, v111
    v_mfma_f32_32x32x16_bf16 v[128:143], a[198:201], a[162:165], 0
    s_add_u32 s4, s3, 2
    v_exp_f32 v112, v112
    v_exp_f32 v113, v113
    v_exp_f32 v114, v114
    v_exp_f32 v115, v115
    v_mfma_f32_32x32x8_bf16 v[128:143], a[202:203], a[166:167], v[128:143]
    v_exp_f32 v116, v116
    v_exp_f32 v117, v117
    v_exp_f32 v118, v118
    v_exp_f32 v119, v119
    v_smfmac_f32_32x32x32_bf16 a[16:31], a[216:219], v[104:111], v150
    s_and_b32 s5, s4, 1
    v_exp_f32 v120, v120
    v_exp_f32 v121, v121
    v_exp_f32 v122, v122
    v_exp_f32 v123, v123
    v_smfmac_f32_32x32x32_bf16 a[32:47], a[212:215], v[112:119], v150
    s_lshl_b32 s5, s5, 8
    v_exp_f32 v124, v124
    v_exp_f32 v125, v125
    v_exp_f32 v126, v126
    v_exp_f32 v127, v127
    v_mfma_f32_32x32x16_bf16 v[96:111], a[198:201], a[168:171], 0
    s_waitcnt vmcnt(16)
    ds_read_b64_tr_b16 a[204:205], v147 offset:0
    ds_read_b64_tr_b16 a[206:207], v147 offset:64
    ds_read_b64_tr_b16 a[208:209], v147 offset:256
    ds_read_b64_tr_b16 a[210:211], v147 offset:320
    v_exp_f32 v128, v128
    v_exp_f32 v129, v129
    v_exp_f32 v130, v130
    v_exp_f32 v131, v131
    v_mfma_f32_32x32x8_bf16 v[96:111], a[202:203], a[172:173], v[96:111]
    v_exp_f32 v132, v132
    v_exp_f32 v133, v133
    v_exp_f32 v134, v134
    v_exp_f32 v135, v135
    v_smfmac_f32_32x32x32_bf16 a[32:47], a[216:219], v[120:127], v150
    s_bfe_u32 s4, s4, 0x10001
    v_exp_f32 v136, v136
    v_exp_f32 v137, v137
    v_exp_f32 v138, v138
    v_exp_f32 v139, v139
    v_smfmac_f32_32x32x32_bf16 a[48:63], a[212:215], v[128:135], v150
    s_mul_i32 s4, s4, 99328
    v_exp_f32 v140, v140
    v_exp_f32 v141, v141
    v_exp_f32 v142, v142
    v_exp_f32 v143, v143
    v_mfma_f32_32x32x16_bf16 v[112:127], a[198:201], a[174:177], 0
    s_waitcnt lgkmcnt(0)
    v_exp_f32 v96, v96
    v_exp_f32 v97, v97
    v_exp_f32 v98, v98
    v_exp_f32 v99, v99
    v_mfma_f32_32x32x8_bf16 v[112:127], a[202:203], a[178:179], v[112:127]
    v_exp_f32 v100, v100
    v_exp_f32 v101, v101
    v_exp_f32 v102, v102
    v_exp_f32 v103, v103
    v_smfmac_f32_32x32x32_bf16 a[48:63], a[216:219], v[136:143], v150
    s_add_u32 s4, s4, s5
    v_add_u32 v3, s4, v74
    v_add_u32 v8, 56320, v1
    v_exp_f32 v104, v104
    v_exp_f32 v105, v105
    v_exp_f32 v106, v106
    v_exp_f32 v107, v107
    v_smfmac_f32_32x32x32_bf16 a[64:79], a[212:215], v[96:103], v150
    s_add_u32 m0, s48, 35840
    v_exp_f32 v108, v108
    v_exp_f32 v109, v109
    v_exp_f32 v110, v110
    v_exp_f32 v111, v111
    v_mfma_f32_32x32x16_bf16 v[128:143], a[198:201], a[180:183], 0
    s_add_u32 s4, s3, 3
    global_load_lds_dwordx4 v146, s[16:17] offset:0 sc1
    global_load_lds_dwordx4 v146, s[16:17] offset:1024 sc1
    v_exp_f32 v112, v112
    v_exp_f32 v113, v113
    v_exp_f32 v114, v114
    v_exp_f32 v115, v115
    v_mfma_f32_32x32x8_bf16 v[128:143], a[202:203], a[184:185], v[128:143]
    v_exp_f32 v116, v116
    v_exp_f32 v117, v117
    v_exp_f32 v118, v118
    v_exp_f32 v119, v119
    v_smfmac_f32_32x32x32_bf16 a[64:79], a[216:219], v[104:111], v150
    s_and_b32 s5, s4, 1
    v_exp_f32 v120, v120
    v_exp_f32 v121, v121
    v_exp_f32 v122, v122
    v_exp_f32 v123, v123
    v_smfmac_f32_32x32x32_bf16 a[80:95], a[212:215], v[112:119], v150
    s_lshl_b32 s5, s5, 8
    v_exp_f32 v124, v124
    v_exp_f32 v125, v125
    v_exp_f32 v126, v126
    v_exp_f32 v127, v127
    v_mfma_f32_32x32x16_bf16 v[96:111], a[198:201], a[186:189], 0
L_pad9:
    s_cbranch_execz L_pad13
    s_bfe_u32 s4, s4, 0x10001
    v_exp_f32 v128, v128
    v_exp_f32 v129, v129
    v_exp_f32 v130, v130
    v_exp_f32 v131, v131
    v_mfma_f32_32x32x8_bf16 v[96:111], a[202:203], a[190:191], v[96:111]
    v_exp_f32 v132, v132
    v_exp_f32 v133, v133
    v_exp_f32 v134, v134
    v_exp_f32 v135, v135
    v_smfmac_f32_32x32x32_bf16 a[80:95], a[216:219], v[120:127], v150
    s_mul_i32 s4, s4, 99328
    v_exp_f32 v136, v136
    v_exp_f32 v137, v137
    v_exp_f32 v138, v138
    v_exp_f32 v139, v139
    v_smfmac_f32_32x32x32_bf16 v[160:175], a[212:215], v[128:135], v150
    s_waitcnt vmcnt(6)
    global_load_dwordx4 a[198:201], v144, s[16:17] offset:0 sc1
    global_load_dwordx2 a[202:203], v145, s[16:17] offset:0 sc1
    v_exp_f32 v140, v140
    v_exp_f32 v141, v141
    v_exp_f32 v142, v142
    v_exp_f32 v143, v143
    v_mfma_f32_32x32x16_bf16 v[112:127], a[192:195], a[144:147], 0
    s_add_u32 s16, s16, 123904
    s_addc_u32 s17, s17, 0
    v_exp_f32 v96, v96
    v_exp_f32 v97, v97
    v_exp_f32 v98, v98
    v_exp_f32 v99, v99
    v_mfma_f32_32x32x8_bf16 v[112:127], a[196:197], a[148:149], v[112:127]
    v_exp_f32 v100, v100
    v_exp_f32 v101, v101
    v_exp_f32 v102, v102
    v_exp_f32 v103, v103
    v_smfmac_f32_32x32x32_bf16 v[160:175], a[216:219], v[136:143], v150
    s_add_u32 s4, s4, s5
    v_add_u32 v4, s4, v74
    v_add_u32 v9, 97280, v1
    v_exp_f32 v104, v104
    v_exp_f32 v105, v105
    v_exp_f32 v106, v106
    v_exp_f32 v107, v107
    v_smfmac_f32_32x32x32_bf16 v[176:191], a[212:215], v[96:103], v150
    s_add_u32 s4, s3, 4
    v_exp_f32 v108, v108
    v_exp_f32 v109, v109
    v_exp_f32 v110, v110
    v_exp_f32 v111, v111
    v_mfma_f32_32x32x16_bf16 v[128:143], a[192:195], a[150:153], 0
    s_and_b32 s5, s4, 1
    v_exp_f32 v112, v112
    v_exp_f32 v113, v113
    v_exp_f32 v114, v114
    v_exp_f32 v115, v115
    v_mfma_f32_32x32x8_bf16 v[128:143], a[196:197], a[154:155], v[128:143]
    v_exp_f32 v116, v116
    v_exp_f32 v117, v117
    v_exp_f32 v118, v118
    v_exp_f32 v119, v119
    v_smfmac_f32_32x32x32_bf16 v[176:191], a[216:219], v[104:111], v150
    s_lshl_b32 s5, s5, 8
    v_exp_f32 v120, v120
    v_exp_f32 v121, v121
    v_exp_f32 v122, v122
    v_exp_f32 v123, v123
    v_smfmac_f32_32x32x32_bf16 a[0:15], a[204:207], v[112:119], v150
    s_bfe_u32 s4, s4, 0x10001
    v_exp_f32 v124, v124
    v_exp_f32 v125, v125
    v_exp_f32 v126, v126
    v_exp_f32 v127, v127
    v_mfma_f32_32x32x16_bf16 v[96:111], a[192:195], a[156:159], 0
    s_mul_i32 s4, s4, 99328
    v_exp_f32 v128, v128
    v_exp_f32 v129, v129
    v_exp_f32 v130, v130
    v_exp_f32 v131, v131
    v_mfma_f32_32x32x8_bf16 v[96:111], a[196:197], a[160:161], v[96:111]
    v_exp_f32 v132, v132
    v_exp_f32 v133, v133
    v_exp_f32 v134, v134
    v_exp_f32 v135, v135
    v_smfmac_f32_32x32x32_bf16 a[0:15], a[208:211], v[120:127], v150
    s_add_u32 s4, s4, s5
    v_add_u32 v5, s4, v74
    v_add_u32 v10, 138240, v1
    v_exp_f32 v136, v136
    v_exp_f32 v137, v137
    v_exp_f32 v138, v138
    v_exp_f32 v139, v139
    v_smfmac_f32_32x32x32_bf16 a[16:31], a[204:207], v[128:135], v150
    s_mul_i32 s69, s61, 198656
    v_exp_f32 v140, v140
    v_exp_f32 v141, v141
    v_exp_f32 v142, v142
    v_exp_f32 v143, v143
    v_mfma_f32_32x32x16_bf16 v[112:127], a[192:195], a[162:165], 0
    s_mul_i32 s4, s3, 24576
    v_exp_f32 v96, v96
    v_exp_f32 v97, v97
    v_exp_f32 v98, v98
    v_exp_f32 v99, v99
    v_mfma_f32_32x32x8_bf16 v[112:127], a[196:197], a[166:167], v[112:127]
    v_exp_f32 v100, v100
    v_exp_f32 v101, v101
    v_exp_f32 v102, v102
    v_exp_f32 v103, v103
    v_smfmac_f32_32x32x32_bf16 a[16:31], a[208:211], v[136:143], v150
    s_add_u32 s69, s69, s4
    v_exp_f32 v104, v104
    v_exp_f32 v105, v105
    v_exp_f32 v106, v106
    v_exp_f32 v107, v107
    v_smfmac_f32_32x32x32_bf16 a[32:47], a[204:207], v[96:103], v150
    s_add_u32 s69, s69, 7933952
    v_exp_f32 v108, v108
    v_exp_f32 v109, v109
    v_exp_f32 v110, v110
    v_exp_f32 v111, v111
    v_mfma_f32_32x32x16_bf16 v[128:143], a[192:195], a[168:171], 0
    ds_read_b64_tr_b16 a[212:213], v148 offset:0
    ds_read_b64_tr_b16 a[214:215], v148 offset:64
    ds_read_b64_tr_b16 a[216:217], v148 offset:256
    ds_read_b64_tr_b16 a[218:219], v148 offset:320
    v_exp_f32 v112, v112
    v_exp_f32 v113, v113
    v_exp_f32 v114, v114
    v_exp_f32 v115, v115
    v_mfma_f32_32x32x8_bf16 v[128:143], a[196:197], a[172:173], v[128:143]
    v_exp_f32 v116, v116
    v_exp_f32 v117, v117
    v_exp_f32 v118, v118
    v_exp_f32 v119, v119
    v_smfmac_f32_32x32x32_bf16 a[32:47], a[208:211], v[104:111], v150
    v_accvgpr_read_b32 v13, a242
    v_exp_f32 v120, v120
    v_exp_f32 v121, v121
    v_exp_f32 v122, v122
    v_exp_f32 v123, v123
    v_smfmac_f32_32x32x32_bf16 a[48:63], a[204:207], v[112:119], v150
    s_add_u32 s18, s12, s69
    s_addc_u32 s19, s13, 0
    v_exp_f32 v124, v124
    v_exp_f32 v125, v125
    v_exp_f32 v126, v126
    v_exp_f32 v127, v127
    v_mfma_f32_32x32x16_bf16 v[96:111], a[192:195], a[174:177], 0
    s_waitcnt lgkmcnt(0)
    v_exp_f32 v128, v128
    v_exp_f32 v129, v129
    v_exp_f32 v130, v130
    v_exp_f32 v131, v131
    v_mfma_f32_32x32x8_bf16 v[96:111], a[196:197], a[178:179], v[96:111]
    v_exp_f32 v132, v132
    v_exp_f32 v133, v133
    v_exp_f32 v134, v134
    v_exp_f32 v135, v135
    v_smfmac_f32_32x32x32_bf16 a[48:63], a[208:211], v[120:127], v150
    s_waitcnt vmcnt(4)
    s_barrier
    buffer_atomic_add v14, v13, s[40:43], 0 offen sc1
    v_exp_f32 v136, v136
    v_exp_f32 v137, v137
    v_exp_f32 v138, v138
    v_exp_f32 v139, v139
    v_smfmac_f32_32x32x32_bf16 a[64:79], a[204:207], v[128:135], v150
    s_add_u32 m0, s48, 37888
    v_exp_f32 v140, v140
    v_exp_f32 v141, v141
    v_exp_f32 v142, v142
    v_exp_f32 v143, v143
    v_mfma_f32_32x32x16_bf16 v[112:127], a[192:195], a[180:183], 0
    s_mul_i32 s5, s62, 348160
    global_load_lds_dwordx4 v146, s[16:17] offset:0 sc1
    global_load_lds_dwordx4 v146, s[16:17] offset:1024 sc1
    v_exp_f32 v96, v96
    v_exp_f32 v97, v97
    v_exp_f32 v98, v98
    v_exp_f32 v99, v99
    v_mfma_f32_32x32x8_bf16 v[112:127], a[196:197], a[184:185], v[112:127]
    v_exp_f32 v100, v100
    v_exp_f32 v101, v101
    v_exp_f32 v102, v102
    v_exp_f32 v103, v103
    v_smfmac_f32_32x32x32_bf16 a[64:79], a[208:211], v[136:143], v150
    s_add_u32 s5, s5, 16910336
    v_exp_f32 v104, v104
    v_exp_f32 v105, v105
    v_exp_f32 v106, v106
    v_exp_f32 v107, v107
    v_smfmac_f32_32x32x32_bf16 a[80:95], a[204:207], v[96:103], v150
    s_mul_i32 s4, s3, 61440
    v_exp_f32 v108, v108
    v_exp_f32 v109, v109
    v_exp_f32 v110, v110
    v_exp_f32 v111, v111
    v_mfma_f32_32x32x16_bf16 v[128:143], a[192:195], a[186:189], 0
    s_add_u32 s70, s5, s4
    v_exp_f32 v112, v112
    v_exp_f32 v113, v113
    v_exp_f32 v114, v114
    v_exp_f32 v115, v115
    v_mfma_f32_32x32x8_bf16 v[128:143], a[196:197], a[190:191], v[128:143]
    v_exp_f32 v116, v116
    v_exp_f32 v117, v117
    v_exp_f32 v118, v118
    v_exp_f32 v119, v119
    v_smfmac_f32_32x32x32_bf16 a[80:95], a[208:211], v[104:111], v150
    s_add_u32 s70, s70, 4096
    v_mov_b32 v14, 1
    v_exp_f32 v120, v120
    v_exp_f32 v121, v121
    v_exp_f32 v122, v122
    v_exp_f32 v123, v123
    v_smfmac_f32_32x32x32_bf16 v[160:175], a[204:207], v[112:119], v150
    s_waitcnt vmcnt(3)
    global_load_dwordx4 a[192:195], v144, s[16:17] offset:0 sc1
    global_load_dwordx2 a[196:197], v145, s[16:17] offset:0 sc1
    v_exp_f32 v124, v124
    v_exp_f32 v125, v125
    v_exp_f32 v126, v126
    v_exp_f32 v127, v127
    v_mfma_f32_32x32x16_bf16 v[96:111], a[198:201], a[144:147], 0
    s_add_u32 s16, s16, 123904
    s_addc_u32 s17, s17, 0
    v_exp_f32 v128, v128
    v_exp_f32 v129, v129
    v_exp_f32 v130, v130
    v_exp_f32 v131, v131
    v_mfma_f32_32x32x8_bf16 v[96:111], a[202:203], a[148:149], v[96:111]
    v_exp_f32 v132, v132
    v_exp_f32 v133, v133
    v_exp_f32 v134, v134
    v_exp_f32 v135, v135
    v_smfmac_f32_32x32x32_bf16 v[160:175], a[208:211], v[120:127], v150
    s_add_u32 s20, s12, s70
    s_addc_u32 s21, s13, 0
    v_exp_f32 v136, v136
    v_exp_f32 v137, v137
    v_exp_f32 v138, v138
    v_exp_f32 v139, v139
    v_smfmac_f32_32x32x32_bf16 v[176:191], a[204:207], v[128:135], v150
    s_mul_i32 s4, s3, 25600
    v_exp_f32 v140, v140
    v_exp_f32 v141, v141
    v_exp_f32 v142, v142
    v_exp_f32 v143, v143
    v_mfma_f32_32x32x16_bf16 v[112:127], a[198:201], a[150:153], 0
    s_add_u32 s71, s5, s4
    v_exp_f32 v96, v96
    v_exp_f32 v97, v97
    v_exp_f32 v98, v98
    v_exp_f32 v99, v99
    v_mfma_f32_32x32x8_bf16 v[112:127], a[202:203], a[154:155], v[112:127]
    v_exp_f32 v100, v100
    v_exp_f32 v101, v101
    v_exp_f32 v102, v102
    v_exp_f32 v103, v103
    v_smfmac_f32_32x32x32_bf16 v[176:191], a[208:211], v[136:143], v150
    s_add_u32 s71, s71, 245760
    v_exp_f32 v104, v104
    v_exp_f32 v105, v105
    v_exp_f32 v106, v106
    v_exp_f32 v107, v107
    v_smfmac_f32_32x32x32_bf16 a[0:15], a[212:215], v[96:103], v150
    s_lshl_b32 s4, s61, 2
    v_exp_f32 v108, v108
    v_exp_f32 v109, v109
    v_exp_f32 v110, v110
    v_exp_f32 v111, v111
    v_mfma_f32_32x32x16_bf16 v[128:143], a[198:201], a[156:159], 0
    s_add_u32 s4, s4, s3
    v_exp_f32 v112, v112
    v_exp_f32 v113, v113
    v_exp_f32 v114, v114
    v_exp_f32 v115, v115
    v_mfma_f32_32x32x8_bf16 v[128:143], a[202:203], a[160:161], v[128:143]
    v_exp_f32 v116, v116
    v_exp_f32 v117, v117
    v_exp_f32 v118, v118
    v_exp_f32 v119, v119
    v_smfmac_f32_32x32x32_bf16 a[0:15], a[216:219], v[104:111], v150
    s_mul_i32 s72, s4, 20480
    v_exp_f32 v120, v120
    v_exp_f32 v121, v121
    v_exp_f32 v122, v122
    v_exp_f32 v123, v123
    v_smfmac_f32_32x32x32_bf16 a[16:31], a[212:215], v[112:119], v150
    s_mul_i32 s4, s62, 160
    v_exp_f32 v124, v124
    v_exp_f32 v125, v125
    v_exp_f32 v126, v126
    v_exp_f32 v127, v127
    v_mfma_f32_32x32x16_bf16 v[96:111], a[198:201], a[162:165], 0
    s_add_u32 s72, s72, s4
    global_load_dword v151, v1, s[98:99] offset:0
    v_exp_f32 v128, v128
    v_exp_f32 v129, v129
    v_exp_f32 v130, v130
    v_exp_f32 v131, v131
    v_mfma_f32_32x32x8_bf16 v[96:111], a[202:203], a[166:167], v[96:111]
    v_exp_f32 v132, v132
    v_exp_f32 v133, v133
    v_exp_f32 v134, v134
    v_exp_f32 v135, v135
    v_smfmac_f32_32x32x32_bf16 a[16:31], a[216:219], v[120:127], v150
    v_exp_f32 v136, v136
    v_exp_f32 v137, v137
    v_exp_f32 v138, v138
    v_exp_f32 v139, v139
    v_smfmac_f32_32x32x32_bf16 a[32:47], a[212:215], v[128:135], v150
    v_exp_f32 v140, v140
    v_exp_f32 v141, v141
    v_exp_f32 v142, v142
    v_exp_f32 v143, v143
    v_mfma_f32_32x32x16_bf16 v[112:127], a[198:201], a[168:171], 0
    ds_read_b64_tr_b16 a[204:205], v147 offset:0
    ds_read_b64_tr_b16 a[206:207], v147 offset:64
    ds_read_b64_tr_b16 a[208:209], v147 offset:256
    ds_read_b64_tr_b16 a[210:211], v147 offset:320
    v_exp_f32 v96, v96
    v_exp_f32 v97, v97
    v_exp_f32 v98, v98
    v_exp_f32 v99, v99
    v_mfma_f32_32x32x8_bf16 v[112:127], a[202:203], a[172:173], v[112:127]
    v_exp_f32 v100, v100
    v_exp_f32 v101, v101
    v_exp_f32 v102, v102
    v_exp_f32 v103, v103
    v_smfmac_f32_32x32x32_bf16 a[32:47], a[216:219], v[136:143], v150
    v_exp_f32 v104, v104
    v_exp_f32 v105, v105
    v_exp_f32 v106, v106
    v_exp_f32 v107, v107
    v_smfmac_f32_32x32x32_bf16 a[48:63], a[212:215], v[96:103], v150
    v_exp_f32 v108, v108
    v_exp_f32 v109, v109
    v_exp_f32 v110, v110
    v_exp_f32 v111, v111
    v_mfma_f32_32x32x16_bf16 v[128:143], a[198:201], a[174:177], 0
    s_waitcnt lgkmcnt(0)
    v_exp_f32 v112, v112
    v_exp_f32 v113, v113
    v_exp_f32 v114, v114
    v_exp_f32 v115, v115
    v_mfma_f32_32x32x8_bf16 v[128:143], a[202:203], a[178:179], v[128:143]
    v_exp_f32 v116, v116
    v_exp_f32 v117, v117
    v_exp_f32 v118, v118
    v_exp_f32 v119, v119
    v_smfmac_f32_32x32x32_bf16 a[48:63], a[216:219], v[104:111], v150
    v_exp_f32 v120, v120
    v_exp_f32 v121, v121
    v_exp_f32 v122, v122
    v_exp_f32 v123, v123
    v_smfmac_f32_32x32x32_bf16 a[64:79], a[212:215], v[112:119], v150
    s_add_u32 m0, s48, 35840
    v_exp_f32 v124, v124
    v_exp_f32 v125, v125
    v_exp_f32 v126, v126
    v_exp_f32 v127, v127
    v_mfma_f32_32x32x16_bf16 v[96:111], a[198:201], a[180:183], 0
    global_load_lds_dwordx4 v146, s[16:17] offset:0 sc1
    global_load_lds_dwordx4 v146, s[16:17] offset:1024 sc1
    v_exp_f32 v128, v128
    v_exp_f32 v129, v129
    v_exp_f32 v130, v130
    v_exp_f32 v131, v131
    v_mfma_f32_32x32x8_bf16 v[96:111], a[202:203], a[184:185], v[96:111]
    v_exp_f32 v132, v132
    v_exp_f32 v133, v133
    v_exp_f32 v134, v134
    v_exp_f32 v135, v135
    v_smfmac_f32_32x32x32_bf16 a[64:79], a[216:219], v[120:127], v150
    v_exp_f32 v136, v136
    v_exp_f32 v137, v137
    v_exp_f32 v138, v138
    v_exp_f32 v139, v139
    v_smfmac_f32_32x32x32_bf16 a[80:95], a[212:215], v[128:135], v150
    v_exp_f32 v140, v140
    v_exp_f32 v141, v141
    v_exp_f32 v142, v142
    v_exp_f32 v143, v143
    v_mfma_f32_32x32x16_bf16 v[112:127], a[198:201], a[186:189], 0
    v_exp_f32 v96, v96
    v_exp_f32 v97, v97
    v_exp_f32 v98, v98
    v_exp_f32 v99, v99
    v_mfma_f32_32x32x8_bf16 v[112:127], a[202:203], a[190:191], v[112:127]
    v_exp_f32 v100, v100
    v_exp_f32 v101, v101
    v_exp_f32 v102, v102
    v_exp_f32 v103, v103
    v_smfmac_f32_32x32x32_bf16 a[80:95], a[216:219], v[136:143], v150
    v_exp_f32 v104, v104
    v_exp_f32 v105, v105
    v_exp_f32 v106, v106
    v_exp_f32 v107, v107
    v_smfmac_f32_32x32x32_bf16 v[160:175], a[212:215], v[96:103], v150
    s_waitcnt vmcnt(3)
    global_load_dwordx4 a[198:201], v144, s[16:17] offset:0 sc1
    global_load_dwordx2 a[202:203], v145, s[16:17] offset:0 sc1
    v_exp_f32 v108, v108
    v_exp_f32 v109, v109
    v_exp_f32 v110, v110
    v_exp_f32 v111, v111
    v_mfma_f32_32x32x16_bf16 v[128:143], a[192:195], a[144:147], 0
    s_add_u32 s16, s16, 123904
    s_addc_u32 s17, s17, 0
    v_exp_f32 v112, v112
    v_exp_f32 v113, v113
    v_exp_f32 v114, v114
    v_exp_f32 v115, v115
    v_mfma_f32_32x32x8_bf16 v[128:143], a[196:197], a[148:149], v[128:143]
    v_exp_f32 v116, v116
    v_exp_f32 v117, v117
    v_exp_f32 v118, v118
    v_exp_f32 v119, v119
    v_smfmac_f32_32x32x32_bf16 v[160:175], a[216:219], v[104:111], v150
    v_exp_f32 v120, v120
    v_exp_f32 v121, v121
    v_exp_f32 v122, v122
    v_exp_f32 v123, v123
    v_smfmac_f32_32x32x32_bf16 v[176:191], a[212:215], v[112:119], v150
    v_exp_f32 v124, v124
    v_exp_f32 v125, v125
    v_exp_f32 v126, v126
    v_exp_f32 v127, v127
    v_mfma_f32_32x32x16_bf16 v[96:111], a[192:195], a[150:153], 0
    v_exp_f32 v128, v128
    v_exp_f32 v129, v129
    v_exp_f32 v130, v130
    v_exp_f32 v131, v131
    v_mfma_f32_32x32x8_bf16 v[96:111], a[196:197], a[154:155], v[96:111]
    v_exp_f32 v132, v132
    v_exp_f32 v133, v133
    v_exp_f32 v134, v134
    v_exp_f32 v135, v135
    v_smfmac_f32_32x32x32_bf16 v[176:191], a[216:219], v[120:127], v150
    v_exp_f32 v136, v136
    v_exp_f32 v137, v137
    v_exp_f32 v138, v138
    v_exp_f32 v139, v139
    v_smfmac_f32_32x32x32_bf16 a[0:15], a[204:207], v[128:135], v150
    v_exp_f32 v140, v140
    v_exp_f32 v141, v141
    v_exp_f32 v142, v142
    v_exp_f32 v143, v143
    v_mfma_f32_32x32x16_bf16 v[112:127], a[192:195], a[156:159], 0
    buffer_load_dword v151, v11, s[8:11], s72 offen offset:36
    v_exp_f32 v96, v96
    v_exp_f32 v97, v97
    v_exp_f32 v98, v98
    v_exp_f32 v99, v99
    v_mfma_f32_32x32x8_bf16 v[112:127], a[196:197], a[160:161], v[112:127]
    v_exp_f32 v100, v100
    v_exp_f32 v101, v101
    v_exp_f32 v102, v102
    v_exp_f32 v103, v103
    v_smfmac_f32_32x32x32_bf16 a[0:15], a[208:211], v[136:143], v150
    v_exp_f32 v104, v104
    v_exp_f32 v105, v105
    v_exp_f32 v106, v106
    v_exp_f32 v107, v107
    v_smfmac_f32_32x32x32_bf16 a[16:31], a[204:207], v[96:103], v150
    v_exp_f32 v108, v108
    v_exp_f32 v109, v109
    v_exp_f32 v110, v110
    v_exp_f32 v111, v111
    v_mfma_f32_32x32x16_bf16 v[128:143], a[192:195], a[162:165], 0
    buffer_store_dword v14, off, s[44:47], s72
    v_exp_f32 v112, v112
    v_exp_f32 v113, v113
    v_exp_f32 v114, v114
    v_exp_f32 v115, v115
    v_mfma_f32_32x32x8_bf16 v[128:143], a[196:197], a[166:167], v[128:143]
    v_exp_f32 v116, v116
    v_exp_f32 v117, v117
    v_exp_f32 v118, v118
    v_exp_f32 v119, v119
    v_smfmac_f32_32x32x32_bf16 a[16:31], a[208:211], v[104:111], v150
    v_exp_f32 v120, v120
    v_exp_f32 v121, v121
    v_exp_f32 v122, v122
    v_exp_f32 v123, v123
    v_smfmac_f32_32x32x32_bf16 a[32:47], a[204:207], v[112:119], v150
    v_exp_f32 v124, v124
    v_exp_f32 v125, v125
    v_exp_f32 v126, v126
    v_exp_f32 v127, v127
    v_mfma_f32_32x32x16_bf16 v[96:111], a[192:195], a[168:171], 0
    ds_read_b64_tr_b16 a[212:213], v148 offset:0
    ds_read_b64_tr_b16 a[214:215], v148 offset:64
    ds_read_b64_tr_b16 a[216:217], v148 offset:256
    ds_read_b64_tr_b16 a[218:219], v148 offset:320
    v_exp_f32 v128, v128
    v_exp_f32 v129, v129
    v_exp_f32 v130, v130
    v_exp_f32 v131, v131
    v_mfma_f32_32x32x8_bf16 v[96:111], a[196:197], a[172:173], v[96:111]
    v_exp_f32 v132, v132
    v_exp_f32 v133, v133
    v_exp_f32 v134, v134
    v_exp_f32 v135, v135
    v_smfmac_f32_32x32x32_bf16 a[32:47], a[208:211], v[120:127], v150
    v_exp_f32 v136, v136
    v_exp_f32 v137, v137
    v_exp_f32 v138, v138
    v_exp_f32 v139, v139
    v_smfmac_f32_32x32x32_bf16 a[48:63], a[204:207], v[128:135], v150
    v_exp_f32 v140, v140
    v_exp_f32 v141, v141
    v_exp_f32 v142, v142
    v_exp_f32 v143, v143
    v_mfma_f32_32x32x16_bf16 v[112:127], a[192:195], a[174:177], 0
    s_waitcnt lgkmcnt(0)
    v_exp_f32 v96, v96
    v_exp_f32 v97, v97
    v_exp_f32 v98, v98
    v_exp_f32 v99, v99
    v_mfma_f32_32x32x8_bf16 v[112:127], a[196:197], a[178:179], v[112:127]
    v_exp_f32 v100, v100
    v_exp_f32 v101, v101
    v_exp_f32 v102, v102
    v_exp_f32 v103, v103
    v_smfmac_f32_32x32x32_bf16 a[48:63], a[208:211], v[136:143], v150
    v_exp_f32 v104, v104
    v_exp_f32 v105, v105
    v_exp_f32 v106, v106
    v_exp_f32 v107, v107
    v_smfmac_f32_32x32x32_bf16 a[64:79], a[204:207], v[96:103], v150
    s_add_u32 m0, s48, 37888
    v_exp_f32 v108, v108
    v_exp_f32 v109, v109
    v_exp_f32 v110, v110
    v_exp_f32 v111, v111
    v_mfma_f32_32x32x16_bf16 v[128:143], a[192:195], a[180:183], 0
    global_load_lds_dwordx4 v146, s[16:17] offset:0 sc1
    global_load_lds_dwordx4 v146, s[16:17] offset:1024 sc1
    v_exp_f32 v112, v112
    v_exp_f32 v113, v113
    v_exp_f32 v114, v114
    v_exp_f32 v115, v115
    v_mfma_f32_32x32x8_bf16 v[128:143], a[196:197], a[184:185], v[128:143]
    v_exp_f32 v116, v116
    v_exp_f32 v117, v117
    v_exp_f32 v118, v118
    v_exp_f32 v119, v119
    v_smfmac_f32_32x32x32_bf16 a[64:79], a[208:211], v[104:111], v150
    v_exp_f32 v120, v120
    v_exp_f32 v121, v121
    v_exp_f32 v122, v122
    v_exp_f32 v123, v123
    v_smfmac_f32_32x32x32_bf16 a[80:95], a[204:207], v[112:119], v150
    v_exp_f32 v124, v124
    v_exp_f32 v125, v125
    v_exp_f32 v126, v126
    v_exp_f32 v127, v127
    v_mfma_f32_32x32x16_bf16 v[96:111], a[192:195], a[186:189], 0
    v_exp_f32 v128, v128
    v_exp_f32 v129, v129
    v_exp_f32 v130, v130
    v_exp_f32 v131, v131
    v_mfma_f32_32x32x8_bf16 v[96:111], a[196:197], a[190:191], v[96:111]
    v_exp_f32 v132, v132
    v_exp_f32 v133, v133
    v_exp_f32 v134, v134
    v_exp_f32 v135, v135
    v_smfmac_f32_32x32x32_bf16 a[80:95], a[208:211], v[120:127], v150
    v_exp_f32 v136, v136
    v_exp_f32 v137, v137
    v_exp_f32 v138, v138
    v_exp_f32 v139, v139
    v_smfmac_f32_32x32x32_bf16 v[160:175], a[204:207], v[128:135], v150
    s_waitcnt vmcnt(4)
    global_load_dwordx4 a[192:195], v144, s[16:17] offset:0 sc1
    global_load_dwordx2 a[196:197], v145, s[16:17] offset:0 sc1
    v_exp_f32 v140, v140
    v_exp_f32 v141, v141
    v_exp_f32 v142, v142
    v_exp_f32 v143, v143
    v_mfma_f32_32x32x16_bf16 v[112:127], a[198:201], a[144:147], 0
    s_add_u32 s16, s16, 123904
    s_addc_u32 s17, s17, 0
    v_exp_f32 v96, v96
    v_exp_f32 v97, v97
    v_exp_f32 v98, v98
    v_exp_f32 v99, v99
    v_mfma_f32_32x32x8_bf16 v[112:127], a[202:203], a[148:149], v[112:127]
    v_exp_f32 v100, v100
    v_exp_f32 v101, v101
    v_exp_f32 v102, v102
    v_exp_f32 v103, v103
    v_smfmac_f32_32x32x32_bf16 v[160:175], a[208:211], v[136:143], v150
    v_exp_f32 v104, v104
    v_exp_f32 v105, v105
    v_exp_f32 v106, v106
    v_exp_f32 v107, v107
    v_smfmac_f32_32x32x32_bf16 v[176:191], a[204:207], v[96:103], v150
    v_exp_f32 v108, v108
    v_exp_f32 v109, v109
    v_exp_f32 v110, v110
    v_exp_f32 v111, v111
    v_mfma_f32_32x32x16_bf16 v[128:143], a[198:201], a[150:153], 0
    v_exp_f32 v112, v112
    v_exp_f32 v113, v113
    v_exp_f32 v114, v114
    v_exp_f32 v115, v115
    v_mfma_f32_32x32x8_bf16 v[128:143], a[202:203], a[154:155], v[128:143]
    v_exp_f32 v116, v116
    v_exp_f32 v117, v117
    v_exp_f32 v118, v118
    v_exp_f32 v119, v119
    v_smfmac_f32_32x32x32_bf16 v[176:191], a[208:211], v[104:111], v150
    v_exp_f32 v120, v120
    v_exp_f32 v121, v121
    v_exp_f32 v122, v122
    v_exp_f32 v123, v123
    v_smfmac_f32_32x32x32_bf16 a[0:15], a[212:215], v[112:119], v150
    v_exp_f32 v124, v124
    v_exp_f32 v125, v125
    v_exp_f32 v126, v126
    v_exp_f32 v127, v127
    v_mfma_f32_32x32x16_bf16 v[96:111], a[198:201], a[156:159], 0
    v_exp_f32 v128, v128
    v_exp_f32 v129, v129
    v_exp_f32 v130, v130
    v_exp_f32 v131, v131
    v_mfma_f32_32x32x8_bf16 v[96:111], a[202:203], a[160:161], v[96:111]
    v_exp_f32 v132, v132
    v_exp_f32 v133, v133
    v_exp_f32 v134, v134
    v_exp_f32 v135, v135
    v_smfmac_f32_32x32x32_bf16 a[0:15], a[216:219], v[120:127], v150
    v_exp_f32 v136, v136
    v_exp_f32 v137, v137
    v_exp_f32 v138, v138
    v_exp_f32 v139, v139
    v_smfmac_f32_32x32x32_bf16 a[16:31], a[212:215], v[128:135], v150
    v_exp_f32 v140, v140
    v_exp_f32 v141, v141
    v_exp_f32 v142, v142
    v_exp_f32 v143, v143
    v_mfma_f32_32x32x16_bf16 v[112:127], a[198:201], a[162:165], 0
    v_exp_f32 v96, v96
    v_exp_f32 v97, v97
    v_exp_f32 v98, v98
    v_exp_f32 v99, v99
    v_mfma_f32_32x32x8_bf16 v[112:127], a[202:203], a[166:167], v[112:127]
    v_exp_f32 v100, v100
    v_exp_f32 v101, v101
    v_exp_f32 v102, v102
    v_exp_f32 v103, v103
    v_smfmac_f32_32x32x32_bf16 a[16:31], a[216:219], v[136:143], v150
    buffer_load_dword v157, v156, s[40:43], 0 offen offset:0 sc1
    v_exp_f32 v104, v104
    v_exp_f32 v105, v105
    v_exp_f32 v106, v106
    v_exp_f32 v107, v107
    v_smfmac_f32_32x32x32_bf16 a[32:47], a[212:215], v[96:103], v150
    v_exp_f32 v108, v108
    v_exp_f32 v109, v109
    v_exp_f32 v110, v110
    v_exp_f32 v111, v111
    v_mfma_f32_32x32x16_bf16 v[128:143], a[198:201], a[168:171], 0
    ds_read_b64_tr_b16 a[204:205], v147 offset:0
    ds_read_b64_tr_b16 a[206:207], v147 offset:64
    ds_read_b64_tr_b16 a[208:209], v147 offset:256
    ds_read_b64_tr_b16 a[210:211], v147 offset:320
    v_exp_f32 v112, v112
    v_exp_f32 v113, v113
    v_exp_f32 v114, v114
    v_exp_f32 v115, v115
    v_mfma_f32_32x32x8_bf16 v[128:143], a[202:203], a[172:173], v[128:143]
    v_exp_f32 v116, v116
    v_exp_f32 v117, v117
    v_exp_f32 v118, v118
    v_exp_f32 v119, v119
    v_smfmac_f32_32x32x32_bf16 a[32:47], a[216:219], v[104:111], v150
    v_exp_f32 v120, v120
    v_exp_f32 v121, v121
    v_exp_f32 v122, v122
    v_exp_f32 v123, v123
    v_smfmac_f32_32x32x32_bf16 a[48:63], a[212:215], v[112:119], v150
    v_exp_f32 v124, v124
    v_exp_f32 v125, v125
    v_exp_f32 v126, v126
    v_exp_f32 v127, v127
    v_mfma_f32_32x32x16_bf16 v[96:111], a[198:201], a[174:177], 0
    s_waitcnt lgkmcnt(0)
    v_exp_f32 v128, v128
    v_exp_f32 v129, v129
    v_exp_f32 v130, v130
    v_exp_f32 v131, v131
    v_mfma_f32_32x32x8_bf16 v[96:111], a[202:203], a[178:179], v[96:111]
    v_exp_f32 v132, v132
    v_exp_f32 v133, v133
    v_exp_f32 v134, v134
    v_exp_f32 v135, v135
    v_smfmac_f32_32x32x32_bf16 a[48:63], a[216:219], v[120:127], v150
    v_exp_f32 v136, v136
    v_exp_f32 v137, v137
    v_exp_f32 v138, v138
    v_exp_f32 v139, v139
    v_smfmac_f32_32x32x32_bf16 a[64:79], a[212:215], v[128:135], v150
    s_add_u32 m0, s48, 35840
    v_exp_f32 v140, v140
    v_exp_f32 v141, v141
    v_exp_f32 v142, v142
    v_exp_f32 v143, v143
    v_mfma_f32_32x32x16_bf16 v[112:127], a[198:201], a[180:183], 0
    global_load_lds_dwordx4 v146, s[16:17] offset:0 sc1
    global_load_lds_dwordx4 v146, s[16:17] offset:1024 sc1
    v_exp_f32 v96, v96
    v_exp_f32 v97, v97
    v_exp_f32 v98, v98
    v_exp_f32 v99, v99
    v_mfma_f32_32x32x8_bf16 v[112:127], a[202:203], a[184:185], v[112:127]
    v_exp_f32 v100, v100
    v_exp_f32 v101, v101
    v_exp_f32 v102, v102
    v_exp_f32 v103, v103
    v_smfmac_f32_32x32x32_bf16 a[64:79], a[216:219], v[136:143], v150
    s_waitcnt vmcnt(2)
    v_bfe_u32 v157, v157, 8, 8
    v_cmp_gt_u32 vcc, 4, v157
    s_cbranch_vccnz L_ps5
L_pd5:
    v_exp_f32 v104, v104
    v_exp_f32 v105, v105
    v_exp_f32 v106, v106
    v_exp_f32 v107, v107
    v_smfmac_f32_32x32x32_bf16 a[80:95], a[212:215], v[96:103], v150
    v_exp_f32 v108, v108
    v_exp_f32 v109, v109
    v_exp_f32 v110, v110
    v_exp_f32 v111, v111
    v_mfma_f32_32x32x16_bf16 v[128:143], a[198:201], a[186:189], 0
    global_load_dwordx4 v[68:71], v2, s[18:19] offset:-4096 sc1
    v_exp_f32 v112, v112
    v_exp_f32 v113, v113
    v_exp_f32 v114, v114
    v_exp_f32 v115, v115
    v_mfma_f32_32x32x8_bf16 v[128:143], a[202:203], a[190:191], v[128:143]
    v_exp_f32 v116, v116
    v_exp_f32 v117, v117
    v_exp_f32 v118, v118
    v_exp_f32 v119, v119
    v_smfmac_f32_32x32x32_bf16 a[80:95], a[216:219], v[104:111], v150
    global_load_dwordx4 v[72:75], v3, s[18:19] offset:-4096 sc1
    v_exp_f32 v120, v120
    v_exp_f32 v121, v121
    v_exp_f32 v122, v122
    v_exp_f32 v123, v123
    v_smfmac_f32_32x32x32_bf16 v[160:175], a[212:215], v[112:119], v150
    global_load_dwordx4 a[198:201], v144, s[16:17] offset:0 sc1
    global_load_dwordx2 a[202:203], v145, s[16:17] offset:0 sc1
    v_exp_f32 v124, v124
    v_exp_f32 v125, v125
    v_exp_f32 v126, v126
    v_exp_f32 v127, v127
    v_mfma_f32_32x32x16_bf16 v[96:111], a[192:195], a[144:147], 0
    s_add_u32 s16, s16, 123904
    s_addc_u32 s17, s17, 0
    v_exp_f32 v128, v128
    v_exp_f32 v129, v129
    v_exp_f32 v130, v130
    v_exp_f32 v131, v131
    v_mfma_f32_32x32x8_bf16 v[96:111], a[196:197], a[148:149], v[96:111]
    v_exp_f32 v132, v132
    v_exp_f32 v133, v133
    v_exp_f32 v134, v134
    v_exp_f32 v135, v135
    v_smfmac_f32_32x32x32_bf16 v[160:175], a[216:219], v[120:127], v150
    global_load_dwordx4 v[76:79], v4, s[18:19] offset:-4096 sc1
    v_exp_f32 v136, v136
    v_exp_f32 v137, v137
    v_exp_f32 v138, v138
    v_exp_f32 v139, v139
    v_smfmac_f32_32x32x32_bf16 v[176:191], a[212:215], v[128:135], v150
    global_load_dwordx4 v[80:83], v1, s[20:21] offset:-4096 sc1
    v_exp_f32 v140, v140
    v_exp_f32 v141, v141
    v_exp_f32 v142, v142
    v_exp_f32 v143, v143
    v_mfma_f32_32x32x16_bf16 v[112:127], a[192:195], a[150:153], 0
    global_load_dwordx4 v[84:87], v1, s[20:21] offset:-3072 sc1
    v_exp_f32 v96, v96
    v_exp_f32 v97, v97
    v_exp_f32 v98, v98
    v_exp_f32 v99, v99
    v_mfma_f32_32x32x8_bf16 v[112:127], a[196:197], a[154:155], v[112:127]
    v_exp_f32 v100, v100
    v_exp_f32 v101, v101
    v_exp_f32 v102, v102
    v_exp_f32 v103, v103
    v_smfmac_f32_32x32x32_bf16 v[176:191], a[216:219], v[136:143], v150
    global_load_dwordx4 v[88:91], v1, s[20:21] offset:-2048 sc1
    v_exp_f32 v104, v104
    v_exp_f32 v105, v105
    v_exp_f32 v106, v106
    v_exp_f32 v107, v107
    v_smfmac_f32_32x32x32_bf16 a[0:15], a[204:207], v[96:103], v150
    v_exp_f32 v108, v108
    v_exp_f32 v109, v109
    v_exp_f32 v110, v110
    v_exp_f32 v111, v111
    v_mfma_f32_32x32x16_bf16 v[128:143], a[192:195], a[156:159], 0
L_pad10:
    s_cbranch_execz L_back
    global_load_dwordx4 v[92:95], v1, s[20:21] offset:-1024 sc1
    v_exp_f32 v112, v112
    v_exp_f32 v113, v113
    v_exp_f32 v114, v114
    v_exp_f32 v115, v115
    v_mfma_f32_32x32x8_bf16 v[128:143], a[196:197], a[160:161], v[128:143]
    v_exp_f32 v116, v116
    v_exp_f32 v117, v117
    v_exp_f32 v118, v118
    v_exp_f32 v119, v119
    v_smfmac_f32_32x32x32_bf16 a[0:15], a[208:211], v[104:111], v150
    global_load_dwordx4 v[16:19], v1, s[20:21] offset:0 sc1
    v_exp_f32 v120, v120
    v_exp_f32 v121, v121
    v_exp_f32 v122, v122
    v_exp_f32 v123, v123
    v_smfmac_f32_32x32x32_bf16 a[16:31], a[204:207], v[112:119], v150
    v_exp_f32 v124, v124
    v_exp_f32 v125, v125
    v_exp_f32 v126, v126
    v_exp_f32 v127, v127
    v_mfma_f32_32x32x16_bf16 v[96:111], a[192:195], a[162:165], 0
    global_load_dwordx4 v[20:23], v5, s[18:19] offset:-4096 sc1
    v_exp_f32 v128, v128
    v_exp_f32 v129, v129
    v_exp_f32 v130, v130
    v_exp_f32 v131, v131
    v_mfma_f32_32x32x8_bf16 v[96:111], a[196:197], a[166:167], v[96:111]
    v_exp_f32 v132, v132
    v_exp_f32 v133, v133
    v_exp_f32 v134, v134
    v_exp_f32 v135, v135
    v_smfmac_f32_32x32x32_bf16 a[16:31], a[208:211], v[120:127], v150
    v_exp_f32 v136, v136
    v_exp_f32 v137, v137
    v_exp_f32 v138, v138
    v_exp_f32 v139, v139
    v_smfmac_f32_32x32x32_bf16 a[32:47], a[204:207], v[128:135], v150
    v_exp_f32 v140, v140
    v_exp_f32 v141, v141
    v_exp_f32 v142, v142
    v_exp_f32 v143, v143
    v_mfma_f32_32x32x16_bf16 v[112:127], a[192:195], a[168:171], 0
    ds_read_b64_tr_b16 a[212:213], v148 offset:0
    ds_read_b64_tr_b16 a[214:215], v148 offset:64
    ds_read_b64_tr_b16 a[216:217], v148 offset:256
    ds_read_b64_tr_b16 a[218:219], v148 offset:320
    v_exp_f32 v96, v96
    v_exp_f32 v97, v97
    v_exp_f32 v98, v98
    v_exp_f32 v99, v99
    v_mfma_f32_32x32x8_bf16 v[112:127], a[196:197], a[172:173], v[112:127]
    v_exp_f32 v100, v100
    v_exp_f32 v101, v101
    v_exp_f32 v102, v102
    v_exp_f32 v103, v103
    v_smfmac_f32_32x32x32_bf16 a[32:47], a[208:211], v[136:143], v150
    global_load_dwordx4 v[24:27], v2, s[18:19] offset:-2048 sc1
    v_exp_f32 v104, v104
    v_exp_f32 v105, v105
    v_exp_f32 v106, v106
    v_exp_f32 v107, v107
    v_smfmac_f32_32x32x32_bf16 a[48:63], a[204:207], v[96:103], v150
    v_exp_f32 v108, v108
    v_exp_f32 v109, v109
    v_exp_f32 v110, v110
    v_exp_f32 v111, v111
    v_mfma_f32_32x32x16_bf16 v[128:143], a[192:195], a[174:177], 0
    s_waitcnt lgkmcnt(0)
    global_load_dwordx4 v[28:31], v3, s[18:19] offset:-2048 sc1
    v_exp_f32 v112, v112
    v_exp_f32 v113, v113
    v_exp_f32 v114, v114
    v_exp_f32 v115, v115
    v_mfma_f32_32x32x8_bf16 v[128:143], a[196:197], a[178:179], v[128:143]
    v_exp_f32 v116, v116
    v_exp_f32 v117, v117
    v_exp_f32 v118, v118
    v_exp_f32 v119, v119
    v_smfmac_f32_32x32x32_bf16 a[48:63], a[208:211], v[104:111], v150
    global_load_dwordx4 v[32:35], v4, s[18:19] offset:-2048 sc1
    v_exp_f32 v120, v120
    v_exp_f32 v121, v121
    v_exp_f32 v122, v122
    v_exp_f32 v123, v123
    v_smfmac_f32_32x32x32_bf16 a[64:79], a[204:207], v[112:119], v150
    s_add_u32 m0, s48, 37888
    v_exp_f32 v124, v124
    v_exp_f32 v125, v125
    v_exp_f32 v126, v126
    v_exp_f32 v127, v127
    v_mfma_f32_32x32x16_bf16 v[96:111], a[192:195], a[180:183], 0
    global_load_lds_dwordx4 v146, s[16:17] offset:0 sc1
    global_load_lds_dwordx4 v146, s[16:17] offset:1024 sc1
    v_exp_f32 v128, v128
    v_exp_f32 v129, v129
    v_exp_f32 v130, v130
    v_exp_f32 v131, v131
    v_mfma_f32_32x32x8_bf16 v[96:111], a[196:197], a[184:185], v[96:111]
    v_exp_f32 v132, v132
    v_exp_f32 v133, v133
    v_exp_f32 v134, v134
    v_exp_f32 v135, v135
    v_smfmac_f32_32x32x32_bf16 a[64:79], a[208:211], v[120:127], v150
    global_load_dwordx4 v[36:39], v1, s[20:21] offset:1024 sc1
    v_exp_f32 v136, v136
    v_exp_f32 v137, v137
    v_exp_f32 v138, v138
    v_exp_f32 v139, v139
    v_smfmac_f32_32x32x32_bf16 a[80:95], a[204:207], v[128:135], v150
    v_exp_f32 v140, v140
    v_exp_f32 v141, v141
    v_exp_f32 v142, v142
    v_exp_f32 v143, v143
    v_mfma_f32_32x32x16_bf16 v[112:127], a[192:195], a[186:189], 0
    global_load_dwordx4 v[40:43], v1, s[20:21] offset:2048 sc1
    v_exp_f32 v96, v96
    v_exp_f32 v97, v97
    v_exp_f32 v98, v98
    v_exp_f32 v99, v99
    v_mfma_f32_32x32x8_bf16 v[112:127], a[196:197], a[190:191], v[112:127]
    v_exp_f32 v100, v100
    v_exp_f32 v101, v101
    v_exp_f32 v102, v102
    v_exp_f32 v103, v103
    v_smfmac_f32_32x32x32_bf16 a[80:95], a[208:211], v[136:143], v150
    global_load_dwordx4 v[44:47], v1, s[20:21] offset:3072 sc1
    v_exp_f32 v104, v104
    v_exp_f32 v105, v105
    v_exp_f32 v106, v106
    v_exp_f32 v107, v107
    v_smfmac_f32_32x32x32_bf16 v[160:175], a[204:207], v[96:103], v150
    s_waitcnt vmcnt(15)
    global_load_dwordx4 a[192:195], v144, s[16:17] offset:0 sc1
    global_load_dwordx2 a[196:197], v145, s[16:17] offset:0 sc1
    v_exp_f32 v108, v108
    v_exp_f32 v109, v109
    v_exp_f32 v110, v110
    v_exp_f32 v111, v111
    v_mfma_f32_32x32x16_bf16 v[128:143], a[198:201], a[144:147], 0
    s_add_u32 s16, s16, 123904
    s_addc_u32 s17, s17, 0
    v_exp_f32 v112, v112
    v_exp_f32 v113, v113
    v_exp_f32 v114, v114
    v_exp_f32 v115, v115
    v_mfma_f32_32x32x8_bf16 v[128:143], a[202:203], a[148:149], v[128:143]
    v_exp_f32 v116, v116
    v_exp_f32 v117, v117
    v_exp_f32 v118, v118
    v_exp_f32 v119, v119
    v_smfmac_f32_32x32x32_bf16 v[160:175], a[208:211], v[104:111], v150
    s_add_u32 s20, s20, 8192
    s_addc_u32 s21, s21, 0
    global_load_dwordx4 v[192:195], v1, s[20:21] offset:-4096 sc1
    v_exp_f32 v120, v120
    v_exp_f32 v121, v121
    v_exp_f32 v122, v122
    v_exp_f32 v123, v123
    v_smfmac_f32_32x32x32_bf16 v[176:191], a[204:207], v[112:119], v150
    v_exp_f32 v124, v124
    v_exp_f32 v125, v125
    v_exp_f32 v126, v126
    v_exp_f32 v127, v127
    v_mfma_f32_32x32x16_bf16 v[96:111], a[198:201], a[150:153], 0
    global_load_dwordx4 v[196:199], v1, s[20:21] offset:-3072 sc1
    v_exp_f32 v128, v128
    v_exp_f32 v129, v129
    v_exp_f32 v130, v130
    v_exp_f32 v131, v131
    v_mfma_f32_32x32x8_bf16 v[96:111], a[202:203], a[154:155], v[96:111]
    v_exp_f32 v132, v132
    v_exp_f32 v133, v133
    v_exp_f32 v134, v134
    v_exp_f32 v135, v135
    v_smfmac_f32_32x32x32_bf16 v[176:191], a[208:211], v[120:127], v150
    global_load_dwordx4 v[200:203], v5, s[18:19] offset:-2048 sc1
    v_exp_f32 v136, v136
    v_exp_f32 v137, v137
    v_exp_f32 v138, v138
    v_exp_f32 v139, v139
    v_smfmac_f32_32x32x32_bf16 a[0:15], a[212:215], v[128:135], v150
    v_exp_f32 v140, v140
    v_exp_f32 v141, v141
    v_exp_f32 v142, v142
    v_exp_f32 v143, v143
    v_mfma_f32_32x32x16_bf16 v[112:127], a[198:201], a[156:159], 0
    global_load_dwordx4 v[204:207], v2, s[18:19] offset:0 sc1
    v_exp_f32 v96, v96
    v_exp_f32 v97, v97
    v_exp_f32 v98, v98
    v_exp_f32 v99, v99
    v_mfma_f32_32x32x8_bf16 v[112:127], a[202:203], a[160:161], v[112:127]
    v_exp_f32 v100, v100
    v_exp_f32 v101, v101
    v_exp_f32 v102, v102
    v_exp_f32 v103, v103
    v_smfmac_f32_32x32x32_bf16 a[0:15], a[216:219], v[136:143], v150
    global_load_dwordx4 v[208:211], v3, s[18:19] offset:0 sc1
    v_exp_f32 v104, v104
    v_exp_f32 v105, v105
    v_exp_f32 v106, v106
    v_exp_f32 v107, v107
    v_smfmac_f32_32x32x32_bf16 a[16:31], a[212:215], v[96:103], v150
    v_exp_f32 v108, v108
    v_exp_f32 v109, v109
    v_exp_f32 v110, v110
    v_exp_f32 v111, v111
    v_mfma_f32_32x32x16_bf16 v[128:143], a[198:201], a[162:165], 0
    global_load_dwordx4 v[212:215], v4, s[18:19] offset:0 sc1
    v_exp_f32 v112, v112
    v_exp_f32 v113, v113
    v_exp_f32 v114, v114
    v_exp_f32 v115, v115
    v_mfma_f32_32x32x8_bf16 v[128:143], a[202:203], a[166:167], v[128:143]
    v_exp_f32 v116, v116
    v_exp_f32 v117, v117
    v_exp_f32 v118, v118
    v_exp_f32 v119, v119
    v_smfmac_f32_32x32x32_bf16 a[16:31], a[216:219], v[104:111], v150
    s_waitcnt vmcnt(16)
    v_exp_f32 v120, v120
    v_exp_f32 v121, v121
    v_exp_f32 v122, v122
    v_mfma_f32_16x16x32_bf16 a[96:99], v[80:83], v[68:71], 0
    v_exp_f32 v123, v123
    v_smfmac_f32_32x32x32_bf16 a[32:47], a[212:215], v[112:119], v150
    v_exp_f32 v124, v124
    v_exp_f32 v125, v125
    v_exp_f32 v126, v126
    v_mfma_f32_16x16x32_bf16 a[100:103], v[84:87], v[68:71], 0
    v_exp_f32 v127, v127
    v_mfma_f32_32x32x16_bf16 v[96:111], a[198:201], a[168:171], 0
    ds_read_b64_tr_b16 a[204:205], v147 offset:0
    ds_read_b64_tr_b16 a[206:207], v147 offset:64
    ds_read_b64_tr_b16 a[208:209], v147 offset:256
    ds_read_b64_tr_b16 a[210:211], v147 offset:320
    v_exp_f32 v128, v128
    v_exp_f32 v129, v129
    v_exp_f32 v130, v130
    v_mfma_f32_16x16x32_bf16 a[104:107], v[88:91], v[68:71], 0
    global_load_dwordx4 v[216:219], v1, s[20:21] offset:-2048 sc1
    v_exp_f32 v131, v131
    v_mfma_f32_32x32x8_bf16 v[96:111], a[202:203], a[172:173], v[96:111]
    v_exp_f32 v132, v132
    v_exp_f32 v133, v133
    v_exp_f32 v134, v134
    v_exp_f32 v135, v135
    v_smfmac_f32_32x32x32_bf16 a[32:47], a[216:219], v[120:127], v150
    global_load_dwordx4 v[220:223], v1, s[20:21] offset:-1024 sc1
    v_exp_f32 v136, v136
    v_exp_f32 v137, v137
    v_exp_f32 v138, v138
    v_mfma_f32_16x16x32_bf16 a[108:111], v[92:95], v[68:71], 0
    v_exp_f32 v139, v139
    v_smfmac_f32_32x32x32_bf16 a[48:63], a[212:215], v[128:135], v150
    v_exp_f32 v140, v140
    v_exp_f32 v141, v141
    v_exp_f32 v142, v142
    v_mfma_f32_16x16x32_bf16 a[112:115], v[16:19], v[68:71], 0
    v_exp_f32 v143, v143
    v_mfma_f32_32x32x16_bf16 v[112:127], a[198:201], a[174:177], 0
    s_waitcnt lgkmcnt(0)
    global_load_dwordx4 v[224:227], v1, s[20:21] offset:0 sc1
    v_exp_f32 v96, v96
    v_exp_f32 v97, v97
    v_exp_f32 v98, v98
    v_mfma_f32_16x16x32_bf16 a[116:119], v[80:83], v[72:75], 0
    v_exp_f32 v99, v99
    v_mfma_f32_32x32x8_bf16 v[112:127], a[202:203], a[178:179], v[112:127]
    v_exp_f32 v100, v100
    v_exp_f32 v101, v101
    v_exp_f32 v102, v102
    v_exp_f32 v103, v103
    v_smfmac_f32_32x32x32_bf16 a[48:63], a[216:219], v[136:143], v150
    v_exp_f32 v104, v104
    v_exp_f32 v105, v105
    v_exp_f32 v106, v106
    v_mfma_f32_16x16x32_bf16 a[120:123], v[84:87], v[72:75], 0
    v_exp_f32 v107, v107
    v_smfmac_f32_32x32x32_bf16 a[64:79], a[212:215], v[96:103], v150
    s_add_u32 m0, s48, 35840
    v_exp_f32 v108, v108
    v_exp_f32 v109, v109
    v_exp_f32 v110, v110
    v_mfma_f32_16x16x32_bf16 a[124:127], v[88:91], v[72:75], 0
    v_exp_f32 v111, v111
    v_mfma_f32_32x32x16_bf16 v[128:143], a[198:201], a[180:183], 0
    global_load_lds_dwordx4 v146, s[16:17] offset:0 sc1
    global_load_lds_dwordx4 v146, s[16:17] offset:1024 sc1
    v_exp_f32 v112, v112
    v_exp_f32 v113, v113
    v_exp_f32 v114, v114
    v_exp_f32 v115, v115
    v_mfma_f32_32x32x8_bf16 v[128:143], a[202:203], a[184:185], v[128:143]
    v_exp_f32 v116, v116
    v_exp_f32 v117, v117
    v_exp_f32 v118, v118
    v_exp_f32 v119, v119
    v_smfmac_f32_32x32x32_bf16 a[64:79], a[216:219], v[104:111], v150
    global_load_dwordx4 v[228:231], v1, s[20:21] offset:1024 sc1
    v_exp_f32 v120, v120
    v_exp_f32 v121, v121
    v_exp_f32 v122, v122
    v_mfma_f32_16x16x32_bf16 a[128:131], v[92:95], v[72:75], 0
    global_load_dwordx4 v[232:235], v1, s[20:21] offset:2048 sc1
    v_exp_f32 v123, v123
    v_smfmac_f32_32x32x32_bf16 a[80:95], a[212:215], v[112:119], v150
    v_exp_f32 v124, v124
    v_exp_f32 v125, v125
    v_exp_f32 v126, v126
    v_mfma_f32_16x16x32_bf16 a[132:135], v[16:19], v[72:75], 0
    v_exp_f32 v127, v127
    v_mfma_f32_32x32x16_bf16 v[96:111], a[198:201], a[186:189], 0
    global_load_dwordx4 v[236:239], v5, s[18:19] offset:0 sc1
    v_exp_f32 v128, v128
    v_exp_f32 v129, v129
    v_exp_f32 v130, v130
    v_mfma_f32_16x16x32_bf16 a[136:139], v[80:83], v[76:79], 0
    global_load_dwordx4 v[240:243], v2, s[18:19] offset:2048 sc1
    v_exp_f32 v131, v131
    v_mfma_f32_32x32x8_bf16 v[96:111], a[202:203], a[190:191], v[96:111]
    v_exp_f32 v132, v132
    v_exp_f32 v133, v133
    v_exp_f32 v134, v134
    v_exp_f32 v135, v135
    v_smfmac_f32_32x32x32_bf16 a[80:95], a[216:219], v[120:127], v150
    v_exp_f32 v136, v136
    v_exp_f32 v137, v137
    v_exp_f32 v138, v138
    v_mfma_f32_16x16x32_bf16 a[140:143], v[84:87], v[76:79], 0
    v_exp_f32 v139, v139
    v_smfmac_f32_32x32x32_bf16 v[160:175], a[212:215], v[128:135], v150
    s_waitcnt vmcnt(15)
    global_load_dwordx4 a[198:201], v144, s[16:17] offset:0 sc1
    global_load_dwordx2 a[202:203], v145, s[16:17] offset:0 sc1
    v_exp_f32 v140, v140
    v_exp_f32 v141, v141
    v_exp_f32 v142, v142
    v_mfma_f32_16x16x32_bf16 a[220:223], v[88:91], v[76:79], 0
    v_exp_f32 v143, v143
    v_mfma_f32_32x32x16_bf16 v[112:127], a[192:195], a[144:147], 0
    s_add_u32 s16, s16, 123904
    s_addc_u32 s17, s17, 0
    v_exp_f32 v96, v96
    v_exp_f32 v97, v97
    v_exp_f32 v98, v98
    v_mfma_f32_16x16x32_bf16 a[224:227], v[92:95], v[76:79], 0
    global_load_dwordx4 v[244:247], v3, s[18:19] offset:2048 sc1
    v_exp_f32 v99, v99
    v_mfma_f32_32x32x8_bf16 v[112:127], a[196:197], a[148:149], v[112:127]
    v_exp_f32 v100, v100
    v_exp_f32 v101, v101
    v_exp_f32 v102, v102
    v_exp_f32 v103, v103
    v_smfmac_f32_32x32x32_bf16 v[160:175], a[216:219], v[136:143], v150
    v_exp_f32 v104, v104
    v_exp_f32 v105, v105
    v_exp_f32 v106, v106
    v_mfma_f32_16x16x32_bf16 a[228:231], v[16:19], v[76:79], 0
    v_exp_f32 v107, v107
    v_smfmac_f32_32x32x32_bf16 v[176:191], a[212:215], v[96:103], v150
    v_exp_f32 v108, v108
    v_exp_f32 v109, v109
    v_exp_f32 v110, v110
    v_mfma_f32_16x16x32_bf16 v[48:51], v[80:83], v[20:23], 0
    v_exp_f32 v111, v111
    v_mfma_f32_32x32x16_bf16 v[128:143], a[192:195], a[150:153], 0
    global_load_dwordx4 v[248:251], v4, s[18:19] offset:2048 sc1
    v_exp_f32 v112, v112
    v_exp_f32 v113, v113
    v_exp_f32 v114, v114
    v_exp_f32 v115, v115
    v_mfma_f32_32x32x8_bf16 v[128:143], a[196:197], a[154:155], v[128:143]
    v_exp_f32 v116, v116
    v_exp_f32 v117, v117
    v_exp_f32 v118, v118
    v_exp_f32 v119, v119
    v_smfmac_f32_32x32x32_bf16 v[176:191], a[216:219], v[104:111], v150
    global_load_dwordx4 v[252:255], v1, s[20:21] offset:3072 sc1
    v_exp_f32 v120, v120
    v_exp_f32 v121, v121
    v_exp_f32 v122, v122
    v_mfma_f32_16x16x32_bf16 v[52:55], v[84:87], v[20:23], 0
    v_exp_f32 v123, v123
    v_smfmac_f32_32x32x32_bf16 a[0:15], a[204:207], v[112:119], v150
    v_exp_f32 v124, v124
    v_exp_f32 v125, v125
    v_exp_f32 v126, v126
    v_mfma_f32_16x16x32_bf16 v[56:59], v[88:91], v[20:23], 0
    v_exp_f32 v127, v127
    v_mfma_f32_32x32x16_bf16 v[96:111], a[192:195], a[156:159], 0
    s_add_u32 s20, s20, 8192
    s_addc_u32 s21, s21, 0
    global_load_dwordx4 a[232:235], v1, s[20:21] offset:-4096 sc1
    v_exp_f32 v128, v128
    v_exp_f32 v129, v129
    v_exp_f32 v130, v130
    v_mfma_f32_16x16x32_bf16 v[60:63], v[92:95], v[20:23], 0
    v_exp_f32 v131, v131
    v_mfma_f32_32x32x8_bf16 v[96:111], a[196:197], a[160:161], v[96:111]
    v_exp_f32 v132, v132
    v_exp_f32 v133, v133
    v_exp_f32 v134, v134
    v_exp_f32 v135, v135
    v_smfmac_f32_32x32x32_bf16 a[0:15], a[208:211], v[120:127], v150
    v_exp_f32 v136, v136
    v_exp_f32 v137, v137
    v_exp_f32 v138, v138
    v_mfma_f32_16x16x32_bf16 v[64:67], v[16:19], v[20:23], 0
    v_exp_f32 v139, v139
    v_smfmac_f32_32x32x32_bf16 a[16:31], a[204:207], v[128:135], v150
    s_waitcnt vmcnt(18)
    v_exp_f32 v140, v140
    v_exp_f32 v141, v141
    v_exp_f32 v142, v142
    v_mfma_f32_16x16x32_bf16 a[96:99], v[36:39], v[24:27], a[96:99]
    v_exp_f32 v143, v143
    v_mfma_f32_32x32x16_bf16 v[112:127], a[192:195], a[162:165], 0
    global_load_dwordx4 a[236:239], v1, s[20:21] offset:-3072 sc1
    v_exp_f32 v96, v96
    v_exp_f32 v97, v97
    v_exp_f32 v98, v98
    v_mfma_f32_16x16x32_bf16 a[100:103], v[40:43], v[24:27], a[100:103]
    global_load_dwordx4 a[240:243], v1, s[20:21] offset:-2048 sc1
    v_exp_f32 v99, v99
    v_mfma_f32_32x32x8_bf16 v[112:127], a[196:197], a[166:167], v[112:127]
    v_exp_f32 v100, v100
    v_exp_f32 v101, v101
    v_exp_f32 v102, v102
    v_exp_f32 v103, v103
    v_smfmac_f32_32x32x32_bf16 a[16:31], a[208:211], v[136:143], v150
    s_add_u32 m0, s48, 18432
    s_add_u32 s4, s71, 3072
    buffer_load_dwordx4 v1, s[12:15], s4 offen offset:0 sc1 lds
    v_exp_f32 v104, v104
    v_exp_f32 v105, v105
    v_exp_f32 v106, v106
    v_mfma_f32_16x16x32_bf16 a[104:107], v[44:47], v[24:27], a[104:107]
    v_exp_f32 v107, v107
    v_smfmac_f32_32x32x32_bf16 a[32:47], a[204:207], v[96:103], v150
    v_exp_f32 v108, v108
    v_exp_f32 v109, v109
    v_exp_f32 v110, v110
    v_mfma_f32_16x16x32_bf16 a[108:111], v[192:195], v[24:27], a[108:111]
    v_exp_f32 v111, v111
    v_mfma_f32_32x32x16_bf16 v[128:143], a[192:195], a[168:171], 0
    ds_read_b64_tr_b16 a[212:213], v148 offset:0
    ds_read_b64_tr_b16 a[214:215], v148 offset:64
    ds_read_b64_tr_b16 a[216:217], v148 offset:256
    ds_read_b64_tr_b16 a[218:219], v148 offset:320
    v_exp_f32 v112, v112
    v_exp_f32 v113, v113
    v_exp_f32 v114, v114
    v_exp_f32 v115, v115
    v_mfma_f32_32x32x8_bf16 v[128:143], a[196:197], a[172:173], v[128:143]
    v_exp_f32 v116, v116
    v_exp_f32 v117, v117
    v_exp_f32 v118, v118
    v_exp_f32 v119, v119
    v_smfmac_f32_32x32x32_bf16 a[32:47], a[208:211], v[104:111], v150
    global_load_dwordx4 a[244:247], v1, s[20:21] offset:-1024 sc1
    v_exp_f32 v120, v120
    v_exp_f32 v121, v121
    v_exp_f32 v122, v122
    v_mfma_f32_16x16x32_bf16 a[112:115], v[196:199], v[24:27], a[112:115]
    global_load_dwordx4 a[248:251], v5, s[18:19] offset:2048 sc1
    v_exp_f32 v123, v123
    v_smfmac_f32_32x32x32_bf16 a[48:63], a[204:207], v[112:119], v150
    v_exp_f32 v124, v124
    v_exp_f32 v125, v125
    v_exp_f32 v126, v126
    v_mfma_f32_16x16x32_bf16 a[116:119], v[36:39], v[28:31], a[116:119]
    v_exp_f32 v127, v127
    v_mfma_f32_32x32x16_bf16 v[96:111], a[192:195], a[174:177], 0
    s_waitcnt lgkmcnt(0)
    s_add_u32 s18, s18, 8192
    s_addc_u32 s19, s19, 0
    global_load_dwordx4 a[252:255], v2, s[18:19] offset:-4096 sc1
    v_exp_f32 v128, v128
    v_exp_f32 v129, v129
    v_exp_f32 v130, v130
    v_mfma_f32_16x16x32_bf16 a[120:123], v[40:43], v[28:31], a[120:123]
    v_exp_f32 v131, v131
    v_mfma_f32_32x32x8_bf16 v[96:111], a[196:197], a[178:179], v[96:111]
    v_exp_f32 v132, v132
    v_exp_f32 v133, v133
    v_exp_f32 v134, v134
    v_exp_f32 v135, v135
    v_smfmac_f32_32x32x32_bf16 a[48:63], a[208:211], v[120:127], v150
    v_exp_f32 v136, v136
    v_exp_f32 v137, v137
    v_exp_f32 v138, v138
    v_mfma_f32_16x16x32_bf16 a[124:127], v[44:47], v[28:31], a[124:127]
    v_exp_f32 v139, v139
    v_smfmac_f32_32x32x32_bf16 a[64:79], a[204:207], v[128:135], v150
    s_add_u32 m0, s48, 37888
    v_exp_f32 v140, v140
    v_exp_f32 v141, v141
    v_exp_f32 v142, v142
    v_mfma_f32_16x16x32_bf16 a[128:131], v[192:195], v[28:31], a[128:131]
    v_exp_f32 v143, v143
    v_mfma_f32_32x32x16_bf16 v[112:127], a[192:195], a[180:183], 0
    global_load_lds_dwordx4 v146, s[16:17] offset:0 sc1
    global_load_lds_dwordx4 v146, s[16:17] offset:1024 sc1
    v_exp_f32 v96, v96
    v_exp_f32 v97, v97
    v_exp_f32 v98, v98
    v_mfma_f32_16x16x32_bf16 a[132:135], v[196:199], v[28:31], a[132:135]
    global_load_dwordx4 v[68:71], v3, s[18:19] offset:-4096 sc1
    v_exp_f32 v99, v99
    v_mfma_f32_32x32x8_bf16 v[112:127], a[196:197], a[184:185], v[112:127]
    v_exp_f32 v100, v100
    v_exp_f32 v101, v101
    v_exp_f32 v102, v102
    v_exp_f32 v103, v103
    v_smfmac_f32_32x32x32_bf16 a[64:79], a[208:211], v[136:143], v150
    s_add_u32 m0, s48, 19456
    s_add_u32 s4, s71, 4096
    buffer_load_dwordx4 v1, s[12:15], s4 offen offset:0 sc1 lds
    v_exp_f32 v104, v104
    v_exp_f32 v105, v105
    v_exp_f32 v106, v106
    v_mfma_f32_16x16x32_bf16 a[136:139], v[36:39], v[32:35], a[136:139]
    global_load_dwordx4 v[72:75], v4, s[18:19] offset:-4096 sc1
    v_exp_f32 v107, v107
    v_smfmac_f32_32x32x32_bf16 a[80:95], a[204:207], v[96:103], v150
    v_exp_f32 v108, v108
    v_exp_f32 v109, v109
    v_exp_f32 v110, v110
    v_mfma_f32_16x16x32_bf16 a[140:143], v[40:43], v[32:35], a[140:143]
    v_exp_f32 v111, v111
    v_mfma_f32_32x32x16_bf16 v[128:143], a[192:195], a[186:189], 0
    global_load_dwordx4 v[76:79], v1, s[20:21] offset:0 sc1
    v_exp_f32 v112, v112
    v_exp_f32 v113, v113
    v_exp_f32 v114, v114
    v_exp_f32 v115, v115
    v_mfma_f32_32x32x8_bf16 v[128:143], a[196:197], a[190:191], v[128:143]
    v_exp_f32 v116, v116
    v_exp_f32 v117, v117
    v_exp_f32 v118, v118
    v_exp_f32 v119, v119
    v_smfmac_f32_32x32x32_bf16 a[80:95], a[208:211], v[104:111], v150
    v_exp_f32 v120, v120
    v_exp_f32 v121, v121
    v_exp_f32 v122, v122
    v_mfma_f32_16x16x32_bf16 a[220:223], v[44:47], v[32:35], a[220:223]
    v_exp_f32 v123, v123
    v_smfmac_f32_32x32x32_bf16 v[160:175], a[204:207], v[112:119], v150
    s_waitcnt vmcnt(16)
    global_load_dwordx4 a[192:195], v144, s[16:17] offset:0 sc1
    global_load_dwordx2 a[196:197], v145, s[16:17] offset:0 sc1
    v_exp_f32 v124, v124
    v_exp_f32 v125, v125
    v_exp_f32 v126, v126
    v_mfma_f32_16x16x32_bf16 a[224:227], v[192:195], v[32:35], a[224:227]
    v_exp_f32 v127, v127
    v_mfma_f32_32x32x16_bf16 v[96:111], a[198:201], a[144:147], 0
    s_add_u32 s16, s16, 123904
    s_addc_u32 s17, s17, 0
    v_exp_f32 v128, v128
    v_exp_f32 v129, v129
    v_exp_f32 v130, v130
    v_mfma_f32_16x16x32_bf16 a[228:231], v[196:199], v[32:35], a[228:231]
    global_load_dwordx4 v[80:83], v1, s[20:21] offset:1024 sc1
    v_exp_f32 v131, v131
    v_mfma_f32_32x32x8_bf16 v[96:111], a[202:203], a[148:149], v[96:111]
    v_exp_f32 v132, v132
    v_exp_f32 v133, v133
    v_exp_f32 v134, v134
    v_exp_f32 v135, v135
    v_smfmac_f32_32x32x32_bf16 v[160:175], a[208:211], v[120:127], v150
    global_load_dwordx4 v[84:87], v1, s[20:21] offset:2048 sc1
    v_exp_f32 v136, v136
    v_exp_f32 v137, v137
    v_exp_f32 v138, v138
    v_mfma_f32_16x16x32_bf16 v[48:51], v[36:39], v[200:203], v[48:51]
    v_exp_f32 v139, v139
    v_smfmac_f32_32x32x32_bf16 v[176:191], a[204:207], v[128:135], v150
    v_exp_f32 v140, v140
    v_exp_f32 v141, v141
    v_exp_f32 v142, v142
    v_mfma_f32_16x16x32_bf16 v[52:55], v[40:43], v[200:203], v[52:55]
    v_exp_f32 v143, v143
    v_mfma_f32_32x32x16_bf16 v[112:127], a[198:201], a[150:153], 0
    global_load_dwordx4 v[88:91], v1, s[20:21] offset:3072 sc1
    v_exp_f32 v96, v96
    v_exp_f32 v97, v97
    v_exp_f32 v98, v98
    v_mfma_f32_16x16x32_bf16 v[56:59], v[44:47], v[200:203], v[56:59]
    s_add_u32 s20, s20, 8192
    s_addc_u32 s21, s21, 0
    global_load_dwordx4 v[92:95], v1, s[20:21] offset:-4096 sc1
    v_exp_f32 v99, v99
    v_mfma_f32_32x32x8_bf16 v[112:127], a[202:203], a[154:155], v[112:127]
    v_exp_f32 v100, v100
    v_exp_f32 v101, v101
    v_exp_f32 v102, v102
    v_exp_f32 v103, v103
    v_smfmac_f32_32x32x32_bf16 v[176:191], a[208:211], v[136:143], v150
    s_add_u32 m0, s48, 20480
    s_add_u32 s4, s71, 5120
    buffer_load_dwordx4 v1, s[12:15], s4 offen offset:0 sc1 lds
    v_exp_f32 v104, v104
    v_exp_f32 v105, v105
    v_exp_f32 v106, v106
    v_mfma_f32_16x16x32_bf16 v[60:63], v[192:195], v[200:203], v[60:63]
    v_exp_f32 v107, v107
    v_smfmac_f32_32x32x32_bf16 a[0:15], a[212:215], v[96:103], v150
    v_exp_f32 v108, v108
    v_exp_f32 v109, v109
    v_exp_f32 v110, v110
    v_mfma_f32_16x16x32_bf16 v[64:67], v[196:199], v[200:203], v[64:67]
    v_exp_f32 v111, v111
    v_mfma_f32_32x32x16_bf16 v[128:143], a[198:201], a[156:159], 0
    global_load_dwordx4 v[20:23], v5, s[18:19] offset:-4096 sc1
    v_exp_f32 v112, v112
    v_exp_f32 v113, v113
    v_exp_f32 v114, v114
    v_exp_f32 v115, v115
    v_mfma_f32_32x32x8_bf16 v[128:143], a[202:203], a[160:161], v[128:143]
    v_exp_f32 v116, v116
    v_exp_f32 v117, v117
    v_exp_f32 v118, v118
    v_exp_f32 v119, v119
    v_smfmac_f32_32x32x32_bf16 a[0:15], a[216:219], v[104:111], v150
    v_exp_f32 v120, v120
    v_exp_f32 v121, v121
    v_exp_f32 v122, v122
    v_mfma_f32_16x16x32_bf16 a[96:99], v[216:219], v[204:207], a[96:99]
    v_exp_f32 v123, v123
    v_smfmac_f32_32x32x32_bf16 a[16:31], a[212:215], v[112:119], v150
    v_exp_f32 v124, v124
    v_exp_f32 v125, v125
    v_exp_f32 v126, v126
    v_mfma_f32_16x16x32_bf16 a[100:103], v[220:223], v[204:207], a[100:103]
    v_exp_f32 v127, v127
    v_mfma_f32_32x32x16_bf16 v[96:111], a[198:201], a[162:165], 0
    global_load_dwordx4 v[16:19], v2, s[18:19] offset:-2048 sc1
    v_exp_f32 v128, v128
    v_exp_f32 v129, v129
    v_exp_f32 v130, v130
    v_mfma_f32_16x16x32_bf16 a[104:107], v[224:227], v[204:207], a[104:107]
    global_load_dwordx4 v[24:27], v3, s[18:19] offset:-2048 sc1
    v_exp_f32 v131, v131
    v_mfma_f32_32x32x8_bf16 v[96:111], a[202:203], a[166:167], v[96:111]
    v_exp_f32 v132, v132
    v_exp_f32 v133, v133
    v_exp_f32 v134, v134
    v_exp_f32 v135, v135
    v_smfmac_f32_32x32x32_bf16 a[16:31], a[216:219], v[120:127], v150
    v_exp_f32 v136, v136
    v_exp_f32 v137, v137
    v_exp_f32 v138, v138
    v_mfma_f32_16x16x32_bf16 a[108:111], v[228:231], v[204:207], a[108:111]
    v_exp_f32 v139, v139
    v_smfmac_f32_32x32x32_bf16 a[32:47], a[212:215], v[128:135], v150
    v_exp_f32 v140, v140
    v_exp_f32 v141, v141
    v_exp_f32 v142, v142
    v_mfma_f32_16x16x32_bf16 a[112:115], v[232:235], v[204:207], a[112:115]
    v_exp_f32 v143, v143
    v_mfma_f32_32x32x16_bf16 v[112:127], a[198:201], a[168:171], 0
    ds_read_b64_tr_b16 a[204:205], v147 offset:0
    ds_read_b64_tr_b16 a[206:207], v147 offset:64
    ds_read_b64_tr_b16 a[208:209], v147 offset:256
    ds_read_b64_tr_b16 a[210:211], v147 offset:320
    v_exp_f32 v96, v96
    v_exp_f32 v97, v97
    v_exp_f32 v98, v98
    v_mfma_f32_16x16x32_bf16 a[116:119], v[216:219], v[208:211], a[116:119]
    global_load_dwordx4 v[28:31], v4, s[18:19] offset:-2048 sc1
    v_exp_f32 v99, v99
    v_mfma_f32_32x32x8_bf16 v[112:127], a[202:203], a[172:173], v[112:127]
    v_exp_f32 v100, v100
    v_exp_f32 v101, v101
    v_exp_f32 v102, v102
    v_exp_f32 v103, v103
    v_smfmac_f32_32x32x32_bf16 a[32:47], a[216:219], v[136:143], v150
    s_add_u32 m0, s48, 21504
    s_add_u32 s4, s71, 6144
    buffer_load_dwordx4 v1, s[12:15], s4 offen offset:0 sc1 lds
    v_exp_f32 v104, v104
    v_exp_f32 v105, v105
    v_exp_f32 v106, v106
    v_mfma_f32_16x16x32_bf16 a[120:123], v[220:223], v[208:211], a[120:123]
    v_exp_f32 v107, v107
    v_smfmac_f32_32x32x32_bf16 a[48:63], a[212:215], v[96:103], v150
    v_exp_f32 v108, v108
    v_exp_f32 v109, v109
    v_exp_f32 v110, v110
    v_mfma_f32_16x16x32_bf16 a[124:127], v[224:227], v[208:211], a[124:127]
    v_exp_f32 v111, v111
    v_mfma_f32_32x32x16_bf16 v[128:143], a[198:201], a[174:177], 0
    s_waitcnt lgkmcnt(0)
    global_load_dwordx4 v[32:35], v1, s[20:21] offset:-3072 sc1
    v_exp_f32 v112, v112
    v_exp_f32 v113, v113
    v_exp_f32 v114, v114
    v_exp_f32 v115, v115
    v_mfma_f32_32x32x8_bf16 v[128:143], a[202:203], a[178:179], v[128:143]
    v_exp_f32 v116, v116
    v_exp_f32 v117, v117
    v_exp_f32 v118, v118
    v_exp_f32 v119, v119
    v_smfmac_f32_32x32x32_bf16 a[48:63], a[216:219], v[104:111], v150
    global_load_dwordx4 v[36:39], v1, s[20:21] offset:-2048 sc1
    v_exp_f32 v120, v120
    v_exp_f32 v121, v121
    v_exp_f32 v122, v122
    v_mfma_f32_16x16x32_bf16 a[128:131], v[228:231], v[208:211], a[128:131]
    v_exp_f32 v123, v123
    v_smfmac_f32_32x32x32_bf16 a[64:79], a[212:215], v[112:119], v150
    s_add_u32 m0, s48, 35840
    v_exp_f32 v124, v124
    v_exp_f32 v125, v125
    v_exp_f32 v126, v126
    v_mfma_f32_16x16x32_bf16 a[132:135], v[232:235], v[208:211], a[132:135]
    v_exp_f32 v127, v127
    v_mfma_f32_32x32x16_bf16 v[96:111], a[198:201], a[180:183], 0
    global_load_lds_dwordx4 v146, s[16:17] offset:0 sc1
    global_load_lds_dwordx4 v146, s[16:17] offset:1024 sc1
    v_exp_f32 v128, v128
    v_exp_f32 v129, v129
    v_exp_f32 v130, v130
    v_mfma_f32_16x16x32_bf16 a[136:139], v[216:219], v[212:215], a[136:139]
    global_load_dwordx4 v[40:43], v1, s[20:21] offset:-1024 sc1
    v_exp_f32 v131, v131
    v_mfma_f32_32x32x8_bf16 v[96:111], a[202:203], a[184:185], v[96:111]
    v_exp_f32 v132, v132
    v_exp_f32 v133, v133
    v_exp_f32 v134, v134
    v_exp_f32 v135, v135
    v_smfmac_f32_32x32x32_bf16 a[64:79], a[216:219], v[120:127], v150
    global_load_dwordx4 v[44:47], v1, s[20:21] offset:0 sc1
    v_exp_f32 v136, v136
    v_exp_f32 v137, v137
    v_exp_f32 v138, v138
    v_mfma_f32_16x16x32_bf16 a[140:143], v[220:223], v[212:215], a[140:143]
    v_exp_f32 v139, v139
    v_smfmac_f32_32x32x32_bf16 a[80:95], a[212:215], v[128:135], v150
    v_exp_f32 v140, v140
    v_exp_f32 v141, v141
    v_exp_f32 v142, v142
    v_mfma_f32_16x16x32_bf16 a[220:223], v[224:227], v[212:215], a[220:223]
    v_exp_f32 v143, v143
    v_mfma_f32_32x32x16_bf16 v[112:127], a[198:201], a[186:189], 0
    global_load_dwordx4 v[192:195], v1, s[20:21] offset:1024 sc1
    v_exp_f32 v96, v96
    v_exp_f32 v97, v97
    v_exp_f32 v98, v98
    v_mfma_f32_16x16x32_bf16 a[224:227], v[228:231], v[212:215], a[224:227]
L_pad11:
    s_cbranch_execz L_back
    v_exp_f32 v99, v99
    v_mfma_f32_32x32x8_bf16 v[112:127], a[202:203], a[190:191], v[112:127]
    v_exp_f32 v100, v100
    v_exp_f32 v101, v101
    v_exp_f32 v102, v102
    v_exp_f32 v103, v103
    v_smfmac_f32_32x32x32_bf16 a[80:95], a[216:219], v[136:143], v150
    s_add_u32 m0, s48, 22528
    s_add_u32 s4, s71, 7168
    buffer_load_dwordx4 v1, s[12:15], s4 offen offset:0 sc1 lds
    v_exp_f32 v104, v104
    v_exp_f32 v105, v105
    v_exp_f32 v106, v106
    v_mfma_f32_16x16x32_bf16 a[228:231], v[232:235], v[212:215], a[228:231]
    v_exp_f32 v107, v107
    v_smfmac_f32_32x32x32_bf16 v[160:175], a[212:215], v[96:103], v150
    s_waitcnt vmcnt(18)
    global_load_dwordx4 a[198:201], v144, s[16:17] offset:0 sc1
    global_load_dwordx2 a[202:203], v145, s[16:17] offset:0 sc1
    v_exp_f32 v108, v108
    v_exp_f32 v109, v109
    v_exp_f32 v110, v110
    v_mfma_f32_16x16x32_bf16 v[48:51], v[216:219], v[236:239], v[48:51]
    v_exp_f32 v111, v111
    v_mfma_f32_32x32x16_bf16 v[128:143], a[192:195], a[144:147], 0
    s_add_u32 s16, s16, 123904
    s_addc_u32 s17, s17, 0
    v_exp_f32 v112, v112
    v_exp_f32 v113, v113
    v_exp_f32 v114, v114
    v_exp_f32 v115, v115
    v_mfma_f32_32x32x8_bf16 v[128:143], a[196:197], a[148:149], v[128:143]
    v_exp_f32 v116, v116
    v_exp_f32 v117, v117
    v_exp_f32 v118, v118
    v_exp_f32 v119, v119
    v_smfmac_f32_32x32x32_bf16 v[160:175], a[216:219], v[104:111], v150
    global_load_dwordx4 v[200:203], v5, s[18:19] offset:-2048 sc1
    v_exp_f32 v120, v120
    v_exp_f32 v121, v121
    v_exp_f32 v122, v122
    v_mfma_f32_16x16x32_bf16 v[52:55], v[220:223], v[236:239], v[52:55]
    global_load_dwordx4 v[196:199], v2, s[18:19] offset:0 sc1
    v_exp_f32 v123, v123
    v_smfmac_f32_32x32x32_bf16 v[176:191], a[212:215], v[112:119], v150
    v_exp_f32 v124, v124
    v_exp_f32 v125, v125
    v_exp_f32 v126, v126
    v_mfma_f32_16x16x32_bf16 v[56:59], v[224:227], v[236:239], v[56:59]
    v_exp_f32 v127, v127
    v_mfma_f32_32x32x16_bf16 v[96:111], a[192:195], a[150:153], 0
    global_load_dwordx4 v[204:207], v3, s[18:19] offset:0 sc1
    v_exp_f32 v128, v128
    v_exp_f32 v129, v129
    v_exp_f32 v130, v130
    v_mfma_f32_16x16x32_bf16 v[60:63], v[228:231], v[236:239], v[60:63]
    v_exp_f32 v131, v131
    v_mfma_f32_32x32x8_bf16 v[96:111], a[196:197], a[154:155], v[96:111]
    v_exp_f32 v132, v132
    v_exp_f32 v133, v133
    v_exp_f32 v134, v134
    v_exp_f32 v135, v135
    v_smfmac_f32_32x32x32_bf16 v[176:191], a[216:219], v[120:127], v150
    v_exp_f32 v136, v136
    v_exp_f32 v137, v137
    v_exp_f32 v138, v138
    v_mfma_f32_16x16x32_bf16 v[64:67], v[232:235], v[236:239], v[64:67]
    v_exp_f32 v139, v139
    v_smfmac_f32_32x32x32_bf16 a[0:15], a[204:207], v[128:135], v150
    v_exp_f32 v140, v140
    v_exp_f32 v141, v141
    v_exp_f32 v142, v142
    v_mfma_f32_16x16x32_bf16 a[96:99], v[252:255], v[240:243], a[96:99]
    v_exp_f32 v143, v143
    v_mfma_f32_32x32x16_bf16 v[112:127], a[192:195], a[156:159], 0
    global_load_dwordx4 v[208:211], v4, s[18:19] offset:0 sc1
    v_exp_f32 v96, v96
    v_exp_f32 v97, v97
    v_exp_f32 v98, v98
    v_mfma_f32_16x16x32_bf16 a[100:103], a[232:235], v[240:243], a[100:103]
    global_load_dwordx4 v[212:215], v1, s[20:21] offset:2048 sc1
    v_exp_f32 v99, v99
    v_mfma_f32_32x32x8_bf16 v[112:127], a[196:197], a[160:161], v[112:127]
    v_exp_f32 v100, v100
    v_exp_f32 v101, v101
    v_exp_f32 v102, v102
    v_exp_f32 v103, v103
    v_smfmac_f32_32x32x32_bf16 a[0:15], a[208:211], v[136:143], v150
    s_add_u32 m0, s48, 23552
    s_add_u32 s4, s71, 8192
    buffer_load_dwordx4 v1, s[12:15], s4 offen offset:0 sc1 lds
    v_exp_f32 v104, v104
    v_exp_f32 v105, v105
    v_exp_f32 v106, v106
    v_mfma_f32_16x16x32_bf16 a[104:107], a[236:239], v[240:243], a[104:107]
    v_exp_f32 v107, v107
    v_smfmac_f32_32x32x32_bf16 a[16:31], a[204:207], v[96:103], v150
    v_exp_f32 v108, v108
    v_exp_f32 v109, v109
    v_exp_f32 v110, v110
    v_mfma_f32_16x16x32_bf16 a[108:111], a[240:243], v[240:243], a[108:111]
    v_exp_f32 v111, v111
    v_mfma_f32_32x32x16_bf16 v[128:143], a[192:195], a[162:165], 0
    global_load_dwordx4 v[216:219], v1, s[20:21] offset:3072 sc1
    v_exp_f32 v112, v112
    v_exp_f32 v113, v113
    v_exp_f32 v114, v114
    v_exp_f32 v115, v115
    v_mfma_f32_32x32x8_bf16 v[128:143], a[196:197], a[166:167], v[128:143]
    v_exp_f32 v116, v116
    v_exp_f32 v117, v117
    v_exp_f32 v118, v118
    v_exp_f32 v119, v119
    v_smfmac_f32_32x32x32_bf16 a[16:31], a[208:211], v[104:111], v150
    s_add_u32 s20, s20, 8192
    s_addc_u32 s21, s21, 0
    global_load_dwordx4 v[220:223], v1, s[20:21] offset:-4096 sc1
    v_exp_f32 v120, v120
    v_exp_f32 v121, v121
    v_exp_f32 v122, v122
    v_mfma_f32_16x16x32_bf16 a[112:115], a[244:247], v[240:243], a[112:115]
    v_exp_f32 v123, v123
    v_smfmac_f32_32x32x32_bf16 a[32:47], a[204:207], v[112:119], v150
    v_exp_f32 v124, v124
    v_exp_f32 v125, v125
    v_exp_f32 v126, v126
    v_mfma_f32_16x16x32_bf16 a[116:119], v[252:255], v[244:247], a[116:119]
    v_exp_f32 v127, v127
    v_mfma_f32_32x32x16_bf16 v[96:111], a[192:195], a[168:171], 0
    ds_read_b64_tr_b16 a[212:213], v148 offset:0
    ds_read_b64_tr_b16 a[214:215], v148 offset:64
    ds_read_b64_tr_b16 a[216:217], v148 offset:256
    ds_read_b64_tr_b16 a[218:219], v148 offset:320
    v_exp_f32 v128, v128
    v_exp_f32 v129, v129
    v_exp_f32 v130, v130
    v_mfma_f32_16x16x32_bf16 a[120:123], a[232:235], v[244:247], a[120:123]
    global_load_dwordx4 v[224:227], v1, s[20:21] offset:-3072 sc1
    v_exp_f32 v131, v131
    v_mfma_f32_32x32x8_bf16 v[96:111], a[196:197], a[172:173], v[96:111]
    v_exp_f32 v132, v132
    v_exp_f32 v133, v133
    v_exp_f32 v134, v134
    v_exp_f32 v135, v135
    v_smfmac_f32_32x32x32_bf16 a[32:47], a[208:211], v[120:127], v150
    v_exp_f32 v136, v136
    v_exp_f32 v137, v137
    v_exp_f32 v138, v138
    v_mfma_f32_16x16x32_bf16 a[124:127], a[236:239], v[244:247], a[124:127]
    v_exp_f32 v139, v139
    v_smfmac_f32_32x32x32_bf16 a[48:63], a[204:207], v[128:135], v150
    v_exp_f32 v140, v140
    v_exp_f32 v141, v141
    v_exp_f32 v142, v142
    v_mfma_f32_16x16x32_bf16 a[128:131], a[240:243], v[244:247], a[128:131]
    v_exp_f32 v143, v143
    v_mfma_f32_32x32x16_bf16 v[112:127], a[192:195], a[174:177], 0
    s_waitcnt lgkmcnt(0)
    global_load_dwordx4 v[228:231], v1, s[20:21] offset:-2048 sc1
    v_exp_f32 v96, v96
    v_exp_f32 v97, v97
    v_exp_f32 v98, v98
    v_mfma_f32_16x16x32_bf16 a[132:135], a[244:247], v[244:247], a[132:135]
    global_load_dwordx4 v[236:239], v5, s[18:19] offset:0 sc1
    v_exp_f32 v99, v99
    v_mfma_f32_32x32x8_bf16 v[112:127], a[196:197], a[178:179], v[112:127]
    v_exp_f32 v100, v100
    v_exp_f32 v101, v101
    v_exp_f32 v102, v102
    v_exp_f32 v103, v103
    v_smfmac_f32_32x32x32_bf16 a[48:63], a[208:211], v[136:143], v150
    s_add_u32 m0, s48, 24576
    s_add_u32 s4, s71, 9216
    buffer_load_dwordx4 v1, s[12:15], s4 offen offset:0 sc1 lds
    v_exp_f32 v104, v104
    v_exp_f32 v105, v105
    v_exp_f32 v106, v106
    v_mfma_f32_16x16x32_bf16 a[136:139], v[252:255], v[248:251], a[136:139]
    v_exp_f32 v107, v107
    v_smfmac_f32_32x32x32_bf16 a[64:79], a[204:207], v[96:103], v150
    s_add_u32 m0, s48, 37888
    v_exp_f32 v108, v108
    v_exp_f32 v109, v109
    v_exp_f32 v110, v110
    v_mfma_f32_16x16x32_bf16 a[140:143], a[232:235], v[248:251], a[140:143]
    v_exp_f32 v111, v111
    v_mfma_f32_32x32x16_bf16 v[128:143], a[192:195], a[180:183], 0
    global_load_lds_dwordx4 v146, s[16:17] offset:0 sc1
    global_load_lds_dwordx4 v146, s[16:17] offset:1024 sc1
    v_exp_f32 v112, v112
    v_exp_f32 v113, v113
    v_exp_f32 v114, v114
    v_exp_f32 v115, v115
    v_mfma_f32_32x32x8_bf16 v[128:143], a[196:197], a[184:185], v[128:143]
    v_exp_f32 v116, v116
    v_exp_f32 v117, v117
    v_exp_f32 v118, v118
    v_exp_f32 v119, v119
    v_smfmac_f32_32x32x32_bf16 a[64:79], a[208:211], v[104:111], v150
    global_load_dwordx4 v[232:235], v2, s[18:19] offset:2048 sc1
    v_exp_f32 v120, v120
    v_exp_f32 v121, v121
    v_exp_f32 v122, v122
    v_mfma_f32_16x16x32_bf16 a[220:223], a[236:239], v[248:251], a[220:223]
    v_exp_f32 v123, v123
    v_smfmac_f32_32x32x32_bf16 a[80:95], a[204:207], v[112:119], v150
    v_exp_f32 v124, v124
    v_exp_f32 v125, v125
    v_exp_f32 v126, v126
    v_mfma_f32_16x16x32_bf16 a[224:227], a[240:243], v[248:251], a[224:227]
    v_exp_f32 v127, v127
    v_mfma_f32_32x32x16_bf16 v[96:111], a[192:195], a[186:189], 0
    global_load_dwordx4 v[240:243], v3, s[18:19] offset:2048 sc1
    v_exp_f32 v128, v128
    v_exp_f32 v129, v129
    v_exp_f32 v130, v130
    v_mfma_f32_16x16x32_bf16 a[228:231], a[244:247], v[248:251], a[228:231]
    global_load_dwordx4 v[244:247], v4, s[18:19] offset:2048 sc1
    v_exp_f32 v131, v131
    v_mfma_f32_32x32x8_bf16 v[96:111], a[196:197], a[190:191], v[96:111]
    v_exp_f32 v132, v132
    v_exp_f32 v133, v133
    v_exp_f32 v134, v134
    v_exp_f32 v135, v135
    v_smfmac_f32_32x32x32_bf16 a[80:95], a[208:211], v[120:127], v150
    v_exp_f32 v136, v136
    v_exp_f32 v137, v137
    v_exp_f32 v138, v138
    v_mfma_f32_16x16x32_bf16 v[48:51], v[252:255], a[248:251], v[48:51]
    v_exp_f32 v139, v139
    v_smfmac_f32_32x32x32_bf16 v[160:175], a[204:207], v[128:135], v150
    s_waitcnt vmcnt(17)
    global_load_dwordx4 a[192:195], v144, s[16:17] offset:0 sc1
    global_load_dwordx2 a[196:197], v145, s[16:17] offset:0 sc1
    v_exp_f32 v140, v140
    v_exp_f32 v141, v141
    v_exp_f32 v142, v142
    v_mfma_f32_16x16x32_bf16 v[52:55], a[232:235], a[248:251], v[52:55]
    v_exp_f32 v143, v143
    v_mfma_f32_32x32x16_bf16 v[112:127], a[198:201], a[144:147], 0
    s_add_u32 s16, s16, 123904
    s_addc_u32 s17, s17, 0
    v_exp_f32 v96, v96
    v_exp_f32 v97, v97
    v_exp_f32 v98, v98
    v_mfma_f32_16x16x32_bf16 v[56:59], a[236:239], a[248:251], v[56:59]
    global_load_dwordx4 v[248:251], v1, s[20:21] offset:-1024 sc1
    v_exp_f32 v99, v99
    v_mfma_f32_32x32x8_bf16 v[112:127], a[202:203], a[148:149], v[112:127]
    v_exp_f32 v100, v100
    v_exp_f32 v101, v101
    v_exp_f32 v102, v102
    v_exp_f32 v103, v103
    v_smfmac_f32_32x32x32_bf16 v[160:175], a[208:211], v[136:143], v150
    s_add_u32 m0, s48, 25600
    s_add_u32 s4, s71, 10240
    buffer_load_dwordx4 v1, s[12:15], s4 offen offset:0 sc1 lds
    v_exp_f32 v104, v104
    v_exp_f32 v105, v105
    v_exp_f32 v106, v106
    v_mfma_f32_16x16x32_bf16 v[60:63], a[240:243], a[248:251], v[60:63]
    global_load_dwordx4 v[252:255], v1, s[20:21] offset:0 sc1
    v_exp_f32 v107, v107
    v_smfmac_f32_32x32x32_bf16 v[176:191], a[204:207], v[96:103], v150
    v_exp_f32 v108, v108
    v_exp_f32 v109, v109
    v_exp_f32 v110, v110
    v_mfma_f32_16x16x32_bf16 v[64:67], a[244:247], a[248:251], v[64:67]
    v_exp_f32 v111, v111
    v_mfma_f32_32x32x16_bf16 v[128:143], a[198:201], a[150:153], 0
    global_load_dwordx4 a[232:235], v1, s[20:21] offset:1024 sc1
    v_exp_f32 v112, v112
    v_exp_f32 v113, v113
    v_exp_f32 v114, v114
    v_exp_f32 v115, v115
    v_mfma_f32_32x32x8_bf16 v[128:143], a[202:203], a[154:155], v[128:143]
    v_exp_f32 v116, v116
    v_exp_f32 v117, v117
    v_exp_f32 v118, v118
    v_exp_f32 v119, v119
    v_smfmac_f32_32x32x32_bf16 v[176:191], a[208:211], v[104:111], v150
    v_exp_f32 v120, v120
    v_exp_f32 v121, v121
    v_exp_f32 v122, v122
    v_mfma_f32_16x16x32_bf16 a[96:99], v[76:79], a[252:255], a[96:99]
    v_exp_f32 v123, v123
    v_smfmac_f32_32x32x32_bf16 a[0:15], a[212:215], v[112:119], v150
    v_exp_f32 v124, v124
    v_exp_f32 v125, v125
    v_exp_f32 v126, v126
    v_mfma_f32_16x16x32_bf16 a[100:103], v[80:83], a[252:255], a[100:103]
    v_exp_f32 v127, v127
    v_mfma_f32_32x32x16_bf16 v[96:111], a[198:201], a[156:159], 0
    global_load_dwordx4 a[236:239], v1, s[20:21] offset:2048 sc1
    v_exp_f32 v128, v128
    v_exp_f32 v129, v129
    v_exp_f32 v130, v130
    v_mfma_f32_16x16x32_bf16 a[104:107], v[84:87], a[252:255], a[104:107]
    global_load_dwordx4 a[240:243], v1, s[20:21] offset:3072 sc1
    v_exp_f32 v131, v131
    v_mfma_f32_32x32x8_bf16 v[96:111], a[202:203], a[160:161], v[96:111]
    v_exp_f32 v132, v132
    v_exp_f32 v133, v133
    v_exp_f32 v134, v134
    v_exp_f32 v135, v135
    v_smfmac_f32_32x32x32_bf16 a[0:15], a[216:219], v[120:127], v150
    v_exp_f32 v136, v136
    v_exp_f32 v137, v137
    v_exp_f32 v138, v138
    v_mfma_f32_16x16x32_bf16 a[108:111], v[88:91], a[252:255], a[108:111]
    v_exp_f32 v139, v139
    v_smfmac_f32_32x32x32_bf16 a[16:31], a[212:215], v[128:135], v150
    v_exp_f32 v140, v140
    v_exp_f32 v141, v141
    v_exp_f32 v142, v142
    v_mfma_f32_16x16x32_bf16 a[112:115], v[92:95], a[252:255], a[112:115]
    v_exp_f32 v143, v143
    v_mfma_f32_32x32x16_bf16 v[112:127], a[198:201], a[162:165], 0
    global_load_dwordx4 a[248:251], v5, s[18:19] offset:2048 sc1
    v_exp_f32 v96, v96
    v_exp_f32 v97, v97
    v_exp_f32 v98, v98
    v_mfma_f32_16x16x32_bf16 a[116:119], v[76:79], v[68:71], a[116:119]
    v_exp_f32 v99, v99
    v_mfma_f32_32x32x8_bf16 v[112:127], a[202:203], a[166:167], v[112:127]
    v_exp_f32 v100, v100
    v_exp_f32 v101, v101
    v_exp_f32 v102, v102
    v_exp_f32 v103, v103
    v_smfmac_f32_32x32x32_bf16 a[16:31], a[216:219], v[136:143], v150
    s_add_u32 m0, s48, 26624
    s_add_u32 s4, s71, 11264
    buffer_load_dwordx4 v1, s[12:15], s4 offen offset:0 sc1 lds
    v_exp_f32 v104, v104
    v_exp_f32 v105, v105
    v_exp_f32 v106, v106
    v_mfma_f32_16x16x32_bf16 a[120:123], v[80:83], v[68:71], a[120:123]
    v_exp_f32 v107, v107
    v_smfmac_f32_32x32x32_bf16 a[32:47], a[212:215], v[96:103], v150
    v_exp_f32 v108, v108
    v_exp_f32 v109, v109
    v_exp_f32 v110, v110
    v_mfma_f32_16x16x32_bf16 a[124:127], v[84:87], v[68:71], a[124:127]
    v_exp_f32 v111, v111
    v_mfma_f32_32x32x16_bf16 v[128:143], a[198:201], a[168:171], 0
    ds_read_b64_tr_b16 a[204:205], v147 offset:0
    ds_read_b64_tr_b16 a[206:207], v147 offset:64
    ds_read_b64_tr_b16 a[208:209], v147 offset:256
    ds_read_b64_tr_b16 a[210:211], v147 offset:320
    v_exp_f32 v112, v112
    v_exp_f32 v113, v113
    v_exp_f32 v114, v114
    v_exp_f32 v115, v115
    v_mfma_f32_32x32x8_bf16 v[128:143], a[202:203], a[172:173], v[128:143]
    v_exp_f32 v116, v116
    v_exp_f32 v117, v117
    v_exp_f32 v118, v118
    v_exp_f32 v119, v119
    v_smfmac_f32_32x32x32_bf16 a[32:47], a[216:219], v[104:111], v150
    s_add_u32 s18, s18, 8192
    s_addc_u32 s19, s19, 0
    global_load_dwordx4 a[244:247], v2, s[18:19] offset:-4096 sc1
    v_exp_f32 v120, v120
    v_exp_f32 v121, v121
    v_exp_f32 v122, v122
    v_mfma_f32_16x16x32_bf16 a[128:131], v[88:91], v[68:71], a[128:131]
    global_load_dwordx4 a[252:255], v3, s[18:19] offset:-4096 sc1
    v_exp_f32 v123, v123
    v_smfmac_f32_32x32x32_bf16 a[48:63], a[212:215], v[112:119], v150
    v_exp_f32 v124, v124
    v_exp_f32 v125, v125
    v_exp_f32 v126, v126
    v_mfma_f32_16x16x32_bf16 a[132:135], v[92:95], v[68:71], a[132:135]
    v_exp_f32 v127, v127
    v_mfma_f32_32x32x16_bf16 v[96:111], a[198:201], a[174:177], 0
    s_waitcnt lgkmcnt(0)
    global_load_dwordx4 v[68:71], v4, s[18:19] offset:-4096 sc1
    v_exp_f32 v128, v128
    v_exp_f32 v129, v129
    v_exp_f32 v130, v130
    v_mfma_f32_16x16x32_bf16 a[136:139], v[76:79], v[72:75], a[136:139]
    v_exp_f32 v131, v131
    v_mfma_f32_32x32x8_bf16 v[96:111], a[202:203], a[178:179], v[96:111]
    v_exp_f32 v132, v132
    v_exp_f32 v133, v133
    v_exp_f32 v134, v134
    v_exp_f32 v135, v135
    v_smfmac_f32_32x32x32_bf16 a[48:63], a[216:219], v[120:127], v150
    v_exp_f32 v136, v136
    v_exp_f32 v137, v137
    v_exp_f32 v138, v138
    v_mfma_f32_16x16x32_bf16 a[140:143], v[80:83], v[72:75], a[140:143]
    v_exp_f32 v139, v139
    v_smfmac_f32_32x32x32_bf16 a[64:79], a[212:215], v[128:135], v150
    s_add_u32 m0, s48, 35840
    v_exp_f32 v140, v140
    v_exp_f32 v141, v141
    v_exp_f32 v142, v142
    v_mfma_f32_16x16x32_bf16 a[220:223], v[84:87], v[72:75], a[220:223]
    v_exp_f32 v143, v143
    v_mfma_f32_32x32x16_bf16 v[112:127], a[198:201], a[180:183], 0
    global_load_lds_dwordx4 v146, s[16:17] offset:0 sc1
    global_load_lds_dwordx4 v146, s[16:17] offset:1024 sc1
    v_exp_f32 v96, v96
    v_exp_f32 v97, v97
    v_exp_f32 v98, v98
    v_mfma_f32_16x16x32_bf16 a[224:227], v[88:91], v[72:75], a[224:227]
    v_exp_f32 v99, v99
    v_mfma_f32_32x32x8_bf16 v[112:127], a[202:203], a[184:185], v[112:127]
    v_exp_f32 v100, v100
    v_exp_f32 v101, v101
    v_exp_f32 v102, v102
    v_exp_f32 v103, v103
    v_smfmac_f32_32x32x32_bf16 a[64:79], a[216:219], v[136:143], v150
    s_add_u32 m0, s48, 27648
    s_add_u32 s4, s71, 12288
    buffer_load_dwordx4 v1, s[12:15], s4 offen offset:0 sc1 lds
    v_exp_f32 v104, v104
    v_exp_f32 v105, v105
    v_exp_f32 v106, v106
    v_mfma_f32_16x16x32_bf16 a[228:231], v[92:95], v[72:75], a[228:231]
    s_add_u32 s20, s20, 8192
    s_addc_u32 s21, s21, 0
    global_load_dwordx4 v[72:75], v1, s[20:21] offset:-4096 sc1
    v_exp_f32 v107, v107
    v_smfmac_f32_32x32x32_bf16 a[80:95], a[212:215], v[96:103], v150
    v_exp_f32 v108, v108
    v_exp_f32 v109, v109
    v_exp_f32 v110, v110
    v_mfma_f32_16x16x32_bf16 v[48:51], v[76:79], v[20:23], v[48:51]
    global_load_dwordx4 v[76:79], v1, s[20:21] offset:-3072 sc1
    v_exp_f32 v111, v111
    v_mfma_f32_32x32x16_bf16 v[128:143], a[198:201], a[186:189], 0
    v_exp_f32 v112, v112
    v_exp_f32 v113, v113
    v_exp_f32 v114, v114
    v_exp_f32 v115, v115
    v_mfma_f32_32x32x8_bf16 v[128:143], a[202:203], a[190:191], v[128:143]
    v_exp_f32 v116, v116
    v_exp_f32 v117, v117
    v_exp_f32 v118, v118
    v_exp_f32 v119, v119
    v_smfmac_f32_32x32x32_bf16 a[80:95], a[216:219], v[104:111], v150
    v_exp_f32 v120, v120
    v_exp_f32 v121, v121
    v_exp_f32 v122, v122
    v_mfma_f32_16x16x32_bf16 v[52:55], v[80:83], v[20:23], v[52:55]
    global_load_dwordx4 v[80:83], v1, s[20:21] offset:-2048 sc1
    v_exp_f32 v123, v123
    v_smfmac_f32_32x32x32_bf16 v[160:175], a[212:215], v[112:119], v150
    s_waitcnt vmcnt(17)
    global_load_dwordx4 a[198:201], v144, s[16:17] offset:0 sc1
    global_load_dwordx2 a[202:203], v145, s[16:17] offset:0 sc1
    v_exp_f32 v124, v124
    v_exp_f32 v125, v125
    v_exp_f32 v126, v126
    v_mfma_f32_16x16x32_bf16 v[56:59], v[84:87], v[20:23], v[56:59]
    global_load_dwordx4 v[84:87], v1, s[20:21] offset:-1024 sc1
    v_exp_f32 v127, v127
    v_mfma_f32_32x32x16_bf16 v[96:111], a[192:195], a[144:147], 0
    s_add_u32 s16, s16, 123904
    s_addc_u32 s17, s17, 0
    v_exp_f32 v128, v128
    v_exp_f32 v129, v129
    v_exp_f32 v130, v130
    v_mfma_f32_16x16x32_bf16 v[60:63], v[88:91], v[20:23], v[60:63]
    global_load_dwordx4 v[88:91], v1, s[20:21] offset:0 sc1
    v_exp_f32 v131, v131
    v_mfma_f32_32x32x8_bf16 v[96:111], a[196:197], a[148:149], v[96:111]
    v_exp_f32 v132, v132
    v_exp_f32 v133, v133
    v_exp_f32 v134, v134
    v_exp_f32 v135, v135
    v_smfmac_f32_32x32x32_bf16 v[160:175], a[216:219], v[120:127], v150
    v_exp_f32 v136, v136
    v_exp_f32 v137, v137
    v_exp_f32 v138, v138
    v_mfma_f32_16x16x32_bf16 v[64:67], v[92:95], v[20:23], v[64:67]
    v_exp_f32 v139, v139
    v_smfmac_f32_32x32x32_bf16 v[176:191], a[212:215], v[128:135], v150
    v_exp_f32 v140, v140
    v_exp_f32 v141, v141
    v_exp_f32 v142, v142
    v_mfma_f32_16x16x32_bf16 a[96:99], v[32:35], v[16:19], a[96:99]
    v_exp_f32 v143, v143
    v_mfma_f32_32x32x16_bf16 v[112:127], a[192:195], a[150:153], 0
    global_load_dwordx4 v[20:23], v5, s[18:19] offset:-4096 sc1
    v_exp_f32 v96, v96
    v_exp_f32 v97, v97
    v_exp_f32 v98, v98
    v_mfma_f32_16x16x32_bf16 a[100:103], v[36:39], v[16:19], a[100:103]
    global_load_dwordx4 v[92:95], v2, s[18:19] offset:-2048 sc1
    v_exp_f32 v99, v99
    v_mfma_f32_32x32x8_bf16 v[112:127], a[196:197], a[154:155], v[112:127]
    v_exp_f32 v100, v100
    v_exp_f32 v101, v101
    v_exp_f32 v102, v102
    v_exp_f32 v103, v103
    v_smfmac_f32_32x32x32_bf16 v[176:191], a[216:219], v[136:143], v150
    s_add_u32 m0, s48, 28672
    s_add_u32 s4, s71, 13312
    buffer_load_dwordx4 v1, s[12:15], s4 offen offset:0 sc1 lds
    v_exp_f32 v104, v104
    v_exp_f32 v105, v105
    v_exp_f32 v106, v106
    v_mfma_f32_16x16x32_bf16 a[104:107], v[40:43], v[16:19], a[104:107]
    v_exp_f32 v107, v107
    v_smfmac_f32_32x32x32_bf16 a[0:15], a[204:207], v[96:103], v150
    v_exp_f32 v108, v108
    v_exp_f32 v109, v109
    v_exp_f32 v110, v110
    v_mfma_f32_16x16x32_bf16 a[108:111], v[44:47], v[16:19], a[108:111]
    v_exp_f32 v111, v111
    v_mfma_f32_32x32x16_bf16 v[128:143], a[192:195], a[156:159], 0
    v_exp_f32 v112, v112
    v_exp_f32 v113, v113
    v_exp_f32 v114, v114
    v_exp_f32 v115, v115
    v_mfma_f32_32x32x8_bf16 v[128:143], a[196:197], a[160:161], v[128:143]
    v_exp_f32 v116, v116
    v_exp_f32 v117, v117
    v_exp_f32 v118, v118
    v_exp_f32 v119, v119
    v_smfmac_f32_32x32x32_bf16 a[0:15], a[208:211], v[104:111], v150
    v_exp_f32 v120, v120
    v_exp_f32 v121, v121
    v_exp_f32 v122, v122
    v_mfma_f32_16x16x32_bf16 a[112:115], v[192:195], v[16:19], a[112:115]
    global_load_dwordx4 v[16:19], v3, s[18:19] offset:-2048 sc1
    v_exp_f32 v123, v123
    v_smfmac_f32_32x32x32_bf16 a[16:31], a[204:207], v[112:119], v150
    v_exp_f32 v124, v124
    v_exp_f32 v125, v125
    v_exp_f32 v126, v126
    v_mfma_f32_16x16x32_bf16 a[116:119], v[32:35], v[24:27], a[116:119]
    v_exp_f32 v127, v127
    v_mfma_f32_32x32x16_bf16 v[96:111], a[192:195], a[162:165], 0
    v_exp_f32 v128, v128
    v_exp_f32 v129, v129
    v_exp_f32 v130, v130
    v_mfma_f32_16x16x32_bf16 a[120:123], v[36:39], v[24:27], a[120:123]
    v_exp_f32 v131, v131
    v_mfma_f32_32x32x8_bf16 v[96:111], a[196:197], a[166:167], v[96:111]
    v_exp_f32 v132, v132
    v_exp_f32 v133, v133
    v_exp_f32 v134, v134
    v_exp_f32 v135, v135
    v_smfmac_f32_32x32x32_bf16 a[16:31], a[208:211], v[120:127], v150
    v_exp_f32 v136, v136
    v_exp_f32 v137, v137
    v_exp_f32 v138, v138
    v_mfma_f32_16x16x32_bf16 a[124:127], v[40:43], v[24:27], a[124:127]
    v_exp_f32 v139, v139
    v_smfmac_f32_32x32x32_bf16 a[32:47], a[204:207], v[128:135], v150
    v_exp_f32 v140, v140
    v_exp_f32 v141, v141
    v_exp_f32 v142, v142
    v_mfma_f32_16x16x32_bf16 a[128:131], v[44:47], v[24:27], a[128:131]
    v_exp_f32 v143, v143
    v_mfma_f32_32x32x16_bf16 v[112:127], a[192:195], a[168:171], 0
    ds_read_b64_tr_b16 a[212:213], v148 offset:0
    ds_read_b64_tr_b16 a[214:215], v148 offset:64
    ds_read_b64_tr_b16 a[216:217], v148 offset:256
    ds_read_b64_tr_b16 a[218:219], v148 offset:320
    v_exp_f32 v96, v96
    v_exp_f32 v97, v97
    v_exp_f32 v98, v98
    v_mfma_f32_16x16x32_bf16 a[132:135], v[192:195], v[24:27], a[132:135]
    global_load_dwordx4 v[24:27], v4, s[18:19] offset:-2048 sc1
    v_exp_f32 v99, v99
    v_mfma_f32_32x32x8_bf16 v[112:127], a[196:197], a[172:173], v[112:127]
    v_exp_f32 v100, v100
    v_exp_f32 v101, v101
    v_exp_f32 v102, v102
    v_exp_f32 v103, v103
    v_smfmac_f32_32x32x32_bf16 a[32:47], a[208:211], v[136:143], v150
    s_add_u32 m0, s48, 29696
    s_add_u32 s4, s71, 14336
    buffer_load_dwordx4 v1, s[12:15], s4 offen offset:0 sc1 lds
    v_exp_f32 v104, v104
    v_exp_f32 v105, v105
    v_exp_f32 v106, v106
    v_mfma_f32_16x16x32_bf16 a[136:139], v[32:35], v[28:31], a[136:139]
    v_exp_f32 v107, v107
    v_smfmac_f32_32x32x32_bf16 a[48:63], a[204:207], v[96:103], v150
    v_exp_f32 v108, v108
    v_exp_f32 v109, v109
    v_exp_f32 v110, v110
    v_mfma_f32_16x16x32_bf16 a[140:143], v[36:39], v[28:31], a[140:143]
    v_exp_f32 v111, v111
    v_mfma_f32_32x32x16_bf16 v[128:143], a[192:195], a[174:177], 0
    s_waitcnt lgkmcnt(0)
    v_exp_f32 v112, v112
    v_exp_f32 v113, v113
    v_exp_f32 v114, v114
    v_exp_f32 v115, v115
    v_mfma_f32_32x32x8_bf16 v[128:143], a[196:197], a[178:179], v[128:143]
    v_exp_f32 v116, v116
    v_exp_f32 v117, v117
    v_exp_f32 v118, v118
    v_exp_f32 v119, v119
    v_smfmac_f32_32x32x32_bf16 a[48:63], a[208:211], v[104:111], v150
    v_exp_f32 v120, v120
    v_exp_f32 v121, v121
    v_exp_f32 v122, v122
    v_mfma_f32_16x16x32_bf16 a[220:223], v[40:43], v[28:31], a[220:223]
    v_exp_f32 v123, v123
    v_smfmac_f32_32x32x32_bf16 a[64:79], a[204:207], v[112:119], v150
    s_add_u32 m0, s48, 37888
    v_exp_f32 v124, v124
    v_exp_f32 v125, v125
    v_exp_f32 v126, v126
    v_mfma_f32_16x16x32_bf16 a[224:227], v[44:47], v[28:31], a[224:227]
    v_exp_f32 v127, v127
    v_mfma_f32_32x32x16_bf16 v[96:111], a[192:195], a[180:183], 0
    global_load_lds_dwordx4 v146, s[16:17] offset:0 sc1
    global_load_lds_dwordx4 v146, s[16:17] offset:1024 sc1
    v_exp_f32 v128, v128
    v_exp_f32 v129, v129
    v_exp_f32 v130, v130
    v_mfma_f32_16x16x32_bf16 a[228:231], v[192:195], v[28:31], a[228:231]
    global_load_dwordx4 v[28:31], v1, s[20:21] offset:1024 sc1
    v_exp_f32 v131, v131
    v_mfma_f32_32x32x8_bf16 v[96:111], a[196:197], a[184:185], v[96:111]
    v_exp_f32 v132, v132
    v_exp_f32 v133, v133
    v_exp_f32 v134, v134
    v_exp_f32 v135, v135
    v_smfmac_f32_32x32x32_bf16 a[64:79], a[208:211], v[120:127], v150
    v_exp_f32 v136, v136
    v_exp_f32 v137, v137
    v_exp_f32 v138, v138
    v_mfma_f32_16x16x32_bf16 v[48:51], v[32:35], v[200:203], v[48:51]
    global_load_dwordx4 v[32:35], v1, s[20:21] offset:2048 sc1
    v_exp_f32 v139, v139
    v_smfmac_f32_32x32x32_bf16 a[80:95], a[204:207], v[128:135], v150
    v_exp_f32 v140, v140
    v_exp_f32 v141, v141
    v_exp_f32 v142, v142
    v_mfma_f32_16x16x32_bf16 v[52:55], v[36:39], v[200:203], v[52:55]
    v_exp_f32 v143, v143
    v_mfma_f32_32x32x16_bf16 v[112:127], a[192:195], a[186:189], 0
    global_load_dwordx4 v[36:39], v1, s[20:21] offset:3072 sc1
    v_exp_f32 v96, v96
    v_exp_f32 v97, v97
    v_exp_f32 v98, v98
    v_mfma_f32_16x16x32_bf16 v[56:59], v[40:43], v[200:203], v[56:59]
    s_add_u32 s20, s20, 8192
    s_addc_u32 s21, s21, 0
    global_load_dwordx4 v[40:43], v1, s[20:21] offset:-4096 sc1
    v_exp_f32 v99, v99
    v_mfma_f32_32x32x8_bf16 v[112:127], a[196:197], a[190:191], v[112:127]
    v_exp_f32 v100, v100
    v_exp_f32 v101, v101
    v_exp_f32 v102, v102
    v_exp_f32 v103, v103
    v_smfmac_f32_32x32x32_bf16 a[80:95], a[208:211], v[136:143], v150
    s_add_u32 m0, s48, 30720
    s_add_u32 s4, s71, 15360
    buffer_load_dwordx4 v1, s[12:15], s4 offen offset:0 sc1 lds
    v_exp_f32 v104, v104
    v_exp_f32 v105, v105
    v_exp_f32 v106, v106
    v_mfma_f32_16x16x32_bf16 v[60:63], v[44:47], v[200:203], v[60:63]
    v_exp_f32 v107, v107
    v_smfmac_f32_32x32x32_bf16 v[160:175], a[204:207], v[96:103], v150
    s_waitcnt vmcnt(15)
    global_load_dwordx4 a[192:195], v144, s[16:17] offset:0 sc1
    global_load_dwordx2 a[196:197], v145, s[16:17] offset:0 sc1
    v_exp_f32 v108, v108
    v_exp_f32 v109, v109
    v_exp_f32 v110, v110
    v_mfma_f32_16x16x32_bf16 v[64:67], v[192:195], v[200:203], v[64:67]
    v_exp_f32 v111, v111
    v_mfma_f32_32x32x16_bf16 v[128:143], a[198:201], a[144:147], 0
    s_add_u32 s16, s16, 123904
    s_addc_u32 s17, s17, 0
    v_exp_f32 v112, v112
    v_exp_f32 v113, v113
    v_exp_f32 v114, v114
    v_exp_f32 v115, v115
    v_mfma_f32_32x32x8_bf16 v[128:143], a[202:203], a[148:149], v[128:143]
    v_exp_f32 v116, v116
    v_exp_f32 v117, v117
    v_exp_f32 v118, v118
    v_exp_f32 v119, v119
    v_smfmac_f32_32x32x32_bf16 v[160:175], a[208:211], v[104:111], v150
    global_load_dwordx4 v[44:47], v1, s[20:21] offset:-3072 sc1
    v_exp_f32 v120, v120
    v_exp_f32 v121, v121
    v_exp_f32 v122, v122
    v_mfma_f32_16x16x32_bf16 a[96:99], v[212:215], v[196:199], a[96:99]
    global_load_dwordx4 v[200:203], v5, s[18:19] offset:-2048 sc1
    v_exp_f32 v123, v123
    v_smfmac_f32_32x32x32_bf16 v[176:191], a[204:207], v[112:119], v150
    v_exp_f32 v124, v124
    v_exp_f32 v125, v125
    v_exp_f32 v126, v126
    v_mfma_f32_16x16x32_bf16 a[100:103], v[216:219], v[196:199], a[100:103]
    v_exp_f32 v127, v127
    v_mfma_f32_32x32x16_bf16 v[96:111], a[198:201], a[150:153], 0
    global_load_dwordx4 v[192:195], v2, s[18:19] offset:0 sc1
    v_exp_f32 v128, v128
    v_exp_f32 v129, v129
    v_exp_f32 v130, v130
    v_mfma_f32_16x16x32_bf16 a[104:107], v[220:223], v[196:199], a[104:107]
    v_exp_f32 v131, v131
    v_mfma_f32_32x32x8_bf16 v[96:111], a[202:203], a[154:155], v[96:111]
    v_exp_f32 v132, v132
    v_exp_f32 v133, v133
    v_exp_f32 v134, v134
    v_exp_f32 v135, v135
    v_smfmac_f32_32x32x32_bf16 v[176:191], a[208:211], v[120:127], v150
    v_exp_f32 v136, v136
    v_exp_f32 v137, v137
    v_exp_f32 v138, v138
    v_mfma_f32_16x16x32_bf16 a[108:111], v[224:227], v[196:199], a[108:111]
    v_exp_f32 v139, v139
    v_smfmac_f32_32x32x32_bf16 a[0:15], a[212:215], v[128:135], v150
    v_exp_f32 v140, v140
    v_exp_f32 v141, v141
    v_exp_f32 v142, v142
    v_mfma_f32_16x16x32_bf16 a[112:115], v[228:231], v[196:199], a[112:115]
    global_load_dwordx4 v[196:199], v3, s[18:19] offset:0 sc1
    v_exp_f32 v143, v143
    v_mfma_f32_32x32x16_bf16 v[112:127], a[198:201], a[156:159], 0
    v_exp_f32 v96, v96
    v_exp_f32 v97, v97
    v_exp_f32 v98, v98
    v_mfma_f32_16x16x32_bf16 a[116:119], v[212:215], v[204:207], a[116:119]
    v_exp_f32 v99, v99
    v_mfma_f32_32x32x8_bf16 v[112:127], a[202:203], a[160:161], v[112:127]
    v_exp_f32 v100, v100
    v_exp_f32 v101, v101
    v_exp_f32 v102, v102
    v_exp_f32 v103, v103
    v_smfmac_f32_32x32x32_bf16 a[0:15], a[216:219], v[136:143], v150
L_pad12:
    s_cbranch_execz L_back
    s_add_u32 m0, s48, 31744
    s_add_u32 s4, s71, 16384
    buffer_load_dwordx4 v1, s[12:15], s4 offen offset:0 sc1 lds
    v_exp_f32 v104, v104
    v_exp_f32 v105, v105
    v_exp_f32 v106, v106
    v_mfma_f32_16x16x32_bf16 a[120:123], v[216:219], v[204:207], a[120:123]
    v_exp_f32 v107, v107
    v_smfmac_f32_32x32x32_bf16 a[16:31], a[212:215], v[96:103], v150
    v_exp_f32 v108, v108
    v_exp_f32 v109, v109
    v_exp_f32 v110, v110
    v_mfma_f32_16x16x32_bf16 a[124:127], v[220:223], v[204:207], a[124:127]
    v_exp_f32 v111, v111
    v_mfma_f32_32x32x16_bf16 v[128:143], a[198:201], a[162:165], 0
    v_exp_f32 v112, v112
    v_exp_f32 v113, v113
    v_exp_f32 v114, v114
    v_exp_f32 v115, v115
    v_mfma_f32_32x32x8_bf16 v[128:143], a[202:203], a[166:167], v[128:143]
    v_exp_f32 v116, v116
    v_exp_f32 v117, v117
    v_exp_f32 v118, v118
    v_exp_f32 v119, v119
    v_smfmac_f32_32x32x32_bf16 a[16:31], a[216:219], v[104:111], v150
    v_exp_f32 v120, v120
    v_exp_f32 v121, v121
    v_exp_f32 v122, v122
    v_mfma_f32_16x16x32_bf16 a[128:131], v[224:227], v[204:207], a[128:131]
    v_exp_f32 v123, v123
    v_smfmac_f32_32x32x32_bf16 a[32:47], a[212:215], v[112:119], v150
    v_exp_f32 v124, v124
    v_exp_f32 v125, v125
    v_exp_f32 v126, v126
    v_mfma_f32_16x16x32_bf16 a[132:135], v[228:231], v[204:207], a[132:135]
    global_load_dwordx4 v[204:207], v4, s[18:19] offset:0 sc1
    v_exp_f32 v127, v127
    v_mfma_f32_32x32x16_bf16 v[96:111], a[198:201], a[168:171], 0
    ds_read_b64_tr_b16 a[204:205], v147 offset:0
    ds_read_b64_tr_b16 a[206:207], v147 offset:64
    ds_read_b64_tr_b16 a[208:209], v147 offset:256
    ds_read_b64_tr_b16 a[210:211], v147 offset:320
    v_exp_f32 v128, v128
    v_exp_f32 v129, v129
    v_exp_f32 v130, v130
    v_mfma_f32_16x16x32_bf16 a[136:139], v[212:215], v[208:211], a[136:139]
    v_exp_f32 v131, v131
    v_mfma_f32_32x32x8_bf16 v[96:111], a[202:203], a[172:173], v[96:111]
    v_exp_f32 v132, v132
    v_exp_f32 v133, v133
    v_exp_f32 v134, v134
    v_exp_f32 v135, v135
    v_smfmac_f32_32x32x32_bf16 a[32:47], a[216:219], v[120:127], v150
    v_exp_f32 v136, v136
    v_exp_f32 v137, v137
    v_exp_f32 v138, v138
    v_mfma_f32_16x16x32_bf16 a[140:143], v[216:219], v[208:211], a[140:143]
    v_exp_f32 v139, v139
    v_smfmac_f32_32x32x32_bf16 a[48:63], a[212:215], v[128:135], v150
    v_exp_f32 v140, v140
    v_exp_f32 v141, v141
    v_exp_f32 v142, v142
    v_mfma_f32_16x16x32_bf16 a[220:223], v[220:223], v[208:211], a[220:223]
    v_exp_f32 v143, v143
    v_mfma_f32_32x32x16_bf16 v[112:127], a[198:201], a[174:177], 0
    s_waitcnt lgkmcnt(0)
    v_exp_f32 v96, v96
    v_exp_f32 v97, v97
    v_exp_f32 v98, v98
    v_mfma_f32_16x16x32_bf16 a[224:227], v[224:227], v[208:211], a[224:227]
    v_exp_f32 v99, v99
    v_mfma_f32_32x32x8_bf16 v[112:127], a[202:203], a[178:179], v[112:127]
    v_exp_f32 v100, v100
    v_exp_f32 v101, v101
    v_exp_f32 v102, v102
    v_exp_f32 v103, v103
    v_smfmac_f32_32x32x32_bf16 a[48:63], a[216:219], v[136:143], v150
    s_add_u32 m0, s48, 32768
    s_add_u32 s4, s71, 17408
    buffer_load_dwordx4 v1, s[12:15], s4 offen offset:0 sc1 lds
    v_exp_f32 v104, v104
    v_exp_f32 v105, v105
    v_exp_f32 v106, v106
    v_mfma_f32_16x16x32_bf16 a[228:231], v[228:231], v[208:211], a[228:231]
    global_load_dwordx4 v[208:211], v1, s[20:21] offset:-2048 sc1
    v_exp_f32 v107, v107
    v_smfmac_f32_32x32x32_bf16 a[64:79], a[212:215], v[96:103], v150
    v_exp_f32 v108, v108
    v_exp_f32 v109, v109
    v_exp_f32 v110, v110
    v_mfma_f32_16x16x32_bf16 v[48:51], v[212:215], v[236:239], v[48:51]
    global_load_dwordx4 v[212:215], v1, s[20:21] offset:-1024 sc1
    v_exp_f32 v111, v111
    v_mfma_f32_32x32x16_bf16 v[128:143], a[198:201], a[180:183], 0
    v_exp_f32 v112, v112
    v_exp_f32 v113, v113
    v_exp_f32 v114, v114
    v_exp_f32 v115, v115
    v_mfma_f32_32x32x8_bf16 v[128:143], a[202:203], a[184:185], v[128:143]
    v_exp_f32 v116, v116
    v_exp_f32 v117, v117
    v_exp_f32 v118, v118
    v_exp_f32 v119, v119
    v_smfmac_f32_32x32x32_bf16 a[64:79], a[216:219], v[104:111], v150
    v_exp_f32 v120, v120
    v_exp_f32 v121, v121
    v_exp_f32 v122, v122
    v_mfma_f32_16x16x32_bf16 v[52:55], v[216:219], v[236:239], v[52:55]
    global_load_dwordx4 v[216:219], v1, s[20:21] offset:0 sc1
    v_exp_f32 v123, v123
    v_smfmac_f32_32x32x32_bf16 a[80:95], a[212:215], v[112:119], v150
    v_exp_f32 v124, v124
    v_exp_f32 v125, v125
    v_exp_f32 v126, v126
    v_mfma_f32_16x16x32_bf16 v[56:59], v[220:223], v[236:239], v[56:59]
    global_load_dwordx4 v[220:223], v1, s[20:21] offset:1024 sc1
    v_exp_f32 v127, v127
    v_mfma_f32_32x32x16_bf16 v[96:111], a[198:201], a[186:189], 0
    v_exp_f32 v128, v128
    v_exp_f32 v129, v129
    v_exp_f32 v130, v130
    v_mfma_f32_16x16x32_bf16 v[60:63], v[224:227], v[236:239], v[60:63]
    global_load_dwordx4 v[224:227], v1, s[20:21] offset:2048 sc1
    v_exp_f32 v131, v131
    v_mfma_f32_32x32x8_bf16 v[96:111], a[202:203], a[190:191], v[96:111]
    v_exp_f32 v132, v132
    v_exp_f32 v133, v133
    v_exp_f32 v134, v134
    v_exp_f32 v135, v135
    v_smfmac_f32_32x32x32_bf16 a[80:95], a[216:219], v[120:127], v150
    v_exp_f32 v136, v136
    v_exp_f32 v137, v137
    v_exp_f32 v138, v138
    v_mfma_f32_16x16x32_bf16 v[64:67], v[228:231], v[236:239], v[64:67]
    global_load_dwordx4 v[236:239], v5, s[18:19] offset:0 sc1
    v_exp_f32 v139, v139
    v_smfmac_f32_32x32x32_bf16 v[160:175], a[212:215], v[128:135], v150
    s_waitcnt vmcnt(13)
    global_load_dwordx4 a[198:201], v144, s[16:17] offset:0 sc1
    global_load_dwordx2 a[202:203], v145, s[16:17] offset:0 sc1
    v_exp_f32 v140, v140
    v_exp_f32 v141, v141
    v_exp_f32 v142, v142
    v_mfma_f32_16x16x32_bf16 a[96:99], v[248:251], v[232:235], a[96:99]
    v_exp_f32 v143, v143
    v_mfma_f32_32x32x16_bf16 v[112:127], a[192:195], a[144:147], 0
    global_load_dwordx4 v[228:231], v2, s[18:19] offset:2048 sc1
    v_exp_f32 v96, v96
    v_exp_f32 v97, v97
    v_exp_f32 v98, v98
    v_mfma_f32_16x16x32_bf16 a[100:103], v[252:255], v[232:235], a[100:103]
    v_exp_f32 v99, v99
    v_mfma_f32_32x32x8_bf16 v[112:127], a[196:197], a[148:149], v[112:127]
    v_exp_f32 v100, v100
    v_exp_f32 v101, v101
    v_exp_f32 v102, v102
    v_exp_f32 v103, v103
    v_smfmac_f32_32x32x32_bf16 v[160:175], a[216:219], v[136:143], v150
    s_add_u32 m0, s48, 33792
    s_add_u32 s4, s71, 18432
    buffer_load_dwordx4 v1, s[12:15], s4 offen offset:0 sc1 lds
    v_exp_f32 v104, v104
    v_exp_f32 v105, v105
    v_exp_f32 v106, v106
    v_mfma_f32_16x16x32_bf16 a[104:107], a[232:235], v[232:235], a[104:107]
    v_exp_f32 v107, v107
    v_smfmac_f32_32x32x32_bf16 v[176:191], a[212:215], v[96:103], v150
    v_exp_f32 v108, v108
    v_exp_f32 v109, v109
    v_exp_f32 v110, v110
    v_mfma_f32_16x16x32_bf16 a[108:111], a[236:239], v[232:235], a[108:111]
    v_exp_f32 v111, v111
    v_mfma_f32_32x32x16_bf16 v[128:143], a[192:195], a[150:153], 0
    v_exp_f32 v112, v112
    v_exp_f32 v113, v113
    v_exp_f32 v114, v114
    v_exp_f32 v115, v115
    v_mfma_f32_32x32x8_bf16 v[128:143], a[196:197], a[154:155], v[128:143]
    v_exp_f32 v116, v116
    v_exp_f32 v117, v117
    v_exp_f32 v118, v118
    v_exp_f32 v119, v119
    v_smfmac_f32_32x32x32_bf16 v[176:191], a[216:219], v[104:111], v150
    v_exp_f32 v120, v120
    v_exp_f32 v121, v121
    v_exp_f32 v122, v122
    v_mfma_f32_16x16x32_bf16 a[112:115], a[240:243], v[232:235], a[112:115]
    global_load_dwordx4 v[232:235], v3, s[18:19] offset:2048 sc1
    v_exp_f32 v123, v123
    v_smfmac_f32_32x32x32_bf16 a[0:15], a[204:207], v[112:119], v150
    v_exp_f32 v124, v124
    v_exp_f32 v125, v125
    v_exp_f32 v126, v126
    v_mfma_f32_16x16x32_bf16 a[116:119], v[248:251], v[240:243], a[116:119]
    v_exp_f32 v127, v127
    v_mfma_f32_32x32x16_bf16 v[96:111], a[192:195], a[156:159], 0
    v_exp_f32 v128, v128
    v_exp_f32 v129, v129
    v_exp_f32 v130, v130
    v_mfma_f32_16x16x32_bf16 a[120:123], v[252:255], v[240:243], a[120:123]
    v_exp_f32 v131, v131
    v_mfma_f32_32x32x8_bf16 v[96:111], a[196:197], a[160:161], v[96:111]
    v_exp_f32 v132, v132
    v_exp_f32 v133, v133
    v_exp_f32 v134, v134
    v_exp_f32 v135, v135
    v_smfmac_f32_32x32x32_bf16 a[0:15], a[208:211], v[120:127], v150
    v_exp_f32 v136, v136
    v_exp_f32 v137, v137
    v_exp_f32 v138, v138
    v_mfma_f32_16x16x32_bf16 a[124:127], a[232:235], v[240:243], a[124:127]
    v_exp_f32 v139, v139
    v_smfmac_f32_32x32x32_bf16 a[16:31], a[204:207], v[128:135], v150
    v_exp_f32 v140, v140
    v_exp_f32 v141, v141
    v_exp_f32 v142, v142
    v_mfma_f32_16x16x32_bf16 a[128:131], a[236:239], v[240:243], a[128:131]
    v_exp_f32 v143, v143
    v_mfma_f32_32x32x16_bf16 v[112:127], a[192:195], a[162:165], 0
    v_exp_f32 v96, v96
    v_exp_f32 v97, v97
    v_exp_f32 v98, v98
    v_mfma_f32_16x16x32_bf16 a[132:135], a[240:243], v[240:243], a[132:135]
    global_load_dwordx4 v[240:243], v4, s[18:19] offset:2048 sc1
    v_exp_f32 v99, v99
    v_mfma_f32_32x32x8_bf16 v[112:127], a[196:197], a[166:167], v[112:127]
    v_exp_f32 v100, v100
    v_exp_f32 v101, v101
    v_exp_f32 v102, v102
    v_exp_f32 v103, v103
    v_smfmac_f32_32x32x32_bf16 a[16:31], a[208:211], v[136:143], v150
    s_add_u32 m0, s48, 34816
    s_add_u32 s4, s71, 19456
    buffer_load_dwordx4 v1, s[12:15], s4 offen offset:0 sc1 lds
    v_exp_f32 v104, v104
    v_exp_f32 v105, v105
    v_exp_f32 v106, v106
    v_mfma_f32_16x16x32_bf16 a[136:139], v[248:251], v[244:247], a[136:139]
    v_exp_f32 v107, v107
    v_smfmac_f32_32x32x32_bf16 a[32:47], a[204:207], v[96:103], v150
    v_exp_f32 v108, v108
    v_exp_f32 v109, v109
    v_exp_f32 v110, v110
    v_mfma_f32_16x16x32_bf16 a[140:143], v[252:255], v[244:247], a[140:143]
    v_exp_f32 v111, v111
    v_mfma_f32_32x32x16_bf16 v[128:143], a[192:195], a[168:171], 0
    ds_read_b64_tr_b16 a[212:213], v148 offset:0
    ds_read_b64_tr_b16 a[214:215], v148 offset:64
    ds_read_b64_tr_b16 a[216:217], v148 offset:256
    ds_read_b64_tr_b16 a[218:219], v148 offset:320
    v_exp_f32 v112, v112
    v_exp_f32 v113, v113
    v_exp_f32 v114, v114
    v_exp_f32 v115, v115
    v_mfma_f32_32x32x8_bf16 v[128:143], a[196:197], a[172:173], v[128:143]
    v_exp_f32 v116, v116
    v_exp_f32 v117, v117
    v_exp_f32 v118, v118
    v_exp_f32 v119, v119
    v_smfmac_f32_32x32x32_bf16 a[32:47], a[208:211], v[104:111], v150
    v_exp_f32 v120, v120
    v_exp_f32 v121, v121
    v_exp_f32 v122, v122
    v_mfma_f32_16x16x32_bf16 a[220:223], a[232:235], v[244:247], a[220:223]
    v_exp_f32 v123, v123
    v_smfmac_f32_32x32x32_bf16 a[48:63], a[204:207], v[112:119], v150
    v_exp_f32 v124, v124
    v_exp_f32 v125, v125
    v_exp_f32 v126, v126
    v_mfma_f32_16x16x32_bf16 a[224:227], a[236:239], v[244:247], a[224:227]
    v_exp_f32 v127, v127
    v_mfma_f32_32x32x16_bf16 v[96:111], a[192:195], a[174:177], 0
    s_waitcnt lgkmcnt(0)
    v_exp_f32 v128, v128
    v_exp_f32 v129, v129
    v_exp_f32 v130, v130
    v_mfma_f32_16x16x32_bf16 a[228:231], a[240:243], v[244:247], a[228:231]
    global_load_dwordx4 v[244:247], v1, s[20:21] offset:3072 sc1
    v_exp_f32 v131, v131
    v_mfma_f32_32x32x8_bf16 v[96:111], a[196:197], a[178:179], v[96:111]
    v_exp_f32 v132, v132
    v_exp_f32 v133, v133
    v_exp_f32 v134, v134
    v_exp_f32 v135, v135
    v_smfmac_f32_32x32x32_bf16 a[48:63], a[208:211], v[120:127], v150
    v_exp_f32 v136, v136
    v_exp_f32 v137, v137
    v_exp_f32 v138, v138
    v_mfma_f32_16x16x32_bf16 v[48:51], v[248:251], a[248:251], v[48:51]
    s_add_u32 s20, s20, 8192
    s_addc_u32 s21, s21, 0
    global_load_dwordx4 v[248:251], v1, s[20:21] offset:-4096 sc1
    v_exp_f32 v139, v139
    v_smfmac_f32_32x32x32_bf16 a[64:79], a[204:207], v[128:135], v150
    v_exp_f32 v140, v140
    v_exp_f32 v141, v141
    v_exp_f32 v142, v142
    v_mfma_f32_16x16x32_bf16 v[52:55], v[252:255], a[248:251], v[52:55]
    v_exp_f32 v143, v143
    v_mfma_f32_32x32x16_bf16 v[112:127], a[192:195], a[180:183], 0
    global_load_dwordx4 v[252:255], v1, s[20:21] offset:-3072 sc1
    v_exp_f32 v96, v96
    v_exp_f32 v97, v97
    v_exp_f32 v98, v98
    v_mfma_f32_16x16x32_bf16 v[56:59], a[232:235], a[248:251], v[56:59]
    global_load_dwordx4 a[232:235], v1, s[20:21] offset:-2048 sc1
    v_exp_f32 v99, v99
    v_mfma_f32_32x32x8_bf16 v[112:127], a[196:197], a[184:185], v[112:127]
    v_exp_f32 v100, v100
    v_exp_f32 v101, v101
    v_exp_f32 v102, v102
    v_exp_f32 v103, v103
    v_smfmac_f32_32x32x32_bf16 a[64:79], a[208:211], v[136:143], v150
    v_exp_f32 v104, v104
    v_exp_f32 v105, v105
    v_exp_f32 v106, v106
    v_mfma_f32_16x16x32_bf16 v[60:63], a[236:239], a[248:251], v[60:63]
    v_exp_f32 v107, v107
    v_smfmac_f32_32x32x32_bf16 a[80:95], a[204:207], v[96:103], v150
    v_exp_f32 v108, v108
    v_exp_f32 v109, v109
    v_exp_f32 v110, v110
    v_mfma_f32_16x16x32_bf16 v[64:67], a[240:243], a[248:251], v[64:67]
    v_exp_f32 v111, v111
    v_mfma_f32_32x32x16_bf16 v[128:143], a[192:195], a[186:189], 0
    global_load_dwordx4 a[236:239], v1, s[20:21] offset:-1024 sc1
    v_exp_f32 v112, v112
    v_exp_f32 v113, v113
    v_exp_f32 v114, v114
    v_exp_f32 v115, v115
    v_mfma_f32_32x32x8_bf16 v[128:143], a[196:197], a[190:191], v[128:143]
    v_exp_f32 v116, v116
    v_exp_f32 v117, v117
    v_exp_f32 v118, v118
    v_exp_f32 v119, v119
    v_smfmac_f32_32x32x32_bf16 a[80:95], a[208:211], v[104:111], v150
    s_add_u32 m0, s48, 35840
    s_add_u32 s4, s71, 20480
    buffer_load_dwordx4 v1, s[12:15], s4 offen offset:0 sc1 lds
    v_exp_f32 v120, v120
    v_exp_f32 v121, v121
    v_exp_f32 v122, v122
    v_exp_f32 v123, v123
    v_smfmac_f32_32x32x32_bf16 v[160:175], a[204:207], v[112:119], v150
    s_waitcnt vmcnt(11)
    global_load_dwordx4 a[248:251], v5, s[18:19] offset:2048 sc1
    v_exp_f32 v124, v124
    v_exp_f32 v125, v125
    v_exp_f32 v126, v126
    v_exp_f32 v127, v127
    v_mfma_f32_32x32x16_bf16 v[96:111], a[198:201], a[144:147], 0
    buffer_load_dwordx4 a[192:195], v11, s[8:11], s72 offen offset:0
    v_exp_f32 v128, v128
    v_exp_f32 v129, v129
    v_exp_f32 v130, v130
    v_exp_f32 v131, v131
    v_mfma_f32_32x32x8_bf16 v[96:111], a[202:203], a[148:149], v[96:111]
    v_exp_f32 v132, v132
    v_exp_f32 v133, v133
    v_exp_f32 v134, v134
    v_exp_f32 v135, v135
    v_smfmac_f32_32x32x32_bf16 v[160:175], a[208:211], v[120:127], v150
    buffer_load_dwordx4 v1, s[12:15], s4 offen offset:1024 sc1 lds
    v_exp_f32 v136, v136
    v_exp_f32 v137, v137
    v_exp_f32 v138, v138
    v_exp_f32 v139, v139
    v_smfmac_f32_32x32x32_bf16 v[176:191], a[204:207], v[128:135], v150
    v_exp_f32 v140, v140
    v_exp_f32 v141, v141
    v_exp_f32 v142, v142
    v_exp_f32 v143, v143
    v_mfma_f32_32x32x16_bf16 v[112:127], a[198:201], a[150:153], 0
    buffer_load_dwordx2 a[196:197], v11, s[8:11], s72 offen offset:32
    v_exp_f32 v96, v96
    v_exp_f32 v97, v97
    v_exp_f32 v98, v98
    v_exp_f32 v99, v99
    v_mfma_f32_32x32x8_bf16 v[112:127], a[202:203], a[154:155], v[112:127]
    v_exp_f32 v100, v100
    v_exp_f32 v101, v101
    v_exp_f32 v102, v102
    v_exp_f32 v103, v103
    v_smfmac_f32_32x32x32_bf16 v[176:191], a[208:211], v[136:143], v150
    buffer_load_dwordx4 v1, s[12:15], s4 offen offset:2048 sc1 lds
    v_exp_f32 v104, v104
    v_exp_f32 v105, v105
    v_exp_f32 v106, v106
    v_exp_f32 v107, v107
    v_smfmac_f32_32x32x32_bf16 a[0:15], a[212:215], v[96:103], v150
    v_exp_f32 v108, v108
    v_exp_f32 v109, v109
    v_exp_f32 v110, v110
    v_exp_f32 v111, v111
    v_mfma_f32_32x32x16_bf16 v[128:143], a[198:201], a[156:159], 0
    buffer_load_dwordx4 a[204:207], v11, s[8:11], s72 offen offset:16
    v_exp_f32 v112, v112
    v_exp_f32 v113, v113
    v_exp_f32 v114, v114
    v_exp_f32 v115, v115
    v_mfma_f32_32x32x8_bf16 v[128:143], a[202:203], a[160:161], v[128:143]
    v_exp_f32 v116, v116
    v_exp_f32 v117, v117
    v_exp_f32 v118, v118
    v_exp_f32 v119, v119
    v_smfmac_f32_32x32x32_bf16 a[0:15], a[216:219], v[104:111], v150
    buffer_load_dwordx4 v1, s[12:15], s4 offen offset:3072 sc1 lds
    v_exp_f32 v120, v120
    v_exp_f32 v121, v121
    v_exp_f32 v122, v122
    v_exp_f32 v123, v123
    v_smfmac_f32_32x32x32_bf16 a[16:31], a[212:215], v[112:119], v150
    s_add_u32 m0, s48, 39936
    s_add_u32 s4, s71, 24576
    buffer_load_dwordx4 v1, s[12:15], s4 offen offset:0 sc1 lds
    v_exp_f32 v124, v124
    v_exp_f32 v125, v125
    v_exp_f32 v126, v126
    v_exp_f32 v127, v127
    v_mfma_f32_32x32x16_bf16 v[96:111], a[198:201], a[162:165], 0
    v_exp_f32 v128, v128
    v_exp_f32 v129, v129
    v_exp_f32 v130, v130
    v_exp_f32 v131, v131
    v_mfma_f32_32x32x8_bf16 v[96:111], a[202:203], a[166:167], v[96:111]
    v_exp_f32 v132, v132
    v_exp_f32 v133, v133
    v_exp_f32 v134, v134
    v_exp_f32 v135, v135
    v_smfmac_f32_32x32x32_bf16 a[16:31], a[216:219], v[120:127], v150
    ds_write_b128 v155, a[0:3] offset:0
    v_exp_f32 v136, v136
    v_exp_f32 v137, v137
    v_exp_f32 v138, v138
    v_exp_f32 v139, v139
    v_smfmac_f32_32x32x32_bf16 a[32:47], a[212:215], v[128:135], v150
    ds_write_b128 v155, a[4:7] offset:1024
    v_exp_f32 v140, v140
    v_exp_f32 v141, v141
    v_exp_f32 v142, v142
    v_exp_f32 v143, v143
    v_mfma_f32_32x32x16_bf16 v[112:127], a[198:201], a[168:171], 0
    ds_write_b128 v155, a[8:11] offset:2048
    v_exp_f32 v96, v96
    v_exp_f32 v97, v97
    v_exp_f32 v98, v98
    v_exp_f32 v99, v99
    v_mfma_f32_32x32x8_bf16 v[112:127], a[202:203], a[172:173], v[112:127]
    v_exp_f32 v100, v100
    v_exp_f32 v101, v101
    v_exp_f32 v102, v102
    v_exp_f32 v103, v103
    v_smfmac_f32_32x32x32_bf16 a[32:47], a[216:219], v[136:143], v150
    ds_write_b128 v155, a[16:19] offset:3072
    v_exp_f32 v104, v104
    v_exp_f32 v105, v105
    v_exp_f32 v106, v106
    v_exp_f32 v107, v107
    v_smfmac_f32_32x32x32_bf16 a[48:63], a[212:215], v[96:103], v150
    ds_write_b128 v155, a[20:23] offset:4096
    v_exp_f32 v108, v108
    v_exp_f32 v109, v109
    v_exp_f32 v110, v110
    v_exp_f32 v111, v111
    v_mfma_f32_32x32x16_bf16 v[128:143], a[198:201], a[174:177], 0
    ds_write_b128 v155, a[24:27] offset:5120
    v_exp_f32 v112, v112
    v_exp_f32 v113, v113
    v_exp_f32 v114, v114
    v_exp_f32 v115, v115
    v_mfma_f32_32x32x8_bf16 v[128:143], a[202:203], a[178:179], v[128:143]
    v_exp_f32 v116, v116
    v_exp_f32 v117, v117
    v_exp_f32 v118, v118
    v_exp_f32 v119, v119
    v_smfmac_f32_32x32x32_bf16 a[48:63], a[216:219], v[104:111], v150
    ds_write_b128 v155, a[32:35] offset:6144
    v_exp_f32 v120, v120
    v_exp_f32 v121, v121
    v_exp_f32 v122, v122
    v_exp_f32 v123, v123
    v_smfmac_f32_32x32x32_bf16 a[64:79], a[212:215], v[112:119], v150
    ds_write_b128 v155, a[36:39] offset:7168
    v_exp_f32 v124, v124
    v_exp_f32 v125, v125
    v_exp_f32 v126, v126
    v_exp_f32 v127, v127
    v_mfma_f32_32x32x16_bf16 v[96:111], a[198:201], a[180:183], 0
    ds_write_b128 v155, a[40:43] offset:8192
    v_exp_f32 v128, v128
    v_exp_f32 v129, v129
    v_exp_f32 v130, v130
    v_exp_f32 v131, v131
    v_mfma_f32_32x32x8_bf16 v[96:111], a[202:203], a[184:185], v[96:111]
    v_exp_f32 v132, v132
    v_exp_f32 v133, v133
    v_exp_f32 v134, v134
    v_exp_f32 v135, v135
    v_smfmac_f32_32x32x32_bf16 a[64:79], a[216:219], v[120:127], v150
    ds_write_b128 v155, a[48:51] offset:9216
    v_exp_f32 v136, v136
    v_exp_f32 v137, v137
    v_exp_f32 v138, v138
    v_exp_f32 v139, v139
    v_smfmac_f32_32x32x32_bf16 a[80:95], a[212:215], v[128:135], v150
    ds_write_b128 v155, a[52:55] offset:10240
    v_exp_f32 v140, v140
    v_exp_f32 v141, v141
    v_exp_f32 v142, v142
    v_exp_f32 v143, v143
    v_mfma_f32_32x32x16_bf16 v[112:127], a[198:201], a[186:189], 0
    ds_write_b128 v155, a[56:59] offset:11264
    v_exp_f32 v96, v96
    v_exp_f32 v97, v97
    v_exp_f32 v98, v98
    v_exp_f32 v99, v99
    v_mfma_f32_32x32x8_bf16 v[112:127], a[202:203], a[190:191], v[112:127]
    v_exp_f32 v100, v100
    v_exp_f32 v101, v101
    v_exp_f32 v102, v102
    v_exp_f32 v103, v103
    v_smfmac_f32_32x32x32_bf16 a[80:95], a[216:219], v[136:143], v150
    ds_write_b128 v155, a[64:67] offset:12288
    v_exp_f32 v104, v104
    v_exp_f32 v105, v105
    v_exp_f32 v106, v106
    v_exp_f32 v107, v107
    v_smfmac_f32_32x32x32_bf16 v[160:175], a[212:215], v[96:103], v150
    ds_write_b128 v155, a[68:71] offset:13312
    v_exp_f32 v108, v108
    v_exp_f32 v109, v109
    v_exp_f32 v110, v110
    v_exp_f32 v111, v111
    ds_write_b128 v155, a[72:75] offset:14336
    v_exp_f32 v112, v112
    v_exp_f32 v113, v113
    v_exp_f32 v114, v114
    v_exp_f32 v115, v115
    v_exp_f32 v116, v116
    v_exp_f32 v117, v117
    v_exp_f32 v118, v118
    v_exp_f32 v119, v119
    v_smfmac_f32_32x32x32_bf16 v[160:175], a[216:219], v[104:111], v150
    ds_write_b128 v155, a[80:83] offset:15360
    v_exp_f32 v120, v120
    v_exp_f32 v121, v121
    v_exp_f32 v122, v122
    v_exp_f32 v123, v123
    v_smfmac_f32_32x32x32_bf16 v[176:191], a[212:215], v[112:119], v150
    ds_write_b128 v155, a[84:87] offset:16384
    v_exp_f32 v124, v124
    v_exp_f32 v125, v125
    v_exp_f32 v126, v126
    v_exp_f32 v127, v127
    s_nop 1
    v_smfmac_f32_32x32x32_bf16 v[176:191], a[216:219], v[120:127], v150
    ds_write_b128 v155, a[88:91] offset:17408
    s_waitcnt lgkmcnt(0)
    s_barrier
    ds_read_b128 v[96:99], v152 offset:0
    ds_read_b128 v[100:103], v152 offset:1024
    ds_read_b128 v[104:107], v152 offset:2048
    ds_read_b128 v[108:111], v152 offset:3072
    ds_read_b128 v[112:115], v152 offset:4096
    ds_read_b128 v[116:119], v152 offset:5120
    ds_read_b128 v[120:123], v153 offset:6144
    ds_read_b128 v[124:127], v153 offset:7168
    ds_read_b128 v[128:131], v153 offset:8192
    ds_read_b128 v[132:135], v153 offset:9216
    ds_read_b128 v[136:139], v153 offset:10240
    ds_read_b128 v[140:143], v153 offset:11264
    s_mov_b32 s4, 0x2b800000
    s_mov_b32 s5, 0x53800000
    s_waitcnt lgkmcnt(9)
    v_pk_add_f32 v[160:161], v[160:161], v[96:97]
    v_pk_add_f32 v[162:163], v[162:163], v[98:99]
    v_pk_add_f32 v[164:165], v[164:165], v[100:101]
    v_pk_add_f32 v[166:167], v[166:167], v[102:103]
    v_pk_add_f32 v[168:169], v[168:169], v[104:105]
    v_pk_add_f32 v[170:171], v[170:171], v[106:107]
    ds_read_b128 v[96:99], v154 offset:12288
    ds_read_b128 v[100:103], v154 offset:13312
    ds_read_b128 v[104:107], v154 offset:14336
    s_waitcnt lgkmcnt(9)
    v_pk_add_f32 v[176:177], v[176:177], v[108:109]
    v_pk_add_f32 v[178:179], v[178:179], v[110:111]
    v_pk_add_f32 v[180:181], v[180:181], v[112:113]
    v_pk_add_f32 v[182:183], v[182:183], v[114:115]
    v_pk_add_f32 v[184:185], v[184:185], v[116:117]
    v_pk_add_f32 v[186:187], v[186:187], v[118:119]
    ds_read_b128 v[108:111], v154 offset:15360
    ds_read_b128 v[112:115], v154 offset:16384
    ds_read_b128 v[116:119], v154 offset:17408
    s_waitcnt lgkmcnt(9)
    v_pk_add_f32 v[160:161], v[160:161], v[120:121]
    v_pk_add_f32 v[162:163], v[162:163], v[122:123]
    v_pk_add_f32 v[164:165], v[164:165], v[124:125]
    v_pk_add_f32 v[166:167], v[166:167], v[126:127]
    v_pk_add_f32 v[168:169], v[168:169], v[128:129]
    v_pk_add_f32 v[170:171], v[170:171], v[130:131]
    s_waitcnt lgkmcnt(6)
    v_pk_add_f32 v[176:177], v[176:177], v[132:133]
    v_pk_add_f32 v[178:179], v[178:179], v[134:135]
    v_pk_add_f32 v[180:181], v[180:181], v[136:137]
    v_pk_add_f32 v[182:183], v[182:183], v[138:139]
    v_pk_add_f32 v[184:185], v[184:185], v[140:141]
    v_pk_add_f32 v[186:187], v[186:187], v[142:143]
    s_waitcnt lgkmcnt(3)
    v_pk_add_f32 v[160:161], v[160:161], v[96:97]
    v_pk_add_f32 v[162:163], v[162:163], v[98:99]
    v_pk_add_f32 v[164:165], v[164:165], v[100:101]
    v_pk_add_f32 v[166:167], v[166:167], v[102:103]
    v_pk_add_f32 v[168:169], v[168:169], v[104:105]
    v_pk_add_f32 v[170:171], v[170:171], v[106:107]
    s_waitcnt lgkmcnt(0)
    v_pk_add_f32 v[176:177], v[176:177], v[108:109]
    v_pk_add_f32 v[178:179], v[178:179], v[110:111]
    v_pk_add_f32 v[180:181], v[180:181], v[112:113]
    v_pk_add_f32 v[182:183], v[182:183], v[114:115]
    v_pk_add_f32 v[184:185], v[184:185], v[116:117]
    v_pk_add_f32 v[186:187], v[186:187], v[118:119]
    v_mov_b32 v158, v168
    v_mov_b32 v159, v184
    s_nop 1
    v_permlane32_swap_b32 v158, v159
    s_nop 0
    v_cmp_nle_f32 vcc, s4, v159
    v_cmp_nge_f32 s[6:7], s5, v159
    v_rcp_f32 v158, v159
    s_or_b64 vcc, vcc, s[6:7]
    s_cbranch_vccnz L_slow
L_norm:
    buffer_store_dword v14, v15, s[12:15], 0 offen offset:0 sc1
    v_mov_b32 v159, v158
    s_nop 1
    v_permlane32_swap_b32 v158, v159
    s_nop 0
    v_pk_mul_f32 v[160:161], v[160:161], v[158:159] op_sel:[0,0] op_sel_hi:[1,0]
    v_pk_mul_f32 v[162:163], v[162:163], v[158:159] op_sel:[0,0] op_sel_hi:[1,0]
    v_pk_mul_f32 v[164:165], v[164:165], v[158:159] op_sel:[0,0] op_sel_hi:[1,0]
    v_pk_mul_f32 v[166:167], v[166:167], v[158:159] op_sel:[0,0] op_sel_hi:[1,0]
    v_pk_mul_f32 v[168:169], v[168:169], v[158:159] op_sel:[0,0] op_sel_hi:[1,0]
    v_pk_mul_f32 v[170:171], v[170:171], v[158:159] op_sel:[0,0] op_sel_hi:[1,0]
    v_pk_mul_f32 v[176:177], v[176:177], v[158:159] op_sel:[0,1] op_sel_hi:[1,1]
    v_pk_mul_f32 v[178:179], v[178:179], v[158:159] op_sel:[0,1] op_sel_hi:[1,1]
    v_pk_mul_f32 v[180:181], v[180:181], v[158:159] op_sel:[0,1] op_sel_hi:[1,1]
    v_pk_mul_f32 v[182:183], v[182:183], v[158:159] op_sel:[0,1] op_sel_hi:[1,1]
    v_pk_mul_f32 v[184:185], v[184:185], v[158:159] op_sel:[0,1] op_sel_hi:[1,1]
    v_pk_mul_f32 v[186:187], v[186:187], v[158:159] op_sel:[0,1] op_sel_hi:[1,1]
    v_cvt_pk_bf16_f32 v104, v168, v169
    v_cvt_pk_bf16_f32 v105, v170, v171
    v_cvt_pk_bf16_f32 v106, v184, v185
    v_cvt_pk_bf16_f32 v107, v186, v187
    v_cvt_pk_bf16_f32 v96, v160, v161
    v_cvt_pk_bf16_f32 v97, v162, v163
    v_cvt_pk_bf16_f32 v98, v164, v165
    v_cvt_pk_bf16_f32 v99, v166, v167
    v_cvt_pk_bf16_f32 v100, v176, v177
    v_cvt_pk_bf16_f32 v101, v178, v179
    v_cvt_pk_bf16_f32 v102, v180, v181
    v_cvt_pk_bf16_f32 v103, v182, v183
    v_permlane32_swap_b32 v104, v106
    v_permlane32_swap_b32 v105, v107
    buffer_store_dwordx4 v[96:99], v1, s[12:15], s67 offen offset:0 sc1
    buffer_store_dwordx4 v[100:103], v1, s[12:15], s22 offen offset:0 sc1
    buffer_store_dwordx2 v[104:105], v149, s[12:15], s68 offen offset:0 sc1
    v_mfma_f32_16x16x32_bf16 a[96:99], v[72:75], a[244:247], a[96:99]
    v_and_b32 v156, 0x7f, v156
    s_mov_b32 s23, 0
    v_mfma_f32_16x16x32_bf16 a[100:103], v[76:79], a[244:247], a[100:103]
    s_lshl_b32 s64, s61, 9
    s_add_u32 s64, s64, 19695616
    s_lshl_b32 s6, s61, 1
    v_mfma_f32_16x16x32_bf16 a[104:107], v[80:83], a[244:247], a[104:107]
    s_lshr_b32 s5, s3, 1
    s_add_u32 s6, s6, s5
    s_lshl_b32 s67, s6, 15
    v_mfma_f32_16x16x32_bf16 a[108:111], v[84:87], a[244:247], a[108:111]
    s_add_u32 s67, s67, 14290944
    s_mul_i32 s5, s5, 99328
    s_sub_u32 s67, s67, s5
    v_mfma_f32_16x16x32_bf16 a[112:115], v[88:91], a[244:247], a[112:115]
    s_lshl_b32 s68, s6, 13
    s_and_b32 s5, s3, 1
    s_lshl_b32 s5, s5, 7
    v_mfma_f32_16x16x32_bf16 a[96:99], v[28:31], v[92:95], a[96:99]
    s_add_u32 s68, s68, s5
    s_add_u32 s68, s68, 16389120
    s_add_u32 s26, s12, s68
    s_addc_u32 s27, s13, 0
    v_mfma_f32_16x16x32_bf16 a[100:103], v[32:35], v[92:95], a[100:103]
    s_waitcnt vmcnt(6)
    v_accvgpr_read_b32 v116, a192
    v_accvgpr_read_b32 v117, a193
    v_mfma_f32_16x16x32_bf16 a[104:107], v[36:39], v[92:95], a[104:107]
    v_accvgpr_read_b32 v118, a194
    v_accvgpr_read_b32 v119, a195
    v_mfma_f32_16x16x32_bf16 a[108:111], v[40:43], v[92:95], a[108:111]
    v_accvgpr_read_b32 v124, a196
    v_accvgpr_read_b32 v125, a197
    v_mfma_f32_16x16x32_bf16 a[112:115], v[44:47], v[92:95], a[112:115]
    v_accvgpr_read_b32 v120, a204
    v_accvgpr_read_b32 v121, a205
    v_mfma_f32_16x16x32_bf16 a[96:99], v[208:211], v[192:195], a[96:99]
    v_accvgpr_read_b32 v122, a206
    v_accvgpr_read_b32 v123, a207
    v_mfma_f32_16x16x32_bf16 a[100:103], v[212:215], v[192:195], a[100:103]
    s_barrier
    v_mfma_f32_16x16x32_bf16 a[104:107], v[216:219], v[192:195], a[104:107]
    s_add_u32 m0, s48, 15360
    s_add_u32 s4, s71, 0
    buffer_load_dwordx4 v1, s[12:15], s4 offen offset:0 sc1 lds
    v_mfma_f32_16x16x32_bf16 a[108:111], v[220:223], v[192:195], a[108:111]
    v_and_b32 v168, 15, v0
    v_lshrrev_b32 v169, 4, v0
    v_mfma_f32_16x16x32_bf16 a[112:115], v[224:227], v[192:195], a[112:115]
L_pad13:
    s_cbranch_execz L_back
    v_mul_u32_u24 v160, 176, v168
    v_mad_u32_u24 v160, v169, 40, v160
    v_mfma_f32_16x16x32_bf16 a[96:99], v[244:247], v[228:231], a[96:99]
    v_add_u32 v160, s48, v160
    v_add_u32 v168, 0, v0
    v_mfma_f32_16x16x32_bf16 a[100:103], v[248:251], v[228:231], a[100:103]
    buffer_load_dwordx4 v1, s[12:15], s4 offen offset:1024 sc1 lds
    v_mfma_f32_16x16x32_bf16 a[104:107], v[252:255], v[228:231], a[104:107]
    v_mul_u32_u24 v169, 0x199a, v168
    v_lshrrev_b32 v169, 16, v169
    v_mfma_f32_16x16x32_bf16 a[108:111], a[232:235], v[228:231], a[108:111]
    v_lshlrev_b32 v168, 4, v168
    v_mad_u32_u24 v161, v169, 16, v168
    v_mfma_f32_16x16x32_bf16 a[112:115], a[236:239], v[228:231], a[112:115]
    v_add_u32 v161, s48, v161
    v_mul_u32_u24 v169, 1120, v169
    v_mfma_f32_16x16x32_bf16 a[116:119], v[72:75], a[252:255], a[116:119]
    buffer_load_dwordx4 v1, s[12:15], s4 offen offset:2048 sc1 lds
    v_mfma_f32_16x16x32_bf16 a[120:123], v[76:79], a[252:255], a[120:123]
    v_add_u32 v164, v169, v168
    v_add_u32 v168, 64, v0
    v_mfma_f32_16x16x32_bf16 a[124:127], v[80:83], a[252:255], a[124:127]
    ds_write_b128 v155, a[96:99] offset:0
    v_mfma_f32_16x16x32_bf16 a[128:131], v[84:87], a[252:255], a[128:131]
    v_mul_u32_u24 v169, 0x199a, v168
    v_lshrrev_b32 v169, 16, v169
    v_mfma_f32_16x16x32_bf16 a[132:135], v[88:91], a[252:255], a[132:135]
    v_lshlrev_b32 v168, 4, v168
    v_mad_u32_u24 v162, v169, 16, v168
    v_mfma_f32_16x16x32_bf16 a[116:119], v[28:31], v[16:19], a[116:119]
    v_add_u32 v162, s48, v162
    v_mul_u32_u24 v169, 1120, v169
    v_mfma_f32_16x16x32_bf16 a[120:123], v[32:35], v[16:19], a[120:123]
    ds_write_b128 v155, a[100:103] offset:1024
    v_mfma_f32_16x16x32_bf16 a[124:127], v[36:39], v[16:19], a[124:127]
    v_add_u32 v165, v169, v168
    v_add_u32 v168, 128, v0
    v_mfma_f32_16x16x32_bf16 a[128:131], v[40:43], v[16:19], a[128:131]
    v_mul_u32_u24 v169, 0x199a, v168
    v_lshrrev_b32 v169, 16, v169
    v_mfma_f32_16x16x32_bf16 a[132:135], v[44:47], v[16:19], a[132:135]
    v_lshlrev_b32 v168, 4, v168
    v_mad_u32_u24 v163, v169, 16, v168
    v_mfma_f32_16x16x32_bf16 a[116:119], v[208:211], v[196:199], a[116:119]
    ds_write_b128 v155, a[104:107] offset:2048
    v_mfma_f32_16x16x32_bf16 a[120:123], v[212:215], v[196:199], a[120:123]
    v_add_u32 v163, s48, v163
    v_mul_u32_u24 v169, 1120, v169
    v_mfma_f32_16x16x32_bf16 a[124:127], v[216:219], v[196:199], a[124:127]
    v_add_u32 v166, v169, v168
    v_lshrrev_b32 v168, 5, v0
    v_mfma_f32_16x16x32_bf16 a[128:131], v[220:223], v[196:199], a[128:131]
    v_lshl_add_u32 v166, v168, 30, v166
    v_mfma_f32_16x16x32_bf16 a[132:135], v[224:227], v[196:199], a[132:135]
    ds_write_b128 v155, a[108:111] offset:3072
    v_mfma_f32_16x16x32_bf16 a[116:119], v[244:247], v[232:235], a[116:119]
    v_mfma_f32_16x16x32_bf16 a[120:123], v[248:251], v[232:235], a[120:123]
    v_mfma_f32_16x16x32_bf16 a[124:127], v[252:255], v[232:235], a[124:127]
    v_mfma_f32_16x16x32_bf16 a[128:131], a[232:235], v[232:235], a[128:131]
    ds_write_b128 v155, a[112:115] offset:4096
    v_mfma_f32_16x16x32_bf16 a[132:135], a[236:239], v[232:235], a[132:135]
    v_mfma_f32_16x16x32_bf16 a[136:139], v[72:75], v[68:71], a[136:139]
    v_mfma_f32_16x16x32_bf16 a[140:143], v[76:79], v[68:71], a[140:143]
    v_mfma_f32_16x16x32_bf16 a[220:223], v[80:83], v[68:71], a[220:223]
    ds_write_b128 v155, a[116:119] offset:5120
    v_mfma_f32_16x16x32_bf16 a[224:227], v[84:87], v[68:71], a[224:227]
    v_mfma_f32_16x16x32_bf16 a[228:231], v[88:91], v[68:71], a[228:231]
    v_mfma_f32_16x16x32_bf16 a[136:139], v[28:31], v[24:27], a[136:139]
    v_mfma_f32_16x16x32_bf16 a[140:143], v[32:35], v[24:27], a[140:143]
    ds_write_b128 v155, a[120:123] offset:6144
    v_mfma_f32_16x16x32_bf16 a[220:223], v[36:39], v[24:27], a[220:223]
    v_mfma_f32_16x16x32_bf16 a[224:227], v[40:43], v[24:27], a[224:227]
    v_mfma_f32_16x16x32_bf16 a[228:231], v[44:47], v[24:27], a[228:231]
    v_mfma_f32_16x16x32_bf16 a[136:139], v[208:211], v[204:207], a[136:139]
    ds_write_b128 v155, a[124:127] offset:7168
    v_mfma_f32_16x16x32_bf16 a[140:143], v[212:215], v[204:207], a[140:143]
    buffer_load_dword v157, v156, s[12:15], s64 offen offset:0 sc1
    v_mfma_f32_16x16x32_bf16 a[220:223], v[216:219], v[204:207], a[220:223]
    v_mfma_f32_16x16x32_bf16 a[224:227], v[220:223], v[204:207], a[224:227]
    v_mfma_f32_16x16x32_bf16 a[228:231], v[224:227], v[204:207], a[228:231]
    ds_write_b128 v155, a[128:131] offset:8192
    v_mfma_f32_16x16x32_bf16 a[136:139], v[244:247], v[240:243], a[136:139]
    v_mfma_f32_16x16x32_bf16 a[140:143], v[248:251], v[240:243], a[140:143]
    v_mfma_f32_16x16x32_bf16 a[220:223], v[252:255], v[240:243], a[220:223]
    v_mfma_f32_16x16x32_bf16 a[224:227], a[232:235], v[240:243], a[224:227]
    ds_write_b128 v155, a[132:135] offset:9216
    v_mfma_f32_16x16x32_bf16 a[228:231], a[236:239], v[240:243], a[228:231]
    v_mfma_f32_16x16x32_bf16 v[48:51], v[72:75], v[20:23], v[48:51]
    v_mfma_f32_16x16x32_bf16 v[52:55], v[76:79], v[20:23], v[52:55]
    v_mfma_f32_16x16x32_bf16 v[56:59], v[80:83], v[20:23], v[56:59]
    ds_write_b128 v155, a[136:139] offset:10240
    v_mfma_f32_16x16x32_bf16 v[60:63], v[84:87], v[20:23], v[60:63]
    v_mfma_f32_16x16x32_bf16 v[64:67], v[88:91], v[20:23], v[64:67]
    v_mfma_f32_16x16x32_bf16 v[48:51], v[28:31], v[200:203], v[48:51]
    v_mfma_f32_16x16x32_bf16 v[52:55], v[32:35], v[200:203], v[52:55]
    ds_write_b128 v155, a[140:143] offset:11264
    v_mfma_f32_16x16x32_bf16 v[56:59], v[36:39], v[200:203], v[56:59]
    v_mfma_f32_16x16x32_bf16 v[60:63], v[40:43], v[200:203], v[60:63]
    v_mfma_f32_16x16x32_bf16 v[64:67], v[44:47], v[200:203], v[64:67]
    s_waitcnt vmcnt(0)
    v_cmp_gt_u32 vcc, 1, v157
    s_cbranch_vccnz L_ps6
L_pd6:
    v_mfma_f32_16x16x32_bf16 v[48:51], v[208:211], v[236:239], v[48:51]
    ds_write_b128 v155, a[220:223] offset:12288
    v_mfma_f32_16x16x32_bf16 v[52:55], v[212:215], v[236:239], v[52:55]
    s_add_u32 s24, s12, s67
    s_addc_u32 s25, s13, 0
    global_load_dwordx4 a[0:3], v5, s[24:25] offset:-4096 sc1
    v_mfma_f32_16x16x32_bf16 v[56:59], v[216:219], v[236:239], v[56:59]
    v_mfma_f32_16x16x32_bf16 v[60:63], v[220:223], v[236:239], v[60:63]
    global_load_dwordx4 a[4:7], v5, s[24:25] offset:-2048 sc1
    v_mfma_f32_16x16x32_bf16 v[64:67], v[224:227], v[236:239], v[64:67]
    ds_write_b128 v155, a[224:227] offset:13312
    v_mfma_f32_16x16x32_bf16 v[48:51], v[244:247], a[248:251], v[48:51]
    global_load_dwordx4 a[8:11], v5, s[24:25] offset:0 sc1
    v_mfma_f32_16x16x32_bf16 v[52:55], v[248:251], a[248:251], v[52:55]
    v_mfma_f32_16x16x32_bf16 v[56:59], v[252:255], a[248:251], v[56:59]
    buffer_store_dword v14, v15, s[12:15], 0 offen offset:128 sc1
    v_mfma_f32_16x16x32_bf16 v[60:63], a[232:235], a[248:251], v[60:63]
    ds_write_b128 v155, a[228:231] offset:14336
    v_mfma_f32_16x16x32_bf16 v[64:67], a[236:239], a[248:251], v[64:67]
    global_load_dwordx4 a[12:15], v5, s[24:25] offset:2048 sc1
    s_waitcnt lgkmcnt(0)
    s_barrier
    ds_read_b128 v[192:195], v152 offset:0
    ds_read_b128 v[196:199], v152 offset:1024
    ds_read_b128 v[200:203], v152 offset:2048
    ds_read_b128 v[204:207], v152 offset:3072
    ds_read_b128 v[208:211], v152 offset:4096
    ds_read_b128 v[212:215], v153 offset:5120
    ds_read_b128 v[216:219], v153 offset:6144
    ds_read_b128 v[220:223], v153 offset:7168
    ds_read_b128 v[224:227], v153 offset:8192
    ds_read_b128 v[228:231], v153 offset:9216
    ds_read_b128 v[232:235], v154 offset:10240
    ds_read_b128 v[236:239], v154 offset:11264
    ds_read_b128 v[240:243], v154 offset:12288
    ds_read_b128 v[244:247], v154 offset:13312
    ds_read_b128 v[248:251], v154 offset:14336
    s_add_u32 s24, s24, 8192
    s_addc_u32 s25, s25, 0
    global_load_dwordx4 a[16:19], v5, s[24:25] offset:-4096 sc1
    s_mov_b32 s6, 0xbfb8aa3b
    s_mov_b32 s7, 0xbfb8aa3b
    s_waitcnt lgkmcnt(10)
    v_pk_add_f32 v[48:49], v[48:49], v[192:193]
    v_pk_add_f32 v[50:51], v[50:51], v[194:195]
    v_pk_add_f32 v[52:53], v[52:53], v[196:197]
    v_pk_add_f32 v[54:55], v[54:55], v[198:199]
    v_pk_add_f32 v[56:57], v[56:57], v[200:201]
    v_pk_add_f32 v[58:59], v[58:59], v[202:203]
    v_pk_add_f32 v[60:61], v[60:61], v[204:205]
    v_pk_add_f32 v[62:63], v[62:63], v[206:207]
    v_pk_add_f32 v[64:65], v[64:65], v[208:209]
    v_pk_add_f32 v[66:67], v[66:67], v[210:211]
    s_waitcnt lgkmcnt(5)
    global_load_dwordx4 a[20:23], v5, s[24:25] offset:-2048 sc1
    v_pk_add_f32 v[48:49], v[48:49], v[212:213]
    v_pk_add_f32 v[50:51], v[50:51], v[214:215]
    v_pk_add_f32 v[52:53], v[52:53], v[216:217]
    v_pk_add_f32 v[54:55], v[54:55], v[218:219]
    v_pk_add_f32 v[56:57], v[56:57], v[220:221]
    v_pk_add_f32 v[58:59], v[58:59], v[222:223]
    v_pk_add_f32 v[60:61], v[60:61], v[224:225]
    v_pk_add_f32 v[62:63], v[62:63], v[226:227]
    v_pk_add_f32 v[64:65], v[64:65], v[228:229]
    v_pk_add_f32 v[66:67], v[66:67], v[230:231]
    s_waitcnt lgkmcnt(0)
    v_pk_add_f32 v[48:49], v[48:49], v[232:233]
    v_pk_add_f32 v[50:51], v[50:51], v[234:235]
    v_pk_add_f32 v[52:53], v[52:53], v[236:237]
    global_load_dwordx4 a[24:27], v5, s[24:25] offset:0 sc1
    v_pk_add_f32 v[54:55], v[54:55], v[238:239]
    v_pk_add_f32 v[56:57], v[56:57], v[240:241]
    v_pk_add_f32 v[58:59], v[58:59], v[242:243]
    v_pk_add_f32 v[60:61], v[60:61], v[244:245]
    v_pk_add_f32 v[62:63], v[62:63], v[246:247]
    v_pk_add_f32 v[64:65], v[64:65], v[248:249]
    v_pk_add_f32 v[66:67], v[66:67], v[250:251]
    ds_read_b128 a[144:147], v7 offset:0
    ds_read_b128 a[148:151], v7 offset:1024
    ds_read_b128 a[152:155], v7 offset:2048
    ds_read_b128 a[156:159], v7 offset:3072
    ds_read_b128 a[160:163], v7 offset:4096
    ds_read_b128 a[164:167], v7 offset:5120
    ds_read_b128 a[168:171], v7 offset:6144
    ds_read_b128 a[172:175], v7 offset:7168
    ds_read_b128 a[176:179], v7 offset:8192
    ds_read_b128 a[180:183], v7 offset:9216
    global_load_dwordx4 a[28:31], v5, s[24:25] offset:2048 sc1
    v_pk_mul_f32 v[68:69], v[48:49], s[6:7]
    v_pk_mul_f32 v[70:71], v[50:51], s[6:7]
    v_pk_mul_f32 v[72:73], v[52:53], s[6:7]
    v_pk_mul_f32 v[74:75], v[54:55], s[6:7]
    v_pk_mul_f32 v[76:77], v[56:57], s[6:7]
    v_pk_mul_f32 v[78:79], v[58:59], s[6:7]
    v_pk_mul_f32 v[80:81], v[60:61], s[6:7]
    v_pk_mul_f32 v[82:83], v[62:63], s[6:7]
    v_pk_mul_f32 v[84:85], v[64:65], s[6:7]
    v_pk_mul_f32 v[86:87], v[66:67], s[6:7]
    v_exp_f32 v68, v68
    s_add_u32 s24, s24, 8192
    s_addc_u32 s25, s25, 0
    global_load_dwordx4 a[32:35], v5, s[24:25] offset:-4096 sc1
    v_exp_f32 v69, v69
    v_exp_f32 v70, v70
    v_exp_f32 v71, v71
    v_exp_f32 v72, v72
    v_exp_f32 v73, v73
    v_exp_f32 v74, v74
    v_exp_f32 v75, v75
    global_load_dwordx4 a[36:39], v5, s[24:25] offset:-2048 sc1
    v_exp_f32 v76, v76
    v_exp_f32 v77, v77
    v_exp_f32 v78, v78
    v_exp_f32 v79, v79
    v_exp_f32 v80, v80
    v_exp_f32 v81, v81
    v_exp_f32 v82, v82
    global_load_dwordx4 a[40:43], v5, s[24:25] offset:0 sc1
    v_exp_f32 v83, v83
    v_exp_f32 v84, v84
    v_exp_f32 v85, v85
    v_exp_f32 v86, v86
    v_exp_f32 v87, v87
    v_pk_add_f32 v[68:69], v[68:69], 1.0 op_sel_hi:[1,0]
    v_pk_add_f32 v[70:71], v[70:71], 1.0 op_sel_hi:[1,0]
    v_pk_add_f32 v[72:73], v[72:73], 1.0 op_sel_hi:[1,0]
    global_load_dwordx4 a[44:47], v5, s[24:25] offset:2048 sc1
    v_pk_add_f32 v[74:75], v[74:75], 1.0 op_sel_hi:[1,0]
    v_pk_add_f32 v[76:77], v[76:77], 1.0 op_sel_hi:[1,0]
    v_pk_add_f32 v[78:79], v[78:79], 1.0 op_sel_hi:[1,0]
    v_pk_add_f32 v[80:81], v[80:81], 1.0 op_sel_hi:[1,0]
    v_pk_add_f32 v[82:83], v[82:83], 1.0 op_sel_hi:[1,0]
    v_pk_add_f32 v[84:85], v[84:85], 1.0 op_sel_hi:[1,0]
    v_pk_add_f32 v[86:87], v[86:87], 1.0 op_sel_hi:[1,0]
    v_rcp_f32 v68, v68
    v_rcp_f32 v69, v69
    v_rcp_f32 v70, v70
    v_rcp_f32 v71, v71
    s_add_u32 s24, s24, 8192
    s_addc_u32 s25, s25, 0
    global_load_dwordx4 a[48:51], v5, s[24:25] offset:-4096 sc1
    v_rcp_f32 v72, v72
    v_rcp_f32 v73, v73
    v_rcp_f32 v74, v74
    v_rcp_f32 v75, v75
    v_rcp_f32 v76, v76
    v_rcp_f32 v77, v77
    v_rcp_f32 v78, v78
    global_load_dwordx4 a[52:55], v5, s[24:25] offset:-2048 sc1
    v_rcp_f32 v79, v79
    v_rcp_f32 v80, v80
    v_rcp_f32 v81, v81
    v_rcp_f32 v82, v82
    v_rcp_f32 v83, v83
    v_rcp_f32 v84, v84
    v_rcp_f32 v85, v85
    global_load_dwordx4 a[56:59], v5, s[24:25] offset:0 sc1
    v_rcp_f32 v86, v86
    v_rcp_f32 v87, v87
    v_pk_mul_f32 v[48:49], v[48:49], v[68:69]
    v_pk_mul_f32 v[50:51], v[50:51], v[70:71]
    v_pk_mul_f32 v[52:53], v[52:53], v[72:73]
    v_pk_mul_f32 v[54:55], v[54:55], v[74:75]
    v_pk_mul_f32 v[56:57], v[56:57], v[76:77]
    v_pk_mul_f32 v[58:59], v[58:59], v[78:79]
    v_pk_mul_f32 v[60:61], v[60:61], v[80:81]
    v_pk_mul_f32 v[62:63], v[62:63], v[82:83]
    v_pk_mul_f32 v[64:65], v[64:65], v[84:85]
    v_pk_mul_f32 v[66:67], v[66:67], v[86:87]
    v_lshlrev_b32 v68, 16, v116
    v_and_b32 v69, s49, v116
    v_lshlrev_b32 v70, 16, v117
    v_and_b32 v71, s49, v117
    v_lshlrev_b32 v72, 16, v118
    v_and_b32 v73, s49, v118
    v_lshlrev_b32 v74, 16, v119
    v_and_b32 v75, s49, v119
    v_lshlrev_b32 v76, 16, v120
    v_and_b32 v77, s49, v120
    v_lshlrev_b32 v78, 16, v121
    v_and_b32 v79, s49, v121
    v_lshlrev_b32 v80, 16, v122
    v_and_b32 v81, s49, v122
    v_lshlrev_b32 v82, 16, v123
    v_and_b32 v83, s49, v123
    v_lshlrev_b32 v84, 16, v124
    v_and_b32 v85, s49, v124
    v_lshlrev_b32 v86, 16, v125
    v_and_b32 v87, s49, v125
    s_barrier
L_wo:
    s_waitcnt vmcnt(15)
    s_waitcnt lgkmcnt(9)
    v_mfma_f32_16x16x32_bf16 v[128:131], a[144:147], a[0:3], 0
    global_load_dwordx4 a[60:63], v5, s[24:25] offset:2048 sc1
    ds_read_b128 a[184:187], v7 offset:10240
    s_waitcnt lgkmcnt(9)
    v_mfma_f32_16x16x32_bf16 v[132:135], a[148:151], a[0:3], 0
    s_waitcnt lgkmcnt(5)
    ds_read_b128 a[188:191], v7 offset:11264
    v_mfma_f32_16x16x32_bf16 v[136:139], a[152:155], a[0:3], 0
    ds_read_b128 a[144:147], v7 offset:12288
    v_mfma_f32_16x16x32_bf16 v[140:143], a[156:159], a[0:3], 0
    global_load_dwordx2 a[64:65], v6, s[26:27] offset:-4096 sc1
    ds_read_b128 a[148:151], v7 offset:13312
    v_mfma_f32_16x16x32_bf16 v[144:147], a[160:163], a[0:3], 0
    s_waitcnt vmcnt(16)
    ds_read_b128 a[152:155], v7 offset:14336
    v_mfma_f32_16x16x32_bf16 v[128:131], a[164:167], a[4:7], v[128:131]
    s_waitcnt lgkmcnt(5)
    ds_read_b128 a[156:159], v7 offset:15360
    v_mfma_f32_16x16x32_bf16 v[132:135], a[168:171], a[4:7], v[132:135]
    global_load_dwordx2 a[66:67], v6, s[26:27] offset:-3840 sc1
    ds_read_b128 a[160:163], v7 offset:16384
    v_mfma_f32_16x16x32_bf16 v[136:139], a[172:175], a[4:7], v[136:139]
    ds_read_b128 a[164:167], v7 offset:17408
    v_mfma_f32_16x16x32_bf16 v[140:143], a[176:179], a[4:7], v[140:143]
    s_waitcnt lgkmcnt(5)
    ds_read_b128 a[168:171], v7 offset:18432
    v_mfma_f32_16x16x32_bf16 v[144:147], a[180:183], a[4:7], v[144:147]
    global_load_dwordx2 a[68:69], v6, s[26:27] offset:-2048 sc1
    ds_read_b128 a[172:175], v7 offset:19456
    s_waitcnt vmcnt(17)
    v_mfma_f32_16x16x32_bf16 v[128:131], a[184:187], a[8:11], v[128:131]
    ds_read_b128 a[176:179], v7 offset:20480
    v_mfma_f32_16x16x32_bf16 v[132:135], a[188:191], a[8:11], v[132:135]
    s_waitcnt lgkmcnt(5)
    ds_read_b128 a[180:183], v7 offset:21504
    v_mfma_f32_16x16x32_bf16 v[136:139], a[144:147], a[8:11], v[136:139]
    global_load_dwordx2 a[70:71], v6, s[26:27] offset:-1792 sc1
    ds_read_b128 a[184:187], v7 offset:22528
    v_mfma_f32_16x16x32_bf16 v[140:143], a[148:151], a[8:11], v[140:143]
    ds_read_b128 a[188:191], v7 offset:23552
    v_mfma_f32_16x16x32_bf16 v[144:147], a[152:155], a[8:11], v[144:147]
    s_waitcnt vmcnt(16)
    ds_read_b128 a[144:147], v7 offset:24576
    v_mfma_f32_16x16x32_bf16 v[128:131], a[156:159], a[12:15], v[128:131]
    global_load_dwordx2 a[72:73], v6, s[26:27] offset:0 sc1
    ds_read_b128 a[148:151], v8 offset:0
    s_waitcnt lgkmcnt(9)
    v_mfma_f32_16x16x32_bf16 v[132:135], a[160:163], a[12:15], v[132:135]
    s_waitcnt lgkmcnt(5)
    ds_read_b128 a[152:155], v8 offset:1024
    v_mfma_f32_16x16x32_bf16 v[136:139], a[164:167], a[12:15], v[136:139]
    ds_read_b128 a[156:159], v8 offset:2048
    v_mfma_f32_16x16x32_bf16 v[140:143], a[168:171], a[12:15], v[140:143]
    global_load_dwordx2 a[74:75], v6, s[26:27] offset:256 sc1
    ds_read_b128 a[160:163], v8 offset:3072
    v_mfma_f32_16x16x32_bf16 v[144:147], a[172:175], a[12:15], v[144:147]
    s_waitcnt vmcnt(17)
    ds_read_b128 a[164:167], v8 offset:4096
    v_mfma_f32_16x16x32_bf16 v[128:131], a[176:179], a[16:19], v[128:131]
    s_waitcnt lgkmcnt(5)
    ds_read_b128 a[168:171], v8 offset:5120
    v_mfma_f32_16x16x32_bf16 v[132:135], a[180:183], a[16:19], v[132:135]
    global_load_dwordx2 a[76:77], v6, s[26:27] offset:2048 sc1
    ds_read_b128 a[172:175], v8 offset:6144
    v_mfma_f32_16x16x32_bf16 v[136:139], a[184:187], a[16:19], v[136:139]
    ds_read_b128 a[176:179], v8 offset:7168
    v_mfma_f32_16x16x32_bf16 v[140:143], a[188:191], a[16:19], v[140:143]
    s_waitcnt lgkmcnt(5)
    ds_read_b128 a[180:183], v8 offset:8192
    v_mfma_f32_16x16x32_bf16 v[144:147], a[144:147], a[16:19], v[144:147]
    global_load_dwordx2 a[78:79], v6, s[26:27] offset:2304 sc1
    ds_read_b128 a[184:187], v8 offset:9216
    s_waitcnt vmcnt(18)
    v_mfma_f32_16x16x32_bf16 v[128:131], a[148:151], a[20:23], v[128:131]
    ds_read_b128 a[188:191], v8 offset:10240
    v_mfma_f32_16x16x32_bf16 v[132:135], a[152:155], a[20:23], v[132:135]
    s_waitcnt lgkmcnt(5)
    ds_read_b128 a[144:147], v8 offset:11264
    v_mfma_f32_16x16x32_bf16 v[136:139], a[156:159], a[20:23], v[136:139]
    ds_read_b128 a[148:151], v8 offset:12288
    v_mfma_f32_16x16x32_bf16 v[140:143], a[160:163], a[20:23], v[140:143]
    ds_read_b128 a[152:155], v8 offset:13312
    v_mfma_f32_16x16x32_bf16 v[144:147], a[164:167], a[20:23], v[144:147]
    s_waitcnt vmcnt(17)
    ds_read_b128 a[156:159], v8 offset:14336
    v_mfma_f32_16x16x32_bf16 v[128:131], a[168:171], a[24:27], v[128:131]
    s_waitcnt lgkmcnt(5)
    ds_read_b128 a[160:163], v8 offset:15360
    v_mfma_f32_16x16x32_bf16 v[132:135], a[172:175], a[24:27], v[132:135]
    ds_read_b128 a[164:167], v8 offset:16384
    v_mfma_f32_16x16x32_bf16 v[136:139], a[176:179], a[24:27], v[136:139]
    ds_read_b128 a[168:171], v8 offset:17408
    v_mfma_f32_16x16x32_bf16 v[140:143], a[180:183], a[24:27], v[140:143]
    s_waitcnt lgkmcnt(5)
    ds_read_b128 a[172:175], v8 offset:18432
    v_mfma_f32_16x16x32_bf16 v[144:147], a[184:187], a[24:27], v[144:147]
    s_waitcnt vmcnt(16)
    ds_read_b128 a[176:179], v8 offset:19456
    v_mfma_f32_16x16x32_bf16 v[128:131], a[188:191], a[28:31], v[128:131]
    ds_read_b128 a[180:183], v8 offset:20480
    v_mfma_f32_16x16x32_bf16 v[132:135], a[144:147], a[28:31], v[132:135]
    s_waitcnt lgkmcnt(5)
    ds_read_b128 a[184:187], v8 offset:21504
    v_mfma_f32_16x16x32_bf16 v[136:139], a[148:151], a[28:31], v[136:139]
    ds_read_b128 a[188:191], v9 offset:0
    v_mfma_f32_16x16x32_bf16 v[140:143], a[152:155], a[28:31], v[140:143]
    ds_read_b128 a[144:147], v9 offset:1024
    v_mfma_f32_16x16x32_bf16 v[144:147], a[156:159], a[28:31], v[144:147]
    s_waitcnt vmcnt(15)
    ds_read_b128 a[148:151], v9 offset:5120
    v_mfma_f32_16x16x32_bf16 v[128:131], a[160:163], a[32:35], v[128:131]
    s_waitcnt lgkmcnt(5)
    ds_read_b128 a[152:155], v9 offset:6144
    v_mfma_f32_16x16x32_bf16 v[132:135], a[164:167], a[32:35], v[132:135]
    ds_read_b128 a[156:159], v9 offset:10240
    v_mfma_f32_16x16x32_bf16 v[136:139], a[168:171], a[32:35], v[136:139]
    ds_read_b128 a[160:163], v9 offset:11264
    v_mfma_f32_16x16x32_bf16 v[140:143], a[172:175], a[32:35], v[140:143]
    s_waitcnt lgkmcnt(5)
    ds_read_b128 a[164:167], v9 offset:15360
    v_mfma_f32_16x16x32_bf16 v[144:147], a[176:179], a[32:35], v[144:147]
    s_waitcnt vmcnt(14)
    ds_read_b128 a[168:171], v9 offset:16384
    v_mfma_f32_16x16x32_bf16 v[128:131], a[180:183], a[36:39], v[128:131]
    ds_read_b128 a[172:175], v9 offset:20480
    v_mfma_f32_16x16x32_bf16 v[132:135], a[184:187], a[36:39], v[132:135]
    s_waitcnt vmcnt(13)
    ds_read_b128 a[176:179], v9 offset:21504
    v_mfma_f32_16x16x32_bf16 v[128:131], a[188:191], a[40:43], v[128:131]
    s_waitcnt lgkmcnt(5)
    ds_read_b128 a[180:183], v10 offset:0
    v_mfma_f32_16x16x32_bf16 v[132:135], a[144:147], a[40:43], v[132:135]
    s_waitcnt vmcnt(12)
    ds_read_b128 a[184:187], v10 offset:1024
    v_mfma_f32_16x16x32_bf16 v[128:131], a[148:151], a[44:47], v[128:131]
    ds_read_b128 a[188:191], v10 offset:5120
    v_mfma_f32_16x16x32_bf16 v[132:135], a[152:155], a[44:47], v[132:135]
    s_waitcnt vmcnt(11)
    ds_read_b128 a[144:147], v10 offset:6144
    v_mfma_f32_16x16x32_bf16 v[128:131], a[156:159], a[48:51], v[128:131]
    s_waitcnt lgkmcnt(5)
    ds_read_b128 a[148:151], v10 offset:10240
    v_mfma_f32_16x16x32_bf16 v[132:135], a[160:163], a[48:51], v[132:135]
    s_waitcnt vmcnt(10)
    ds_read_b128 a[152:155], v10 offset:11264
    v_mfma_f32_16x16x32_bf16 v[128:131], a[164:167], a[52:55], v[128:131]
    ds_read_b128 a[156:159], v10 offset:15360
    v_mfma_f32_16x16x32_bf16 v[132:135], a[168:171], a[52:55], v[132:135]
    s_waitcnt vmcnt(9)
    ds_read_b128 a[160:163], v10 offset:16384
    v_mfma_f32_16x16x32_bf16 v[128:131], a[172:175], a[56:59], v[128:131]
    s_waitcnt lgkmcnt(5)
    ds_read_b128 a[164:167], v10 offset:20480
    v_mfma_f32_16x16x32_bf16 v[132:135], a[176:179], a[56:59], v[132:135]
    s_waitcnt vmcnt(8)
    ds_read_b128 a[168:171], v10 offset:21504
    v_mfma_f32_16x16x32_bf16 v[128:131], a[180:183], a[60:63], v[128:131]
    ds_read_b128 a[172:175], v8 offset:22528
    v_mfma_f32_16x16x32_bf16 v[132:135], a[184:187], a[60:63], v[132:135]
    s_waitcnt vmcnt(6)
    ds_read_b128 a[176:179], v8 offset:23552
    v_mfma_f32_16x16x32_bf16 v[128:131], a[188:191], a[64:67], v[128:131]
    s_waitcnt lgkmcnt(5)
    ds_read_b128 a[180:183], v9 offset:2048
    v_mfma_f32_16x16x32_bf16 v[132:135], a[144:147], a[64:67], v[132:135]
    s_waitcnt vmcnt(4)
    ds_read_b128 a[184:187], v9 offset:3072
    v_mfma_f32_16x16x32_bf16 v[128:131], a[148:151], a[68:71], v[128:131]
    ds_read_b128 a[188:191], v9 offset:7168
    v_mfma_f32_16x16x32_bf16 v[132:135], a[152:155], a[68:71], v[132:135]
    s_waitcnt vmcnt(2)
    ds_read_b128 a[144:147], v9 offset:8192
    v_mfma_f32_16x16x32_bf16 v[128:131], a[156:159], a[72:75], v[128:131]
    s_waitcnt lgkmcnt(5)
    ds_read_b128 a[148:151], v9 offset:12288
    v_mfma_f32_16x16x32_bf16 v[132:135], a[160:163], a[72:75], v[132:135]
    s_waitcnt vmcnt(0)
    ds_read_b128 a[152:155], v9 offset:13312
    v_mfma_f32_16x16x32_bf16 v[128:131], a[164:167], a[76:79], v[128:131]
    ds_read_b128 a[156:159], v9 offset:17408
    v_mfma_f32_16x16x32_bf16 v[132:135], a[168:171], a[76:79], v[132:135]
    s_waitcnt lgkmcnt(5)
    ds_read_b128 a[160:163], v9 offset:18432
    v_mfma_f32_16x16x32_bf16 v[136:139], a[172:175], a[36:39], v[136:139]
    ds_read_b128 a[164:167], v9 offset:22528
    v_mfma_f32_16x16x32_bf16 v[140:143], a[176:179], a[36:39], v[140:143]
    ds_read_b128 a[168:171], v9 offset:23552
    v_mfma_f32_16x16x32_bf16 v[136:139], a[180:183], a[40:43], v[136:139]
    s_waitcnt lgkmcnt(5)
    ds_read_b128 a[172:175], v10 offset:2048
    v_mfma_f32_16x16x32_bf16 v[140:143], a[184:187], a[40:43], v[140:143]
    ds_read_b128 a[176:179], v10 offset:3072
    v_mfma_f32_16x16x32_bf16 v[136:139], a[188:191], a[44:47], v[136:139]
    ds_read_b128 a[180:183], v10 offset:7168
    v_cmp_u_f32 vcc, v128, v128
    s_cbranch_vccnz L_redo
L_clean:
    v_mfma_f32_16x16x32_bf16 v[140:143], a[144:147], a[44:47], v[140:143]
    s_waitcnt lgkmcnt(5)
    ds_read_b128 a[184:187], v10 offset:8192
    v_fmac_f32 v68, v48, v128
    v_mfma_f32_16x16x32_bf16 v[136:139], a[148:151], a[48:51], v[136:139]
    ds_read_b128 a[188:191], v10 offset:12288
    v_fmac_f32 v69, v49, v129
    v_mfma_f32_16x16x32_bf16 v[140:143], a[152:155], a[48:51], v[140:143]
    ds_read_b128 a[144:147], v10 offset:13312
    v_fmac_f32 v70, v50, v130
    v_mfma_f32_16x16x32_bf16 v[136:139], a[156:159], a[52:55], v[136:139]
    s_waitcnt lgkmcnt(5)
    ds_read_b128 a[148:151], v10 offset:17408
    v_fmac_f32 v71, v51, v131
    v_mfma_f32_16x16x32_bf16 v[140:143], a[160:163], a[52:55], v[140:143]
    ds_read_b128 a[152:155], v10 offset:18432
    v_fmac_f32 v72, v52, v132
    v_mfma_f32_16x16x32_bf16 v[136:139], a[164:167], a[56:59], v[136:139]
    ds_read_b128 a[156:159], v10 offset:22528
    v_fmac_f32 v73, v53, v133
    v_mfma_f32_16x16x32_bf16 v[140:143], a[168:171], a[56:59], v[140:143]
    s_waitcnt lgkmcnt(5)
    ds_read_b128 a[160:163], v10 offset:23552
    v_fmac_f32 v74, v54, v134
    v_mfma_f32_16x16x32_bf16 v[136:139], a[172:175], a[60:63], v[136:139]
    ds_read_b128 a[164:167], v8 offset:24576
    v_fmac_f32 v75, v55, v135
    v_mfma_f32_16x16x32_bf16 v[140:143], a[176:179], a[60:63], v[140:143]
    ds_read_b128 a[168:171], v9 offset:4096
    v_cvt_pk_bf16_f32 v116, v68, v69
    v_mfma_f32_16x16x32_bf16 v[136:139], a[180:183], a[64:67], v[136:139]
    s_waitcnt lgkmcnt(5)
    ds_read_b128 a[172:175], v9 offset:9216
    v_cvt_pk_bf16_f32 v117, v70, v71
    v_mfma_f32_16x16x32_bf16 v[140:143], a[184:187], a[64:67], v[140:143]
    ds_read_b128 a[176:179], v9 offset:14336
    v_cvt_pk_bf16_f32 v118, v72, v73
    v_mfma_f32_16x16x32_bf16 v[136:139], a[188:191], a[68:71], v[136:139]
    ds_read_b128 a[180:183], v9 offset:19456
    v_cvt_pk_bf16_f32 v119, v74, v75
    v_mfma_f32_16x16x32_bf16 v[140:143], a[144:147], a[68:71], v[140:143]
    s_waitcnt lgkmcnt(5)
    ds_read_b128 a[184:187], v9 offset:24576
    ds_write_b64 v160, v[116:117] offset:0
    ds_write_b64 v160, v[118:119] offset:8
    v_mfma_f32_16x16x32_bf16 v[136:139], a[148:151], a[72:75], v[136:139]
    ds_read_b128 a[188:191], v10 offset:4096
    v_mfma_f32_16x16x32_bf16 v[140:143], a[152:155], a[72:75], v[140:143]
    ds_read_b128 a[144:147], v10 offset:9216
    v_mfma_f32_16x16x32_bf16 v[136:139], a[156:159], a[76:79], v[136:139]
    s_waitcnt lgkmcnt(7)
    ds_read_b128 a[148:151], v10 offset:14336
    v_mfma_f32_16x16x32_bf16 v[140:143], a[160:163], a[76:79], v[140:143]
    ds_read_b128 a[152:155], v10 offset:19456
    v_mfma_f32_16x16x32_bf16 v[144:147], a[164:167], a[36:39], v[144:147]
    ds_read_b128 a[156:159], v10 offset:24576
    v_mfma_f32_16x16x32_bf16 v[144:147], a[168:171], a[40:43], v[144:147]
    s_waitcnt lgkmcnt(7)
    v_mfma_f32_16x16x32_bf16 v[144:147], a[172:175], a[44:47], v[144:147]
    v_mfma_f32_16x16x32_bf16 v[144:147], a[176:179], a[48:51], v[144:147]
    v_mfma_f32_16x16x32_bf16 v[144:147], a[180:183], a[52:55], v[144:147]
    s_waitcnt lgkmcnt(2)
    v_fmac_f32 v76, v56, v136
    v_fmac_f32 v77, v57, v137
    v_mfma_f32_16x16x32_bf16 v[144:147], a[184:187], a[56:59], v[144:147]
    v_fmac_f32 v78, v58, v138
    v_fmac_f32 v79, v59, v139
    v_mfma_f32_16x16x32_bf16 v[144:147], a[188:191], a[60:63], v[144:147]
    v_fmac_f32 v80, v60, v140
    v_fmac_f32 v81, v61, v141
    v_mfma_f32_16x16x32_bf16 v[144:147], a[144:147], a[64:67], v[144:147]
    s_waitcnt lgkmcnt(0)
    v_fmac_f32 v82, v62, v142
    v_fmac_f32 v83, v63, v143
    v_mfma_f32_16x16x32_bf16 v[144:147], a[148:151], a[68:71], v[144:147]
    v_cvt_pk_bf16_f32 v120, v76, v77
    v_cvt_pk_bf16_f32 v121, v78, v79
    v_mfma_f32_16x16x32_bf16 v[144:147], a[152:155], a[72:75], v[144:147]
    v_cvt_pk_bf16_f32 v122, v80, v81
    v_cvt_pk_bf16_f32 v123, v82, v83
    v_mfma_f32_16x16x32_bf16 v[144:147], a[156:159], a[76:79], v[144:147]
    ds_write_b64 v160, v[120:121] offset:16
    ds_write_b64 v160, v[122:123] offset:24
    s_nop 7
    v_fmac_f32 v84, v64, v144
    v_fmac_f32 v85, v65, v145
    v_fmac_f32 v86, v66, v146
    v_fmac_f32 v87, v67, v147
    v_cvt_pk_bf16_f32 v124, v84, v85
    v_cvt_pk_bf16_f32 v125, v86, v87
    ds_write_b64 v160, v[124:125] offset:32
    ds_read_b128 v[168:171], v161
    ds_read_b128 v[172:175], v162
    ds_read_b128 v[176:179], v163
    s_waitcnt lgkmcnt(2)
    buffer_store_dwordx4 v[168:171], v164, s[44:47], s72 offen offset:0 nt
    s_waitcnt lgkmcnt(1)
    buffer_store_dwordx4 v[172:175], v165, s[44:47], s72 offen offset:0 nt
    s_waitcnt lgkmcnt(0)
    buffer_store_dwordx4 v[176:179], v166, s[44:47], s72 offen offset:0 nt
L_exit:
    s_endpgm
L_ps1:
    s_mov_b32 s66, 0x40000
L_pc1:
    s_sleep 2
    buffer_load_dword v157, v156, s[40:43], 0 offen offset:0 sc1
    s_sub_u32 s66, s66, 1
    s_cmp_eq_u32 s66, 0
    s_waitcnt vmcnt(0)
    s_cbranch_scc1 L_pd1
    v_bfe_u32 v157, v157, 0, 8
    v_cmp_gt_u32 vcc, 4, v157
    s_cbranch_vccnz L_pc1
    s_branch L_pd1
L_ps2:
    s_mov_b32 s66, 0x40000
L_pc2:
    s_sleep 2
    buffer_load_dword v157, v126, s[12:15], 0 offen offset:0 sc1
    buffer_load_dword v158, v127, s[12:15], 0 offen offset:0 sc1
    s_sub_u32 s66, s66, 1
    s_cmp_eq_u32 s66, 0
    s_waitcnt vmcnt(0)
    s_cbranch_scc1 L_pd2
    v_min_u32 v157, v157, v158
    v_cmp_gt_u32 vcc, 1, v157
    s_cbranch_vccnz L_pc2
    s_branch L_pd2
L_ps3:
    s_mov_b32 s66, 0x40000
L_pc3:
    s_sleep 2
    buffer_load_dword v157, v156, s[40:43], 0 offen offset:0 sc1
    s_sub_u32 s66, s66, 1
    s_cmp_eq_u32 s66, 0
    s_waitcnt vmcnt(0)
    s_cbranch_scc1 L_pd3
    v_bfe_u32 v157, v157, 0, 8
    v_cmp_gt_u32 vcc, 4, v157
    s_cbranch_vccnz L_pc3
    s_branch L_pd3
L_ps4:
    s_mov_b32 s66, 0x40000
L_pc4:
    s_sleep 2
    buffer_load_dword v157, v126, s[12:15], 0 offen offset:0 sc1
    buffer_load_dword v158, v127, s[12:15], 0 offen offset:0 sc1
    s_sub_u32 s66, s66, 1
    s_cmp_eq_u32 s66, 0
    s_waitcnt vmcnt(0)
    s_cbranch_scc1 L_pd4
    v_min_u32 v157, v157, v158
    v_cmp_gt_u32 vcc, 1, v157
    s_cbranch_vccnz L_pc4
    s_branch L_pd4
L_ps5:
    s_mov_b32 s66, 0x40000
L_pc5:
    s_sleep 2
    buffer_load_dword v157, v156, s[40:43], 0 offen offset:0 sc1
    s_sub_u32 s66, s66, 1
    s_cmp_eq_u32 s66, 0
    s_waitcnt vmcnt(0)
    s_cbranch_scc1 L_pd5
    v_bfe_u32 v157, v157, 8, 8
    v_cmp_gt_u32 vcc, 4, v157
    s_cbranch_vccnz L_pc5
    s_branch L_pd5
L_ps6:
    s_mov_b32 s66, 0x40000
L_pc6:
    s_sleep 2
    buffer_load_dword v157, v156, s[12:15], s64 offen offset:0 sc1
    s_sub_u32 s66, s66, 1
    s_cmp_eq_u32 s66, 0
    s_waitcnt vmcnt(0)
    s_cbranch_scc1 L_pd6
    v_cmp_gt_u32 vcc, 1, v157
    s_cbranch_vccnz L_pc6
    s_branch L_pd6
L_redo:
    s_cmp_lg_u32 s23, 0
    s_cbranch_scc1 L_clean
    s_mov_b32 s23, 1
    s_mov_b32 s66, 0x40000
L_redo_poll:
    buffer_load_dword v157, v156, s[12:15], s64 offen offset:128 sc1
    s_sub_u32 s66, s66, 1
    s_cmp_eq_u32 s66, 0
    s_waitcnt vmcnt(0) lgkmcnt(0)
    s_cbranch_scc1 L_redo_go
    v_cmp_gt_u32 vcc, 1, v157
    s_cbranch_vccz L_redo_go
    s_sleep 2
    s_branch L_redo_poll
L_redo_go:
    s_add_u32 s24, s12, s67
    s_addc_u32 s25, s13, 0
    global_load_dwordx4 a[0:3], v5, s[24:25] offset:-4096 sc1
    global_load_dwordx4 a[4:7], v5, s[24:25] offset:-2048 sc1
    global_load_dwordx4 a[8:11], v5, s[24:25] offset:0 sc1
    global_load_dwordx4 a[12:15], v5, s[24:25] offset:2048 sc1
    s_add_u32 s24, s24, 8192
    s_addc_u32 s25, s25, 0
    global_load_dwordx4 a[16:19], v5, s[24:25] offset:-4096 sc1
    global_load_dwordx4 a[20:23], v5, s[24:25] offset:-2048 sc1
    global_load_dwordx4 a[24:27], v5, s[24:25] offset:0 sc1
    global_load_dwordx4 a[28:31], v5, s[24:25] offset:2048 sc1
    s_add_u32 s24, s24, 8192
    s_addc_u32 s25, s25, 0
    global_load_dwordx4 a[32:35], v5, s[24:25] offset:-4096 sc1
    global_load_dwordx4 a[36:39], v5, s[24:25] offset:-2048 sc1
    global_load_dwordx4 a[40:43], v5, s[24:25] offset:0 sc1
    global_load_dwordx4 a[44:47], v5, s[24:25] offset:2048 sc1
    s_add_u32 s24, s24, 8192
    s_addc_u32 s25, s25, 0
    global_load_dwordx4 a[48:51], v5, s[24:25] offset:-4096 sc1
    global_load_dwordx4 a[52:55], v5, s[24:25] offset:-2048 sc1
    global_load_dwordx4 a[56:59], v5, s[24:25] offset:0 sc1
    ds_read_b128 a[144:147], v7 offset:0
    ds_read_b128 a[148:151], v7 offset:1024
    ds_read_b128 a[152:155], v7 offset:2048
    ds_read_b128 a[156:159], v7 offset:3072
    ds_read_b128 a[160:163], v7 offset:4096
    ds_read_b128 a[164:167], v7 offset:5120
    ds_read_b128 a[168:171], v7 offset:6144
    ds_read_b128 a[172:175], v7 offset:7168
    ds_read_b128 a[176:179], v7 offset:8192
    ds_read_b128 a[180:183], v7 offset:9216
    s_waitcnt vmcnt(0) lgkmcnt(0)
    s_branch L_wo
L_slow:
    v_subrev_u32 v146, 123904, v146
    s_add_u32 m0, s48, 37888
    v_mov_b32 v128, 0x3f80
    v_mov_b32 v129, 0
    v_mov_b32 v130, 0
    v_mov_b32 v131, 0
    s_waitcnt vmcnt(0)
    ds_write_b128 v155, v[128:131] offset:39936
    s_mov_b64 s[16:17], s[12:13]
    s_mov_b32 s65, 0
    v_mov_b32 v136, 0xff800000
L_sa0:
    global_load_dwordx4 a[198:201], v144, s[16:17] offset:0 sc1
    global_load_dwordx2 a[202:203], v145, s[16:17] offset:0 sc1
    s_waitcnt vmcnt(0)
    v_mfma_f32_32x32x16_bf16 v[112:127], a[198:201], a[180:183], 0
    v_mfma_f32_32x32x8_bf16 v[112:127], a[202:203], a[184:185], v[112:127]
    s_add_u32 s16, s16, 123904
    s_addc_u32 s17, s17, 0
    s_add_u32 s65, s65, 1
    s_nop 7
    s_nop 0
    v_max3_f32 v136, v136, v112, v113
    v_max3_f32 v136, v136, v114, v115
    v_max3_f32 v136, v136, v116, v117
    v_max3_f32 v136, v136, v118, v119
    v_max3_f32 v136, v136, v120, v121
    v_max3_f32 v136, v136, v122, v123
    v_max3_f32 v136, v136, v124, v125
    v_max3_f32 v136, v136, v126, v127
    s_cmp_lt_u32 s65, 64
    s_cbranch_scc1 L_sa0
    v_mov_b32 v137, v136
    s_nop 1
    v_permlane32_swap_b32 v136, v137
    s_nop 0
    v_max_f32 v136, v136, v137
    s_mov_b64 s[16:17], s[12:13]
    s_mov_b32 s65, 0
    v_mov_b32 v160, 0
    v_mov_b32 v161, 0
    v_mov_b32 v162, 0
    v_mov_b32 v163, 0
    v_mov_b32 v164, 0
    v_mov_b32 v165, 0
    v_mov_b32 v166, 0
    v_mov_b32 v167, 0
    v_mov_b32 v168, 0
    v_mov_b32 v169, 0
    v_mov_b32 v170, 0
    v_mov_b32 v171, 0
    v_mov_b32 v172, 0
    v_mov_b32 v173, 0
    v_mov_b32 v174, 0
    v_mov_b32 v175, 0
L_sb0:
    global_load_dwordx4 a[198:201], v144, s[16:17] offset:0 sc1
    global_load_dwordx2 a[202:203], v145, s[16:17] offset:0 sc1
    global_load_lds_dwordx4 v146, s[16:17] offset:0 sc1
    global_load_lds_dwordx4 v146, s[16:17] offset:1024 sc1
    s_waitcnt vmcnt(0)
    ds_read_b64_tr_b16 a[212:213], v148 offset:0
    ds_read_b64_tr_b16 a[214:215], v148 offset:64
    ds_read_b64_tr_b16 a[216:217], v148 offset:256
    ds_read_b64_tr_b16 a[218:219], v148 offset:320
    v_mfma_f32_32x32x16_bf16 v[112:127], a[198:201], a[180:183], 0
    v_mfma_f32_32x32x8_bf16 v[112:127], a[202:203], a[184:185], v[112:127]
    s_add_u32 s16, s16, 123904
    s_addc_u32 s17, s17, 0
    s_add_u32 s65, s65, 1
    s_nop 7
    s_nop 0
    v_sub_f32 v112, v112, v136
    v_sub_f32 v113, v113, v136
    v_sub_f32 v114, v114, v136
    v_sub_f32 v115, v115, v136
    v_sub_f32 v116, v116, v136
    v_sub_f32 v117, v117, v136
    v_sub_f32 v118, v118, v136
    v_sub_f32 v119, v119, v136
    v_sub_f32 v120, v120, v136
    v_sub_f32 v121, v121, v136
    v_sub_f32 v122, v122, v136
    v_sub_f32 v123, v123, v136
    v_sub_f32 v124, v124, v136
    v_sub_f32 v125, v125, v136
    v_sub_f32 v126, v126, v136
    v_sub_f32 v127, v127, v136
    v_exp_f32 v112, v112
    v_exp_f32 v113, v113
    v_exp_f32 v114, v114
    v_exp_f32 v115, v115
    v_exp_f32 v116, v116
    v_exp_f32 v117, v117
    v_exp_f32 v118, v118
    v_exp_f32 v119, v119
    v_exp_f32 v120, v120
    v_exp_f32 v121, v121
    v_exp_f32 v122, v122
    v_exp_f32 v123, v123
    v_exp_f32 v124, v124
    v_exp_f32 v125, v125
    v_exp_f32 v126, v126
    v_exp_f32 v127, v127
    s_waitcnt lgkmcnt(0)
    s_nop 0
    v_smfmac_f32_32x32x32_bf16 v[160:175], a[212:215], v[112:119], v150
    v_smfmac_f32_32x32x32_bf16 v[160:175], a[216:219], v[120:127], v150
    s_cmp_lt_u32 s65, 64
    s_cbranch_scc1 L_sb0
    s_mov_b64 s[16:17], s[12:13]
    s_mov_b32 s65, 0
    v_mov_b32 v136, 0xff800000
L_sa1:
    global_load_dwordx4 a[198:201], v144, s[16:17] offset:0 sc1
    global_load_dwordx2 a[202:203], v145, s[16:17] offset:0 sc1
    s_waitcnt vmcnt(0)
    v_mfma_f32_32x32x16_bf16 v[112:127], a[198:201], a[186:189], 0
    v_mfma_f32_32x32x8_bf16 v[112:127], a[202:203], a[190:191], v[112:127]
    s_add_u32 s16, s16, 123904
    s_addc_u32 s17, s17, 0
    s_add_u32 s65, s65, 1
    s_nop 7
    s_nop 0
    v_max3_f32 v136, v136, v112, v113
    v_max3_f32 v136, v136, v114, v115
    v_max3_f32 v136, v136, v116, v117
    v_max3_f32 v136, v136, v118, v119
    v_max3_f32 v136, v136, v120, v121
    v_max3_f32 v136, v136, v122, v123
    v_max3_f32 v136, v136, v124, v125
    v_max3_f32 v136, v136, v126, v127
    s_cmp_lt_u32 s65, 64
    s_cbranch_scc1 L_sa1
    v_mov_b32 v137, v136
    s_nop 1
    v_permlane32_swap_b32 v136, v137
    s_nop 0
    v_max_f32 v136, v136, v137
    s_mov_b64 s[16:17], s[12:13]
    s_mov_b32 s65, 0
    v_mov_b32 v176, 0
    v_mov_b32 v177, 0
    v_mov_b32 v178, 0
    v_mov_b32 v179, 0
    v_mov_b32 v180, 0
    v_mov_b32 v181, 0
    v_mov_b32 v182, 0
    v_mov_b32 v183, 0
    v_mov_b32 v184, 0
    v_mov_b32 v185, 0
    v_mov_b32 v186, 0
    v_mov_b32 v187, 0
    v_mov_b32 v188, 0
    v_mov_b32 v189, 0
    v_mov_b32 v190, 0
    v_mov_b32 v191, 0
L_sb1:
    global_load_dwordx4 a[198:201], v144, s[16:17] offset:0 sc1
    global_load_dwordx2 a[202:203], v145, s[16:17] offset:0 sc1
    global_load_lds_dwordx4 v146, s[16:17] offset:0 sc1
    global_load_lds_dwordx4 v146, s[16:17] offset:1024 sc1
    s_waitcnt vmcnt(0)
    ds_read_b64_tr_b16 a[212:213], v148 offset:0
    ds_read_b64_tr_b16 a[214:215], v148 offset:64
    ds_read_b64_tr_b16 a[216:217], v148 offset:256
    ds_read_b64_tr_b16 a[218:219], v148 offset:320
    v_mfma_f32_32x32x16_bf16 v[112:127], a[198:201], a[186:189], 0
    v_mfma_f32_32x32x8_bf16 v[112:127], a[202:203], a[190:191], v[112:127]
    s_add_u32 s16, s16, 123904
    s_addc_u32 s17, s17, 0
    s_add_u32 s65, s65, 1
    s_nop 7
    s_nop 0
    v_sub_f32 v112, v112, v136
    v_sub_f32 v113, v113, v136
    v_sub_f32 v114, v114, v136
    v_sub_f32 v115, v115, v136
    v_sub_f32 v116, v116, v136
    v_sub_f32 v117, v117, v136
    v_sub_f32 v118, v118, v136
    v_sub_f32 v119, v119, v136
    v_sub_f32 v120, v120, v136
    v_sub_f32 v121, v121, v136
    v_sub_f32 v122, v122, v136
    v_sub_f32 v123, v123, v136
    v_sub_f32 v124, v124, v136
    v_sub_f32 v125, v125, v136
    v_sub_f32 v126, v126, v136
    v_sub_f32 v127, v127, v136
    v_exp_f32 v112, v112
    v_exp_f32 v113, v113
    v_exp_f32 v114, v114
    v_exp_f32 v115, v115
    v_exp_f32 v116, v116
    v_exp_f32 v117, v117
    v_exp_f32 v118, v118
    v_exp_f32 v119, v119
    v_exp_f32 v120, v120
    v_exp_f32 v121, v121
    v_exp_f32 v122, v122
    v_exp_f32 v123, v123
    v_exp_f32 v124, v124
    v_exp_f32 v125, v125
    v_exp_f32 v126, v126
    v_exp_f32 v127, v127
    s_waitcnt lgkmcnt(0)
    s_nop 0
    v_smfmac_f32_32x32x32_bf16 v[176:191], a[212:215], v[112:119], v150
    v_smfmac_f32_32x32x32_bf16 v[176:191], a[216:219], v[120:127], v150
    s_cmp_lt_u32 s65, 64
    s_cbranch_scc1 L_sb1
    s_add_u32 m0, s48, 35840
    s_add_u32 s4, s71, 20480
    buffer_load_dwordx4 v1, s[12:15], s4 offen offset:0 sc1 lds
    buffer_load_dwordx4 v1, s[12:15], s4 offen offset:1024 sc1 lds
    buffer_load_dwordx4 v1, s[12:15], s4 offen offset:2048 sc1 lds
    buffer_load_dwordx4 v1, s[12:15], s4 offen offset:3072 sc1 lds
    s_add_u32 m0, s48, 39936
    s_add_u32 s4, s71, 24576
    buffer_load_dwordx4 v1, s[12:15], s4 offen offset:0 sc1 lds
    s_waitcnt vmcnt(0)
    s_nop 3
    v_mov_b32 v158, v168
    v_mov_b32 v159, v184
    s_nop 1
    v_permlane32_swap_b32 v158, v159
    s_nop 0
    v_rcp_f32 v158, v159
    s_nop 0
    s_branch L_norm
L_end:
.section .rodata,"a"
.p2align 6
.amdhsa_kernel recurrent_scan__softmax_full_mha__swiglu_ffn__prompt_kernel
  .amdhsa_next_free_vgpr 512
  .amdhsa_next_free_sgpr 102
  .amdhsa_accum_offset 256
  .amdhsa_group_segment_fixed_size 0
  .amdhsa_kernarg_size 80
  .amdhsa_user_sgpr_count 2
  .amdhsa_user_sgpr_kernarg_segment_ptr 1
  .amdhsa_system_sgpr_workgroup_id_x 1
.end_amdhsa_kernel
```
